```python
import torch

def _softmax(x, axis=-1):
    return torch.softmax(x, dim=axis)
def _gelu(x):
    return torch.nn.functional.gelu(x, approximate="tanh")
def _silu(x):
    return torch.nn.functional.silu(x)
def _sigmoid(x):
    return torch.sigmoid(x)
def _layernorm(x, axis=-1, eps=1e-5):
    m = x.mean(dim=axis, keepdim=True)
    v = x.var(dim=axis, keepdim=True, unbiased=False)
    return (x - m) / torch.sqrt(v + eps)
def _scatter_add(tgt, idx, src, axis=0):
    return tgt.clone().index_add_(axis, idx, src)
def _segment_sum(src, seg, n):
    out = torch.zeros((n,) + src.shape[1:], dtype=src.dtype)
    return out.index_add_(0, seg, src)
def _pad(x, pw):
    flat = tuple(v for pair in reversed(pw) for v in pair)
    return torch.nn.functional.pad(x, flat)

kernel_name = 'gated_mix__softmax_full_mha__glu_gated_bilinear__prompt'

def setup_inputs():

    _w = (lambda a: (lambda t: t.to(torch.bfloat16) if t.is_floating_point() else t)(torch.as_tensor(a)))
    def _A_setup():
        B, S, D = 1, 2048, 1024
        return {
            "x": _w((lambda *s: torch.randn(*s, dtype=torch.bfloat16) * 0.05)(B, S, D)),
            "wqkv": _w((lambda *s: torch.randn(*s, dtype=torch.bfloat16) * 0.8)(D, 3 * D)),
            "wo": _w((lambda *s: torch.randn(*s, dtype=torch.bfloat16) * 0.05)(D, D)),
        }
    _A_in = _A_setup()

    def _B_setup():
        B, S, D, F = 1, 2048, 1024, 3584
        return {
            "x": _w((lambda *s: torch.randn(*s, dtype=torch.bfloat16) * 0.05)(B, S, D)),
            "w_gate": _w((lambda *s: torch.randn(*s, dtype=torch.bfloat16) * 3.2)(D, F) * (D ** -0.5)),
            "w_up": _w((lambda *s: torch.randn(*s, dtype=torch.bfloat16) * 3.2)(D, F) * (D ** -0.5)),
            "w_down": _w((lambda *s: torch.randn(*s, dtype=torch.bfloat16) * 3.2)(F, D) * (F ** -0.5)),
        }
    _B_in = _B_setup()

    return {
        "A_x": _A_in["x"],
        "A_wqkv": _A_in["wqkv"],
        "A_wo": _A_in["wo"],
        "B_x": _B_in["x"],
        "B_w_gate": _B_in["w_gate"],
        "B_w_up": _B_in["w_up"],
        "B_w_down": _B_in["w_down"],
        "gate_w": _w((lambda *s: torch.randn(*s, dtype=torch.bfloat16) * 0.05)(1024) * 16.0),
    }

def reference(A_x, A_wqkv, A_wo, B_x, B_w_gate, B_w_up, B_w_down, gate_w):
    def _A_ref(x, wqkv, wo):
        B, S, D = x.shape
        H = 32; Dh = D // H
        qkv = (lambda x, *d: x.permute(*d))((x @ wqkv).reshape(B, S, 3, H, Dh), 2, 0, 3, 1, 4)
        q, k, v = qkv[0], qkv[1], qkv[2]
        scale = Dh ** -0.5
        scores = torch.einsum("bhqd,bhkd->bhqk", q, k) * scale
        p = _softmax(scores, axis=-1)
        o = torch.einsum("bhqk,bhkd->bhqd", p, v)
        return (lambda x, *d: x.permute(*d))(o, 0, 2, 1, 3).reshape(B, S, D) @ wo

    def _B_ref(x, w_gate, w_up, w_down):
        g = torch.einsum("bsd,df->bsf", x, w_gate)
        u = torch.einsum("bsd,df->bsf", x, w_up)
        h = g * u
        return torch.einsum("bsf,fd->bsd", h, w_down)

    x = A_x
    g = _sigmoid((x * gate_w).sum(-1, keepdims=True))
    a = _A_ref(x, A_wqkv, A_wo)
    b = _B_ref(x, B_w_gate, B_w_up, B_w_down)
    return g * a + (1 - g) * b
```

```asm
; @launch grid=(256,1,1) block=(256,1,1) lds=163840
.amdgcn_target "amdgcn-amd-amdhsa--gfx950"
.text
.globl gated_mix__softmax_full_mha__glu_gated_bilinear__prompt_kernel
.p2align 8
.type gated_mix__softmax_full_mha__glu_gated_bilinear__prompt_kernel,@function
gated_mix__softmax_full_mha__glu_gated_bilinear__prompt_kernel:
k_start:
    s_cmp_ge_u32 s2, 256
    s_cbranch_scc1 k_done
    s_load_dwordx16 s[40:55], s[0:1], 0
    s_load_dwordx4 s[56:59], s[0:1], 64
    s_load_dwordx2 s[60:61], s[0:1], 80
    s_getpc_b64 s[62:63]
    s_lshr_b32 s39, s2, 3
    s_mul_i32 s39, s39, 20
    v_lshrrev_b32 v1, 6, v0
    v_mul_u32_u24 v1, 5, v1
    v_and_b32 v2, 63, v0
    v_min_u32 v2, 4, v2
    v_add3_u32 v1, v1, v2, s39
    v_lshlrev_b32 v1, 7, v1
    v_min_u32 v1, k_end - k_start - 128, v1
    global_load_dword v248, v1, s[62:63]
    v_lshrrev_b32 v1, 6, v0
    v_and_b32 v255, 63, v0
    v_readfirstlane_b32 s3, v1
    v_lshlrev_b32 v254, 4, v255
    s_lshr_b32 s36, s2, 5
    s_and_b32 s39, s2, 7
    s_lshl_b32 s39, s39, 2
    s_bfe_u32 s78, s2, 0x20003
    s_add_u32 s37, s39, s78
    s_bitcmp1_b32 s3, 0
    s_mov_b32 s39, 458752
    s_cselect_b32 s77, 393216, s39
    s_cselect_b32 s39, 6, 14
    s_lshr_b32 s78, s2, 3
    s_lshl_b32 s78, s78, 1
    s_and_b32 s79, s2, 7
    v_cmp_le_u32 vcc, 7, v255
    v_mov_b32 v210, 6272
    s_mul_i32 s76, s78, 7168
    v_cndmask_b32 v210, 0, v210, vcc
    v_lshl_add_u32 v210, v255, 7, v210
    s_mul_i32 s62, s79, 896
    s_add_u32 s76, s76, s62
    v_add_u32 v210, s76, v210
    s_lshr_b32 s62, s3, 1
    s_add_u32 s78, s78, s62
    s_mul_i32 s78, s78, 6144
    s_lshl_b32 s79, s79, 8
    s_add_u32 s78, s78, s79
    v_lshrrev_b32 v208, 1, v255
    v_lshlrev_b32 v208, 11, v208
    v_and_b32 v211, 1, v255
    v_lshl_add_u32 v208, v211, 7, v208
    v_add_u32 v208, s78, v208
    s_bitcmp1_b32 s3, 0
    s_cselect_b64 vcc, -1, 0
    v_cndmask_b32 v208, v210, v208, vcc
    v_mov_b32 v209, 0x7ff00000
    v_cmp_gt_u32 vcc, s39, v255
    s_mov_b32 s76, 0
    s_nop 0
    v_cndmask_b32 v207, v209, v208, vcc
    s_lshr_b32 s78, s2, 3
    s_lshl_b32 s78, s78, 2
    s_add_u32 s78, s78, s3
    s_lshl_b32 s75, s78, 15
    v_and_b32 v208, 15, v255
    v_lshrrev_b32 v210, 4, v255
    v_lshlrev_b32 v210, 7, v210
    v_lshl_add_u32 v208, v208, 11, v210
    v_cmp_gt_u32 vcc, 16, v255
    s_nop 1
    v_cndmask_b32 v250, v209, v208, vcc
    s_waitcnt lgkmcnt(0)
    s_mov_b32 s4, s40
    s_mov_b32 s5, s41
    s_mov_b32 s6, 0x400000
    s_mov_b32 s7, 0x20000
    s_cmp_lt_u32 s3, 2
    s_cselect_b32 s8, s48, s50
    s_cselect_b32 s9, s49, s51
    s_mov_b32 s10, 0x700000
    s_mov_b32 s11, 0x20000
    s_bitcmp1_b32 s3, 0
    s_cselect_b32 s32, s42, s8
    s_cselect_b32 s33, s43, s9
    s_cselect_b32 s34, 0x600000, s10
    s_mov_b32 s35, 0x20000
    buffer_load_dword v248, v250, s[4:7], s75 offen
    s_add_u32 s75, s75, 128
    buffer_load_dword v248, v207, s[32:35], s76 offen
    s_add_u32 s76, s76, s77
    s_mov_b32 s12, s42
    s_mov_b32 s13, s43
    s_mov_b32 s14, 0x600000
    s_mov_b32 s15, 0x20000
    v_lshrrev_b32 v208, 3, v255
    v_lshrrev_b32 v209, 4, v255
    v_xor_b32 v209, v209, v255
    v_and_b32 v209, 7, v209
    v_lshlrev_b32 v209, 4, v209
    v_lshl_add_u32 v176, v208, 11, v209
    v_xor_b32 v210, 64, v176
    v_add_u32 v177, 15360, v210
    v_add_u32 v178, 30720, v176
    v_add_u32 v179, 46080, v210
    v_add_u32 v180, 65536, v176
    v_add_u32 v181, 80896, v210
    v_add_u32 v182, 96256, v176
    v_add_u32 v183, 111616, v210
    s_lshl_b32 s39, s36, 2
    s_add_u32 s39, s39, s3
    s_lshl_b32 s63, s39, 17
    s_lshl_b32 s66, s3, 13
    s_add_u32 s66, s66, 122880
    v_lshrrev_b32 v208, 2, v255
    s_lshl_b32 s39, s3, 4
    v_add_u32 v208, s39, v208
    v_mul_u32_u24 v208, 6144, v208
    v_lshrrev_b32 v209, 4, v255
    v_and_b32 v209, 2, v209
    v_xor_b32 v209, v209, v255
    v_and_b32 v209, 3, v209
    v_lshlrev_b32 v209, 4, v209
    s_lshl_b32 s39, s37, 6
    v_add3_u32 v191, v208, v209, s39
    v_add_u32 v192, 1024, v191
    v_add_u32 v193, 2048, v191
    s_mul_i32 s67, s3, 7168
    s_mul_i32 s68, s3, 3072
    s_add_u32 s68, s68, 28672
    s_mov_b32 s64, 0
    s_mov_b32 s65, 0
    s_mov_b32 s69, 81920
    s_mov_b32 s70, 81920
    s_mov_b32 m0, s66
    s_nop 0
    buffer_load_dwordx4 v176, s[4:7], s63 offen offset:0 lds
    buffer_load_dwordx4 v177, s[4:7], s63 offen offset:1024 lds
    buffer_load_dwordx4 v178, s[4:7], s63 offen offset:2048 lds
    buffer_load_dwordx4 v179, s[4:7], s63 offen offset:3072 lds
    s_add_u32 m0, m0, 4096
    s_nop 0
    buffer_load_dwordx4 v180, s[4:7], s63 offen offset:0 lds
    buffer_load_dwordx4 v181, s[4:7], s63 offen offset:1024 lds
    buffer_load_dwordx4 v182, s[4:7], s63 offen offset:2048 lds
    buffer_load_dwordx4 v183, s[4:7], s63 offen offset:3072 lds
    s_add_u32 m0, s68, s69
    s_nop 0
    buffer_load_dwordx4 v191, s[12:15], s65 offen offset:0 lds
    buffer_load_dwordx4 v192, s[12:15], s65 offen offset:1024 lds
    buffer_load_dwordx4 v193, s[12:15], s65 offen offset:2048 lds
    s_add_u32 s63, s63, 128
    buffer_load_dword v248, v207, s[32:35], s76 offen
    s_add_u32 s76, s76, s77
    s_and_b32 s39, s3, 1
    s_mul_i32 s39, s39, 229376
    s_mul_i32 s78, s37, 224
    s_add_u32 s39, s39, s78
    s_and_b32 s78, s37, 1
    s_lshl_b32 s78, s78, 1
    v_add_u32 v208, 0, v255
    v_mul_u32_u24 v209, 4682, v208
    v_lshrrev_b32 v209, 16, v209
    v_mul_u32_u24 v210, 14, v209
    v_sub_u32 v208, v208, v210
    v_add_u32 v208, s78, v208
    v_subrev_u32 v210, 14, v208
    v_min_u32 v208, v208, v210
    v_lshrrev_b32 v210, 1, v209
    v_xor_b32 v210, v210, v209
    v_and_b32 v210, 4, v210
    v_mul_u32_u24 v210, 3, v210
    v_xor_b32 v209, v209, v210
    v_mul_u32_u24 v209, 7168, v209
    v_lshl_add_u32 v208, v208, 4, v209
    v_add_u32 v184, s39, v208
    v_add_u32 v208, 64, v255
    v_mul_u32_u24 v209, 4682, v208
    v_lshrrev_b32 v209, 16, v209
    v_mul_u32_u24 v210, 14, v209
    v_sub_u32 v208, v208, v210
    v_add_u32 v208, s78, v208
    v_subrev_u32 v210, 14, v208
    v_min_u32 v208, v208, v210
    v_lshrrev_b32 v210, 1, v209
    v_xor_b32 v210, v210, v209
    v_and_b32 v210, 4, v210
    v_mul_u32_u24 v210, 3, v210
    v_xor_b32 v209, v209, v210
    v_mul_u32_u24 v209, 7168, v209
    v_lshl_add_u32 v208, v208, 4, v209
    v_add_u32 v185, s39, v208
    v_subrev_u32 v185, 1024, v185
    v_add_u32 v208, 128, v255
    v_mul_u32_u24 v209, 4682, v208
    v_lshrrev_b32 v209, 16, v209
    v_mul_u32_u24 v210, 14, v209
    v_sub_u32 v208, v208, v210
    v_add_u32 v208, s78, v208
    v_subrev_u32 v210, 14, v208
    v_min_u32 v208, v208, v210
    v_lshrrev_b32 v210, 1, v209
    v_xor_b32 v210, v210, v209
    v_and_b32 v210, 4, v210
    v_mul_u32_u24 v210, 3, v210
    v_xor_b32 v209, v209, v210
    v_mul_u32_u24 v209, 7168, v209
    v_lshl_add_u32 v208, v208, 4, v209
    v_add_u32 v186, s39, v208
    v_subrev_u32 v186, 2048, v186
    v_add_u32 v208, 192, v255
    v_mul_u32_u24 v209, 4682, v208
    v_lshrrev_b32 v209, 16, v209
    v_mul_u32_u24 v210, 14, v209
    v_sub_u32 v208, v208, v210
    v_add_u32 v208, s78, v208
    v_subrev_u32 v210, 14, v208
    v_min_u32 v208, v208, v210
    v_lshrrev_b32 v210, 1, v209
    v_xor_b32 v210, v210, v209
    v_and_b32 v210, 4, v210
    v_mul_u32_u24 v210, 3, v210
    v_xor_b32 v209, v209, v210
    v_mul_u32_u24 v209, 7168, v209
    v_lshl_add_u32 v208, v208, 4, v209
    v_add_u32 v187, s39, v208
    v_subrev_u32 v187, 3072, v187
    v_add_u32 v208, 256, v255
    v_mul_u32_u24 v209, 4682, v208
    v_lshrrev_b32 v209, 16, v209
    v_mul_u32_u24 v210, 14, v209
    v_sub_u32 v208, v208, v210
    v_add_u32 v208, s78, v208
    v_subrev_u32 v210, 14, v208
    v_min_u32 v208, v208, v210
    v_lshrrev_b32 v210, 1, v209
    v_xor_b32 v210, v210, v209
    v_and_b32 v210, 4, v210
    v_mul_u32_u24 v210, 3, v210
    v_xor_b32 v209, v209, v210
    v_mul_u32_u24 v209, 7168, v209
    v_lshl_add_u32 v208, v208, 4, v209
    v_add_u32 v188, s39, v208
    v_add_u32 v208, 320, v255
    v_mul_u32_u24 v209, 4682, v208
    v_lshrrev_b32 v209, 16, v209
    v_mul_u32_u24 v210, 14, v209
    v_sub_u32 v208, v208, v210
    v_add_u32 v208, s78, v208
    v_subrev_u32 v210, 14, v208
    v_min_u32 v208, v208, v210
    v_lshrrev_b32 v210, 1, v209
    v_xor_b32 v210, v210, v209
    v_and_b32 v210, 4, v210
    v_mul_u32_u24 v210, 3, v210
    v_xor_b32 v209, v209, v210
    v_mul_u32_u24 v209, 7168, v209
    v_lshl_add_u32 v208, v208, 4, v209
    v_add_u32 v189, s39, v208
    v_subrev_u32 v189, 1024, v189
    v_add_u32 v208, 384, v255
    v_mul_u32_u24 v209, 4682, v208
    v_lshrrev_b32 v209, 16, v209
    v_mul_u32_u24 v210, 14, v209
    v_sub_u32 v208, v208, v210
    v_add_u32 v208, s78, v208
    v_subrev_u32 v210, 14, v208
    v_min_u32 v208, v208, v210
    v_lshrrev_b32 v210, 1, v209
    v_xor_b32 v210, v210, v209
    v_and_b32 v210, 4, v210
    v_mul_u32_u24 v210, 3, v210
    v_xor_b32 v209, v209, v210
    v_mul_u32_u24 v209, 7168, v209
    v_lshl_add_u32 v208, v208, 4, v209
    v_add_u32 v190, s39, v208
    v_subrev_u32 v190, 2048, v190
    s_add_u32 m0, s67, s69
    s_nop 0
    buffer_load_dwordx4 v184, s[8:11], s64 offen offset:0 lds
    buffer_load_dwordx4 v185, s[8:11], s64 offen offset:1024 lds
    buffer_load_dwordx4 v186, s[8:11], s64 offen offset:2048 lds
    buffer_load_dwordx4 v187, s[8:11], s64 offen offset:3072 lds
    s_add_u32 m0, m0, 4096
    s_nop 0
    buffer_load_dwordx4 v188, s[8:11], s64 offen offset:0 lds
    buffer_load_dwordx4 v189, s[8:11], s64 offen offset:1024 lds
    buffer_load_dwordx4 v190, s[8:11], s64 offen offset:2048 lds
    s_add_u32 s64, s64, 458752
    s_add_u32 s65, s65, 393216
    s_add_u32 s69, s69, 40960
    s_cmp_eq_u32 s69, 122880
    s_cselect_b32 s69, 0, s69
    s_mov_b32 s16, s60
    s_mov_b32 s17, s61
    s_mov_b32 s18, 0x3000000
    s_mov_b32 s19, 0x20000
    s_mov_b32 s28, s58
    s_mov_b32 s29, s59
    s_mov_b32 s30, 0x100
    s_mov_b32 s31, 0x20000
    v_and_b32 v208, 15, v255
    v_lshrrev_b32 v209, 4, v255
    v_lshrrev_b32 v210, 1, v208
    v_xor_b32 v210, v210, v209
    v_lshlrev_b32 v210, 4, v210
    v_lshl_add_u32 v210, v208, 7, v210
    v_add_u32 v194, s66, v210
    v_xor_b32 v195, 64, v194
    v_lshrrev_b32 v208, 2, v208
    v_and_b32 v210, 1, v209
    v_lshrrev_b32 v209, 1, v209
    v_and_b32 v211, 3, v255
    v_lshlrev_b32 v211, 3, v211
    v_lshl_add_u32 v199, v210, 2, v208
    v_lshl_add_u32 v199, v209, 4, v199
    v_mul_u32_u24 v199, 224, v199
    v_add_u32 v199, v199, v211
    v_lshl_add_u32 v200, v210, 3, v208
    v_lshlrev_b32 v200, 6, v200
    v_lshl_add_u32 v200, v210, 5, v200
    v_mul_u32_u24 v209, 3072, v209
    v_add3_u32 v200, v200, v209, v211
    v_add_u32 v200, 28672, v200
    v_xor_b32 v201, 32, v200
    v_add_u32 v196, s70, v199
    v_add_u32 v197, s70, v200
    v_add_u32 v198, s70, v201
    v_mov_b32 v253, 1
    v_mov_b32 v208, 0x7ff00000
    v_cmp_eq_u32 vcc, 0, v255
    s_nop 1
    v_cndmask_b32 v252, v208, 0, vcc
    v_mov_b32 v212, 0
    v_mov_b32 v213, 0
    v_mov_b32 v214, 0
    v_mov_b32 v215, 0
    s_lshl_b32 s39, s36, 5
    s_add_u32 s39, s39, s37
    s_lshl_b32 s39, s39, 2
    s_add_u32 s41, s39, s3
    s_waitcnt vmcnt(8)
    s_barrier
    ds_read_b64_tr_b16 a[64:65], v197 offset:1024
    ds_read_b64_tr_b16 a[66:67], v197 offset:1280
    ds_read_b64_tr_b16 a[68:69], v197 offset:7168
    ds_read_b64_tr_b16 a[70:71], v197 offset:7424
    ds_read_b128 a[0:3], v194 offset:0
    ds_read_b128 a[4:7], v195 offset:0
    ds_read_b128 a[8:11], v194 offset:2048
    ds_read_b128 a[12:15], v195 offset:2048
    ds_read_b128 a[16:19], v194 offset:4096
    ds_read_b128 a[20:23], v195 offset:4096
    ds_read_b128 a[24:27], v194 offset:6144
    ds_read_b128 a[28:31], v195 offset:6144
    s_waitcnt lgkmcnt(8)
    ds_read_b64_tr_b16 a[72:73], v198 offset:1024
    ds_read_b64_tr_b16 a[74:75], v198 offset:1280
    ds_read_b64_tr_b16 a[76:77], v198 offset:7168
    ds_read_b64_tr_b16 a[78:79], v198 offset:7424
    s_mov_b32 s38, 6
    s_waitcnt lgkmcnt(4)
    v_mfma_f32_16x16x32_bf16 v[112:115], a[64:67], a[0:3], 0
    ds_read_b64_tr_b16 a[80:81], v197 offset:2048
    v_mfma_f32_16x16x32_bf16 v[112:115], a[68:71], a[4:7], v[112:115]
    ds_read_b64_tr_b16 a[82:83], v197 offset:2304
    v_mfma_f32_16x16x32_bf16 v[116:119], a[64:67], a[8:11], 0
    ds_read_b64_tr_b16 a[84:85], v197 offset:8192
    v_mfma_f32_16x16x32_bf16 v[116:119], a[68:71], a[12:15], v[116:119]
    ds_read_b64_tr_b16 a[86:87], v197 offset:8448
    s_mov_b32 m0, s66
    v_mfma_f32_16x16x32_bf16 v[120:123], a[64:67], a[16:19], 0
    buffer_load_dwordx4 v176, s[4:7], s63 offen offset:0 lds
    v_mfma_f32_16x16x32_bf16 v[120:123], a[68:71], a[20:23], v[120:123]
    v_mfma_f32_16x16x32_bf16 v[124:127], a[64:67], a[24:27], 0
    buffer_load_dwordx4 v177, s[4:7], s63 offen offset:1024 lds
    v_mfma_f32_16x16x32_bf16 v[124:127], a[68:71], a[28:31], v[124:127]
    s_waitcnt lgkmcnt(4)
    v_mfma_f32_16x16x32_bf16 v[128:131], a[72:75], a[0:3], 0
    ds_read_b64_tr_b16 a[88:89], v198 offset:2048
    v_mfma_f32_16x16x32_bf16 v[128:131], a[76:79], a[4:7], v[128:131]
    ds_read_b64_tr_b16 a[90:91], v198 offset:2304
    v_mfma_f32_16x16x32_bf16 v[132:135], a[72:75], a[8:11], 0
    ds_read_b64_tr_b16 a[92:93], v198 offset:8192
    v_mfma_f32_16x16x32_bf16 v[132:135], a[76:79], a[12:15], v[132:135]
    ds_read_b64_tr_b16 a[94:95], v198 offset:8448
    v_mfma_f32_16x16x32_bf16 v[136:139], a[72:75], a[16:19], 0
    buffer_load_dwordx4 v178, s[4:7], s63 offen offset:2048 lds
    v_mfma_f32_16x16x32_bf16 v[136:139], a[76:79], a[20:23], v[136:139]
    v_mfma_f32_16x16x32_bf16 v[140:143], a[72:75], a[24:27], 0
    buffer_load_dwordx4 v179, s[4:7], s63 offen offset:3072 lds
    v_mfma_f32_16x16x32_bf16 v[140:143], a[76:79], a[28:31], v[140:143]
    s_waitcnt lgkmcnt(4)
    v_mfma_f32_16x16x32_bf16 v[144:147], a[0:3], a[80:83], 0
    ds_read_b64_tr_b16 a[64:65], v197 offset:0
    v_mfma_f32_16x16x32_bf16 v[144:147], a[4:7], a[84:87], v[144:147]
    ds_read_b64_tr_b16 a[66:67], v197 offset:256
    v_mfma_f32_16x16x32_bf16 v[148:151], a[8:11], a[80:83], 0
    ds_read_b64_tr_b16 a[68:69], v197 offset:6144
    v_mfma_f32_16x16x32_bf16 v[148:151], a[12:15], a[84:87], v[148:151]
    ds_read_b64_tr_b16 a[70:71], v197 offset:6400
    s_add_u32 m0, m0, 4096
    v_mfma_f32_16x16x32_bf16 v[152:155], a[16:19], a[80:83], 0
    buffer_load_dwordx4 v180, s[4:7], s63 offen offset:0 lds
    v_mfma_f32_16x16x32_bf16 v[152:155], a[20:23], a[84:87], v[152:155]
    v_mfma_f32_16x16x32_bf16 v[156:159], a[24:27], a[80:83], 0
    buffer_load_dwordx4 v181, s[4:7], s63 offen offset:1024 lds
    v_mfma_f32_16x16x32_bf16 v[156:159], a[28:31], a[84:87], v[156:159]
    s_waitcnt lgkmcnt(4)
    v_mfma_f32_16x16x32_bf16 v[160:163], a[0:3], a[88:91], 0
    ds_read_b64_tr_b16 a[72:73], v198 offset:0
    v_mfma_f32_16x16x32_bf16 v[160:163], a[4:7], a[92:95], v[160:163]
    ds_read_b64_tr_b16 a[74:75], v198 offset:256
    v_mfma_f32_16x16x32_bf16 v[164:167], a[8:11], a[88:91], 0
    ds_read_b64_tr_b16 a[76:77], v198 offset:6144
    v_mfma_f32_16x16x32_bf16 v[164:167], a[12:15], a[92:95], v[164:167]
    ds_read_b64_tr_b16 a[78:79], v198 offset:6400
    v_mfma_f32_16x16x32_bf16 v[168:171], a[16:19], a[88:91], 0
    buffer_load_dwordx4 v182, s[4:7], s63 offen offset:2048 lds
    v_mfma_f32_16x16x32_bf16 v[168:171], a[20:23], a[92:95], v[168:171]
    v_mfma_f32_16x16x32_bf16 v[172:175], a[24:27], a[88:91], 0
    buffer_load_dwordx4 v183, s[4:7], s63 offen offset:3072 lds
    v_mfma_f32_16x16x32_bf16 v[172:175], a[28:31], a[92:95], v[172:175]
    s_waitcnt lgkmcnt(4)
    s_waitcnt vmcnt(8)
    s_barrier
    s_add_u32 s63, s63, 128
    v_mfma_f32_16x16x32_bf16 a[208:211], a[64:67], a[0:3], 0
    ds_read_b64_tr_b16 a[80:81], v196 offset:0
    v_mfma_f32_16x16x32_bf16 a[208:211], a[68:71], a[4:7], a[208:211]
    ds_read_b64_tr_b16 a[82:83], v196 offset:1792
    v_mfma_f32_16x16x32_bf16 a[212:215], a[64:67], a[8:11], 0
    ds_read_b64_tr_b16 a[84:85], v196 offset:7168
    v_mfma_f32_16x16x32_bf16 a[212:215], a[68:71], a[12:15], a[212:215]
    ds_read_b64_tr_b16 a[86:87], v196 offset:8960
    v_mfma_f32_16x16x32_bf16 a[216:219], a[64:67], a[16:19], 0
    s_add_u32 m0, s67, s69
    v_mfma_f32_16x16x32_bf16 a[216:219], a[68:71], a[20:23], a[216:219]
    buffer_load_dwordx4 v184, s[8:11], s64 offen offset:0 lds
    v_mfma_f32_16x16x32_bf16 a[220:223], a[64:67], a[24:27], 0
    v_mfma_f32_16x16x32_bf16 a[220:223], a[68:71], a[28:31], a[220:223]
    s_waitcnt lgkmcnt(4)
    v_mfma_f32_16x16x32_bf16 a[224:227], a[72:75], a[0:3], 0
    ds_read_b64_tr_b16 a[88:89], v196 offset:14336
    v_mfma_f32_16x16x32_bf16 a[224:227], a[76:79], a[4:7], a[224:227]
    ds_read_b64_tr_b16 a[90:91], v196 offset:16128
    v_mfma_f32_16x16x32_bf16 a[228:231], a[72:75], a[8:11], 0
    ds_read_b64_tr_b16 a[92:93], v196 offset:21504
    v_mfma_f32_16x16x32_bf16 a[228:231], a[76:79], a[12:15], a[228:231]
    ds_read_b64_tr_b16 a[94:95], v196 offset:23296
    v_mfma_f32_16x16x32_bf16 a[232:235], a[72:75], a[16:19], 0
    v_mfma_f32_16x16x32_bf16 a[232:235], a[76:79], a[20:23], a[232:235]
    buffer_load_dwordx4 v185, s[8:11], s64 offen offset:1024 lds
    v_mfma_f32_16x16x32_bf16 a[236:239], a[72:75], a[24:27], 0
    v_mfma_f32_16x16x32_bf16 a[236:239], a[76:79], a[28:31], a[236:239]
    s_waitcnt lgkmcnt(4)
    v_mfma_f32_16x16x32_bf16 v[0:3], a[80:83], a[0:3], 0
    ds_read_b64_tr_b16 a[64:65], v196 offset:32
    v_mfma_f32_16x16x32_bf16 v[0:3], a[84:87], a[4:7], v[0:3]
    ds_read_b64_tr_b16 a[66:67], v196 offset:1824
    v_mfma_f32_16x16x32_bf16 v[4:7], a[80:83], a[8:11], 0
    ds_read_b64_tr_b16 a[68:69], v196 offset:7200
    v_mfma_f32_16x16x32_bf16 v[4:7], a[84:87], a[12:15], v[4:7]
    ds_read_b64_tr_b16 a[70:71], v196 offset:8992
    v_mfma_f32_16x16x32_bf16 v[8:11], a[80:83], a[16:19], 0
    v_mfma_f32_16x16x32_bf16 v[8:11], a[84:87], a[20:23], v[8:11]
    buffer_load_dwordx4 v186, s[8:11], s64 offen offset:2048 lds
    v_mfma_f32_16x16x32_bf16 v[12:15], a[80:83], a[24:27], 0
    v_mfma_f32_16x16x32_bf16 v[12:15], a[84:87], a[28:31], v[12:15]
    s_waitcnt lgkmcnt(4)
    v_mfma_f32_16x16x32_bf16 a[96:99], a[88:91], a[0:3], 0
    ds_read_b64_tr_b16 a[72:73], v196 offset:14368
    v_mfma_f32_16x16x32_bf16 a[96:99], a[92:95], a[4:7], a[96:99]
    ds_read_b64_tr_b16 a[74:75], v196 offset:16160
    v_mfma_f32_16x16x32_bf16 a[100:103], a[88:91], a[8:11], 0
    ds_read_b64_tr_b16 a[76:77], v196 offset:21536
    v_mfma_f32_16x16x32_bf16 a[100:103], a[92:95], a[12:15], a[100:103]
    ds_read_b64_tr_b16 a[78:79], v196 offset:23328
    v_mfma_f32_16x16x32_bf16 a[104:107], a[88:91], a[16:19], 0
    v_mfma_f32_16x16x32_bf16 a[104:107], a[92:95], a[20:23], a[104:107]
    buffer_load_dwordx4 v187, s[8:11], s64 offen offset:3072 lds
    v_mfma_f32_16x16x32_bf16 a[108:111], a[88:91], a[24:27], 0
    v_mfma_f32_16x16x32_bf16 a[108:111], a[92:95], a[28:31], a[108:111]
    s_waitcnt lgkmcnt(4)
    v_mfma_f32_16x16x32_bf16 v[16:19], a[64:67], a[0:3], 0
    ds_read_b64_tr_b16 a[80:81], v196 offset:64
    v_mfma_f32_16x16x32_bf16 v[16:19], a[68:71], a[4:7], v[16:19]
    ds_read_b64_tr_b16 a[82:83], v196 offset:1856
    v_mfma_f32_16x16x32_bf16 v[20:23], a[64:67], a[8:11], 0
    ds_read_b64_tr_b16 a[84:85], v196 offset:7232
    s_waitcnt vmcnt(4)
    v_mfma_f32_16x16x32_bf16 v[20:23], a[68:71], a[12:15], v[20:23]
    ds_read_b64_tr_b16 a[86:87], v196 offset:9024
    s_cmp_ge_u32 s2, 248
    s_cbranch_scc1 p1_clear
p1_clear_ret:
    v_mfma_f32_16x16x32_bf16 v[24:27], a[64:67], a[16:19], 0
    ds_read_b128 a[32:35], v194 offset:0
    v_mfma_f32_16x16x32_bf16 v[24:27], a[68:71], a[20:23], v[24:27]
    ds_read_b128 a[36:39], v195 offset:0
    s_add_u32 m0, m0, 4096
    v_mfma_f32_16x16x32_bf16 v[28:31], a[64:67], a[24:27], 0
    buffer_load_dwordx4 v188, s[8:11], s64 offen offset:0 lds
    v_mfma_f32_16x16x32_bf16 v[28:31], a[68:71], a[28:31], v[28:31]
    s_waitcnt lgkmcnt(6)
    v_mfma_f32_16x16x32_bf16 a[112:115], a[72:75], a[0:3], 0
    ds_read_b64_tr_b16 a[88:89], v196 offset:14400
    v_mfma_f32_16x16x32_bf16 a[112:115], a[76:79], a[4:7], a[112:115]
    ds_read_b64_tr_b16 a[90:91], v196 offset:16192
    v_mfma_f32_16x16x32_bf16 a[116:119], a[72:75], a[8:11], 0
    ds_read_b64_tr_b16 a[92:93], v196 offset:21568
    v_mfma_f32_16x16x32_bf16 a[116:119], a[76:79], a[12:15], a[116:119]
    ds_read_b64_tr_b16 a[94:95], v196 offset:23360
    v_mfma_f32_16x16x32_bf16 a[120:123], a[72:75], a[16:19], 0
    ds_read_b128 a[40:43], v194 offset:2048
    v_mfma_f32_16x16x32_bf16 a[120:123], a[76:79], a[20:23], a[120:123]
    ds_read_b128 a[44:47], v195 offset:2048
    v_mfma_f32_16x16x32_bf16 a[124:127], a[72:75], a[24:27], 0
    buffer_load_dwordx4 v189, s[8:11], s64 offen offset:1024 lds
    v_mfma_f32_16x16x32_bf16 a[124:127], a[76:79], a[28:31], a[124:127]
    s_waitcnt lgkmcnt(6)
    v_mfma_f32_16x16x32_bf16 v[32:35], a[80:83], a[0:3], 0
    ds_read_b64_tr_b16 a[64:65], v196 offset:96
    v_mfma_f32_16x16x32_bf16 v[32:35], a[84:87], a[4:7], v[32:35]
    ds_read_b64_tr_b16 a[66:67], v196 offset:1888
    v_mfma_f32_16x16x32_bf16 v[36:39], a[80:83], a[8:11], 0
    ds_read_b64_tr_b16 a[68:69], v196 offset:7264
    v_mfma_f32_16x16x32_bf16 v[36:39], a[84:87], a[12:15], v[36:39]
    ds_read_b64_tr_b16 a[70:71], v196 offset:9056
    v_mfma_f32_16x16x32_bf16 v[40:43], a[80:83], a[16:19], 0
    ds_read_b128 a[48:51], v194 offset:4096
    v_mfma_f32_16x16x32_bf16 v[40:43], a[84:87], a[20:23], v[40:43]
    ds_read_b128 a[52:55], v195 offset:4096
    v_mfma_f32_16x16x32_bf16 v[44:47], a[80:83], a[24:27], 0
    buffer_load_dwordx4 v190, s[8:11], s64 offen offset:2048 lds
    v_mfma_f32_16x16x32_bf16 v[44:47], a[84:87], a[28:31], v[44:47]
    s_waitcnt lgkmcnt(6)
    v_mfma_f32_16x16x32_bf16 a[128:131], a[88:91], a[0:3], 0
    ds_read_b64_tr_b16 a[72:73], v196 offset:14432
    v_mfma_f32_16x16x32_bf16 a[128:131], a[92:95], a[4:7], a[128:131]
    ds_read_b64_tr_b16 a[74:75], v196 offset:16224
    v_mfma_f32_16x16x32_bf16 a[132:135], a[88:91], a[8:11], 0
    ds_read_b64_tr_b16 a[76:77], v196 offset:21600
    v_mfma_f32_16x16x32_bf16 a[132:135], a[92:95], a[12:15], a[132:135]
    ds_read_b64_tr_b16 a[78:79], v196 offset:23392
    v_mfma_f32_16x16x32_bf16 a[136:139], a[88:91], a[16:19], 0
    ds_read_b128 a[56:59], v194 offset:6144
    v_mfma_f32_16x16x32_bf16 a[136:139], a[92:95], a[20:23], a[136:139]
    ds_read_b128 a[60:63], v195 offset:6144
    s_add_u32 m0, s68, s69
    v_mfma_f32_16x16x32_bf16 a[140:143], a[88:91], a[24:27], 0
    buffer_load_dwordx4 v191, s[12:15], s65 offen offset:0 lds
    v_mfma_f32_16x16x32_bf16 a[140:143], a[92:95], a[28:31], a[140:143]
    s_waitcnt lgkmcnt(6)
    v_mfma_f32_16x16x32_bf16 v[48:51], a[64:67], a[0:3], 0
    ds_read_b64_tr_b16 a[80:81], v196 offset:128
    v_mfma_f32_16x16x32_bf16 v[48:51], a[68:71], a[4:7], v[48:51]
    ds_read_b64_tr_b16 a[82:83], v196 offset:1920
    v_mfma_f32_16x16x32_bf16 v[52:55], a[64:67], a[8:11], 0
    ds_read_b64_tr_b16 a[84:85], v196 offset:7296
    v_mfma_f32_16x16x32_bf16 v[52:55], a[68:71], a[12:15], v[52:55]
    ds_read_b64_tr_b16 a[86:87], v196 offset:9088
    v_mfma_f32_16x16x32_bf16 v[56:59], a[64:67], a[16:19], 0
    buffer_load_dwordx4 v192, s[12:15], s65 offen offset:1024 lds
    v_mfma_f32_16x16x32_bf16 v[56:59], a[68:71], a[20:23], v[56:59]
    v_mfma_f32_16x16x32_bf16 v[60:63], a[64:67], a[24:27], 0
    buffer_load_dwordx4 v193, s[12:15], s65 offen offset:2048 lds
    v_mfma_f32_16x16x32_bf16 v[60:63], a[68:71], a[28:31], v[60:63]
    s_waitcnt lgkmcnt(4)
    s_add_u32 s64, s64, 458752
    v_mfma_f32_16x16x32_bf16 a[144:147], a[72:75], a[0:3], 0
    ds_read_b64_tr_b16 a[88:89], v196 offset:14464
    s_add_u32 s65, s65, 393216
    v_mfma_f32_16x16x32_bf16 a[144:147], a[76:79], a[4:7], a[144:147]
    ds_read_b64_tr_b16 a[90:91], v196 offset:16256
    s_add_u32 s69, s69, 40960
    v_mfma_f32_16x16x32_bf16 a[148:151], a[72:75], a[8:11], 0
    ds_read_b64_tr_b16 a[92:93], v196 offset:21632
    s_cmp_eq_u32 s69, 122880
    v_mfma_f32_16x16x32_bf16 a[148:151], a[76:79], a[12:15], a[148:151]
    ds_read_b64_tr_b16 a[94:95], v196 offset:23424
    s_cselect_b32 s69, 0, s69
    s_mov_b32 m0, s66
    v_mfma_f32_16x16x32_bf16 a[152:155], a[72:75], a[16:19], 0
    buffer_load_dwordx4 v176, s[4:7], s63 offen offset:0 lds
    v_mfma_f32_16x16x32_bf16 a[152:155], a[76:79], a[20:23], a[152:155]
    v_mfma_f32_16x16x32_bf16 a[156:159], a[72:75], a[24:27], 0
    buffer_load_dwordx4 v177, s[4:7], s63 offen offset:1024 lds
    buffer_load_dword v248, v207, s[32:35], s76 offen
    v_mfma_f32_16x16x32_bf16 a[156:159], a[76:79], a[28:31], a[156:159]
    s_waitcnt lgkmcnt(4)
    s_add_u32 s76, s76, s77
    v_mfma_f32_16x16x32_bf16 v[64:67], a[80:83], a[0:3], 0
    ds_read_b64_tr_b16 a[64:65], v196 offset:160
    v_mfma_f32_16x16x32_bf16 v[64:67], a[84:87], a[4:7], v[64:67]
    ds_read_b64_tr_b16 a[66:67], v196 offset:1952
    v_mfma_f32_16x16x32_bf16 v[68:71], a[80:83], a[8:11], 0
    ds_read_b64_tr_b16 a[68:69], v196 offset:7328
    v_mfma_f32_16x16x32_bf16 v[68:71], a[84:87], a[12:15], v[68:71]
    ds_read_b64_tr_b16 a[70:71], v196 offset:9120
    v_mfma_f32_16x16x32_bf16 v[72:75], a[80:83], a[16:19], 0
    buffer_load_dwordx4 v178, s[4:7], s63 offen offset:2048 lds
    v_mfma_f32_16x16x32_bf16 v[72:75], a[84:87], a[20:23], v[72:75]
    v_mfma_f32_16x16x32_bf16 v[76:79], a[80:83], a[24:27], 0
    v_mfma_f32_16x16x32_bf16 v[76:79], a[84:87], a[28:31], v[76:79]
    s_waitcnt lgkmcnt(4)
    v_mfma_f32_16x16x32_bf16 a[160:163], a[88:91], a[0:3], 0
    ds_read_b64_tr_b16 a[72:73], v196 offset:14496
    v_mfma_f32_16x16x32_bf16 a[160:163], a[92:95], a[4:7], a[160:163]
    ds_read_b64_tr_b16 a[74:75], v196 offset:16288
    v_mfma_f32_16x16x32_bf16 a[164:167], a[88:91], a[8:11], 0
    ds_read_b64_tr_b16 a[76:77], v196 offset:21664
    v_mfma_f32_16x16x32_bf16 a[164:167], a[92:95], a[12:15], a[164:167]
    ds_read_b64_tr_b16 a[78:79], v196 offset:23456
    v_mfma_f32_16x16x32_bf16 a[168:171], a[88:91], a[16:19], 0
    buffer_load_dwordx4 v179, s[4:7], s63 offen offset:3072 lds
    v_mfma_f32_16x16x32_bf16 a[168:171], a[92:95], a[20:23], a[168:171]
    s_add_u32 m0, m0, 4096
    v_mfma_f32_16x16x32_bf16 a[172:175], a[88:91], a[24:27], 0
    buffer_load_dwordx4 v180, s[4:7], s63 offen offset:0 lds
    v_mfma_f32_16x16x32_bf16 a[172:175], a[92:95], a[28:31], a[172:175]
    s_waitcnt lgkmcnt(4)
    v_mfma_f32_16x16x32_bf16 v[80:83], a[64:67], a[0:3], 0
    ds_read_b64_tr_b16 a[80:81], v196 offset:192
    v_mfma_f32_16x16x32_bf16 v[80:83], a[68:71], a[4:7], v[80:83]
    ds_read_b64_tr_b16 a[82:83], v196 offset:1984
    v_mfma_f32_16x16x32_bf16 v[84:87], a[64:67], a[8:11], 0
    ds_read_b64_tr_b16 a[84:85], v196 offset:7360
    buffer_load_dword v248, v207, s[32:35], s76 offen
    v_mfma_f32_16x16x32_bf16 v[84:87], a[68:71], a[12:15], v[84:87]
    ds_read_b64_tr_b16 a[86:87], v196 offset:9152
    s_add_u32 s76, s76, s77
    v_mfma_f32_16x16x32_bf16 v[88:91], a[64:67], a[16:19], 0
    s_add_u32 s70, s70, 40960
    buffer_load_dwordx4 v181, s[4:7], s63 offen offset:1024 lds
    v_mfma_f32_16x16x32_bf16 v[88:91], a[68:71], a[20:23], v[88:91]
    s_cmp_eq_u32 s70, 122880
    v_mfma_f32_16x16x32_bf16 v[92:95], a[64:67], a[24:27], 0
    s_cselect_b32 s70, 0, s70
    v_mfma_f32_16x16x32_bf16 v[92:95], a[68:71], a[28:31], v[92:95]
    s_waitcnt lgkmcnt(4)
    v_mfma_f32_16x16x32_bf16 a[176:179], a[72:75], a[0:3], 0
    ds_read_b64_tr_b16 a[88:89], v196 offset:14528
    v_mfma_f32_16x16x32_bf16 a[176:179], a[76:79], a[4:7], a[176:179]
    ds_read_b64_tr_b16 a[90:91], v196 offset:16320
    v_mfma_f32_16x16x32_bf16 a[180:183], a[72:75], a[8:11], 0
    ds_read_b64_tr_b16 a[92:93], v196 offset:21696
    v_mfma_f32_16x16x32_bf16 a[180:183], a[76:79], a[12:15], a[180:183]
    ds_read_b64_tr_b16 a[94:95], v196 offset:23488
    v_mfma_f32_16x16x32_bf16 a[184:187], a[72:75], a[16:19], 0
    buffer_load_dwordx4 v182, s[4:7], s63 offen offset:2048 lds
    v_add_u32 v196, s70, v199
    v_mfma_f32_16x16x32_bf16 a[184:187], a[76:79], a[20:23], a[184:187]
    v_add_u32 v197, s70, v200
    v_mfma_f32_16x16x32_bf16 a[188:191], a[72:75], a[24:27], 0
    v_add_u32 v198, s70, v201
    v_mfma_f32_16x16x32_bf16 a[188:191], a[76:79], a[28:31], a[188:191]
    s_waitcnt lgkmcnt(0)
    v_mfma_f32_16x16x32_bf16 v[96:99], a[80:83], a[0:3], 0
    s_waitcnt vmcnt(9)
    s_barrier
    v_mfma_f32_16x16x32_bf16 v[96:99], a[84:87], a[4:7], v[96:99]
    ds_read_b64_tr_b16 a[64:65], v197 offset:1024
    v_mfma_f32_16x16x32_bf16 v[100:103], a[80:83], a[8:11], 0
    ds_read_b64_tr_b16 a[66:67], v197 offset:1280
    s_cmp_ge_u32 s2, 248
    s_cbranch_scc1 p1_init
p1_init_ret:
    v_mfma_f32_16x16x32_bf16 v[100:103], a[84:87], a[12:15], v[100:103]
    ds_read_b64_tr_b16 a[68:69], v197 offset:7168
    v_mfma_f32_16x16x32_bf16 v[104:107], a[80:83], a[16:19], 0
    ds_read_b64_tr_b16 a[70:71], v197 offset:7424
    v_mfma_f32_16x16x32_bf16 v[104:107], a[84:87], a[20:23], v[104:107]
    v_mfma_f32_16x16x32_bf16 v[108:111], a[80:83], a[24:27], 0
    buffer_load_dwordx4 v183, s[4:7], s63 offen offset:3072 lds
    v_mfma_f32_16x16x32_bf16 v[108:111], a[84:87], a[28:31], v[108:111]
    s_waitcnt lgkmcnt(4)
    s_add_u32 s63, s63, 128
    v_mfma_f32_16x16x32_bf16 a[192:195], a[88:91], a[0:3], 0
    ds_read_b64_tr_b16 a[72:73], v198 offset:1024
    v_mfma_f32_16x16x32_bf16 a[192:195], a[92:95], a[4:7], a[192:195]
    ds_read_b64_tr_b16 a[74:75], v198 offset:1280
    v_mfma_f32_16x16x32_bf16 a[196:199], a[88:91], a[8:11], 0
    ds_read_b64_tr_b16 a[76:77], v198 offset:7168
    v_mfma_f32_16x16x32_bf16 a[196:199], a[92:95], a[12:15], a[196:199]
    ds_read_b64_tr_b16 a[78:79], v198 offset:7424
    v_mfma_f32_16x16x32_bf16 a[200:203], a[88:91], a[16:19], 0
    buffer_load_dword v248, v207, s[32:35], s76 offen
    v_mfma_f32_16x16x32_bf16 a[200:203], a[92:95], a[20:23], a[200:203]
    s_add_u32 s76, s76, s77
    v_mfma_f32_16x16x32_bf16 a[204:207], a[88:91], a[24:27], 0
    v_mfma_f32_16x16x32_bf16 a[204:207], a[92:95], a[28:31], a[204:207]
    s_waitcnt lgkmcnt(4)
.p2align 6
p1_loop:
    v_mfma_f32_16x16x32_bf16 v[112:115], a[64:67], a[32:35], v[112:115]
    ds_read_b64_tr_b16 a[80:81], v197 offset:2048
    v_mfma_f32_16x16x32_bf16 v[112:115], a[68:71], a[36:39], v[112:115]
    ds_read_b64_tr_b16 a[82:83], v197 offset:2304
    v_mfma_f32_16x16x32_bf16 v[116:119], a[64:67], a[40:43], v[116:119]
    ds_read_b64_tr_b16 a[84:85], v197 offset:8192
    v_mfma_f32_16x16x32_bf16 v[116:119], a[68:71], a[44:47], v[116:119]
    ds_read_b64_tr_b16 a[86:87], v197 offset:8448
    v_mfma_f32_16x16x32_bf16 v[120:123], a[64:67], a[48:51], v[120:123]
    s_add_u32 m0, s67, s69
    v_mfma_f32_16x16x32_bf16 v[120:123], a[68:71], a[52:55], v[120:123]
    buffer_load_dwordx4 v184, s[8:11], s64 offen offset:0 lds
    v_mfma_f32_16x16x32_bf16 v[124:127], a[64:67], a[56:59], v[124:127]
    v_mfma_f32_16x16x32_bf16 v[124:127], a[68:71], a[60:63], v[124:127]
    s_waitcnt lgkmcnt(4)
    v_mfma_f32_16x16x32_bf16 v[128:131], a[72:75], a[32:35], v[128:131]
    ds_read_b64_tr_b16 a[88:89], v198 offset:2048
    v_mfma_f32_16x16x32_bf16 v[128:131], a[76:79], a[36:39], v[128:131]
    ds_read_b64_tr_b16 a[90:91], v198 offset:2304
    v_mfma_f32_16x16x32_bf16 v[132:135], a[72:75], a[40:43], v[132:135]
    ds_read_b64_tr_b16 a[92:93], v198 offset:8192
    v_mfma_f32_16x16x32_bf16 v[132:135], a[76:79], a[44:47], v[132:135]
    ds_read_b64_tr_b16 a[94:95], v198 offset:8448
    v_mfma_f32_16x16x32_bf16 v[136:139], a[72:75], a[48:51], v[136:139]
    v_mfma_f32_16x16x32_bf16 v[136:139], a[76:79], a[52:55], v[136:139]
    v_mfma_f32_16x16x32_bf16 v[140:143], a[72:75], a[56:59], v[140:143]
    buffer_load_dwordx4 v185, s[8:11], s64 offen offset:1024 lds
    v_mfma_f32_16x16x32_bf16 v[140:143], a[76:79], a[60:63], v[140:143]
    s_waitcnt lgkmcnt(4)
    v_mfma_f32_16x16x32_bf16 v[144:147], a[32:35], a[80:83], v[144:147]
    ds_read_b64_tr_b16 a[64:65], v197 offset:0
    v_mfma_f32_16x16x32_bf16 v[144:147], a[36:39], a[84:87], v[144:147]
    ds_read_b64_tr_b16 a[66:67], v197 offset:256
    v_mfma_f32_16x16x32_bf16 v[148:151], a[40:43], a[80:83], v[148:151]
    ds_read_b64_tr_b16 a[68:69], v197 offset:6144
    v_mfma_f32_16x16x32_bf16 v[148:151], a[44:47], a[84:87], v[148:151]
    ds_read_b64_tr_b16 a[70:71], v197 offset:6400
    v_mfma_f32_16x16x32_bf16 v[152:155], a[48:51], a[80:83], v[152:155]
    v_mfma_f32_16x16x32_bf16 v[152:155], a[52:55], a[84:87], v[152:155]
    v_mfma_f32_16x16x32_bf16 v[156:159], a[56:59], a[80:83], v[156:159]
    buffer_load_dwordx4 v186, s[8:11], s64 offen offset:2048 lds
    v_mfma_f32_16x16x32_bf16 v[156:159], a[60:63], a[84:87], v[156:159]
    s_waitcnt lgkmcnt(4)
    v_mfma_f32_16x16x32_bf16 v[160:163], a[32:35], a[88:91], v[160:163]
    ds_read_b64_tr_b16 a[72:73], v198 offset:0
    v_mfma_f32_16x16x32_bf16 v[160:163], a[36:39], a[92:95], v[160:163]
    ds_read_b64_tr_b16 a[74:75], v198 offset:256
    v_mfma_f32_16x16x32_bf16 v[164:167], a[40:43], a[88:91], v[164:167]
    ds_read_b64_tr_b16 a[76:77], v198 offset:6144
    v_mfma_f32_16x16x32_bf16 v[164:167], a[44:47], a[92:95], v[164:167]
    ds_read_b64_tr_b16 a[78:79], v198 offset:6400
    v_mfma_f32_16x16x32_bf16 v[168:171], a[48:51], a[88:91], v[168:171]
    v_mfma_f32_16x16x32_bf16 v[168:171], a[52:55], a[92:95], v[168:171]
    v_mfma_f32_16x16x32_bf16 v[172:175], a[56:59], a[88:91], v[172:175]
    v_mfma_f32_16x16x32_bf16 v[172:175], a[60:63], a[92:95], v[172:175]
    s_waitcnt lgkmcnt(4)
    v_mfma_f32_16x16x32_bf16 a[208:211], a[64:67], a[32:35], a[208:211]
    ds_read_b64_tr_b16 a[80:81], v196 offset:0
    v_mfma_f32_16x16x32_bf16 a[208:211], a[68:71], a[36:39], a[208:211]
    ds_read_b64_tr_b16 a[82:83], v196 offset:1792
    v_mfma_f32_16x16x32_bf16 a[212:215], a[64:67], a[40:43], a[212:215]
    ds_read_b64_tr_b16 a[84:85], v196 offset:7168
    v_mfma_f32_16x16x32_bf16 a[212:215], a[68:71], a[44:47], a[212:215]
    ds_read_b64_tr_b16 a[86:87], v196 offset:8960
    v_mfma_f32_16x16x32_bf16 a[216:219], a[64:67], a[48:51], a[216:219]
    v_mfma_f32_16x16x32_bf16 a[216:219], a[68:71], a[52:55], a[216:219]
    buffer_load_dwordx4 v187, s[8:11], s64 offen offset:3072 lds
    v_mfma_f32_16x16x32_bf16 a[220:223], a[64:67], a[56:59], a[220:223]
    v_mfma_f32_16x16x32_bf16 a[220:223], a[68:71], a[60:63], a[220:223]
    s_waitcnt lgkmcnt(4)
    v_mfma_f32_16x16x32_bf16 a[224:227], a[72:75], a[32:35], a[224:227]
    ds_read_b64_tr_b16 a[88:89], v196 offset:14336
    v_mfma_f32_16x16x32_bf16 a[224:227], a[76:79], a[36:39], a[224:227]
    ds_read_b64_tr_b16 a[90:91], v196 offset:16128
    v_mfma_f32_16x16x32_bf16 a[228:231], a[72:75], a[40:43], a[228:231]
    ds_read_b64_tr_b16 a[92:93], v196 offset:21504
    v_mfma_f32_16x16x32_bf16 a[228:231], a[76:79], a[44:47], a[228:231]
    ds_read_b64_tr_b16 a[94:95], v196 offset:23296
    v_mfma_f32_16x16x32_bf16 a[232:235], a[72:75], a[48:51], a[232:235]
    v_mfma_f32_16x16x32_bf16 a[232:235], a[76:79], a[52:55], a[232:235]
    s_add_u32 m0, m0, 4096
    v_mfma_f32_16x16x32_bf16 a[236:239], a[72:75], a[56:59], a[236:239]
    buffer_load_dwordx4 v188, s[8:11], s64 offen offset:0 lds
    v_mfma_f32_16x16x32_bf16 a[236:239], a[76:79], a[60:63], a[236:239]
    s_waitcnt lgkmcnt(4)
    v_mfma_f32_16x16x32_bf16 v[0:3], a[80:83], a[32:35], v[0:3]
    ds_read_b64_tr_b16 a[64:65], v196 offset:32
    v_mfma_f32_16x16x32_bf16 v[0:3], a[84:87], a[36:39], v[0:3]
    ds_read_b64_tr_b16 a[66:67], v196 offset:1824
    v_mfma_f32_16x16x32_bf16 v[4:7], a[80:83], a[40:43], v[4:7]
    ds_read_b64_tr_b16 a[68:69], v196 offset:7200
    v_mfma_f32_16x16x32_bf16 v[4:7], a[84:87], a[44:47], v[4:7]
    ds_read_b64_tr_b16 a[70:71], v196 offset:8992
    v_mfma_f32_16x16x32_bf16 v[8:11], a[80:83], a[48:51], v[8:11]
    v_mfma_f32_16x16x32_bf16 v[8:11], a[84:87], a[52:55], v[8:11]
    v_mfma_f32_16x16x32_bf16 v[12:15], a[80:83], a[56:59], v[12:15]
    buffer_load_dwordx4 v189, s[8:11], s64 offen offset:1024 lds
    v_mfma_f32_16x16x32_bf16 v[12:15], a[84:87], a[60:63], v[12:15]
    s_waitcnt lgkmcnt(4)
    v_mfma_f32_16x16x32_bf16 a[96:99], a[88:91], a[32:35], a[96:99]
    ds_read_b64_tr_b16 a[72:73], v196 offset:14368
    v_mfma_f32_16x16x32_bf16 a[96:99], a[92:95], a[36:39], a[96:99]
    ds_read_b64_tr_b16 a[74:75], v196 offset:16160
    v_mfma_f32_16x16x32_bf16 a[100:103], a[88:91], a[40:43], a[100:103]
    ds_read_b64_tr_b16 a[76:77], v196 offset:21536
    v_mfma_f32_16x16x32_bf16 a[100:103], a[92:95], a[44:47], a[100:103]
    ds_read_b64_tr_b16 a[78:79], v196 offset:23328
    v_mfma_f32_16x16x32_bf16 a[104:107], a[88:91], a[48:51], a[104:107]
    v_mfma_f32_16x16x32_bf16 a[104:107], a[92:95], a[52:55], a[104:107]
    v_mfma_f32_16x16x32_bf16 a[108:111], a[88:91], a[56:59], a[108:111]
    buffer_load_dwordx4 v190, s[8:11], s64 offen offset:2048 lds
    v_mfma_f32_16x16x32_bf16 a[108:111], a[92:95], a[60:63], a[108:111]
    s_waitcnt lgkmcnt(4)
    v_mfma_f32_16x16x32_bf16 v[16:19], a[64:67], a[32:35], v[16:19]
    ds_read_b64_tr_b16 a[80:81], v196 offset:64
    v_mfma_f32_16x16x32_bf16 v[16:19], a[68:71], a[36:39], v[16:19]
    ds_read_b64_tr_b16 a[82:83], v196 offset:1856
    v_mfma_f32_16x16x32_bf16 v[20:23], a[64:67], a[40:43], v[20:23]
    ds_read_b64_tr_b16 a[84:85], v196 offset:7232
    s_waitcnt vmcnt(8)
    v_mfma_f32_16x16x32_bf16 v[20:23], a[68:71], a[44:47], v[20:23]
    ds_read_b64_tr_b16 a[86:87], v196 offset:9024
    v_mfma_f32_16x16x32_bf16 v[24:27], a[64:67], a[48:51], v[24:27]
    ds_read_b128 a[0:3], v194 offset:0
    v_mfma_f32_16x16x32_bf16 v[24:27], a[68:71], a[52:55], v[24:27]
    ds_read_b128 a[4:7], v195 offset:0
    v_mfma_f32_16x16x32_bf16 v[28:31], a[64:67], a[56:59], v[28:31]
    v_mfma_f32_16x16x32_bf16 v[28:31], a[68:71], a[60:63], v[28:31]
    s_waitcnt lgkmcnt(6)
    v_mfma_f32_16x16x32_bf16 a[112:115], a[72:75], a[32:35], a[112:115]
    ds_read_b64_tr_b16 a[88:89], v196 offset:14400
    v_mfma_f32_16x16x32_bf16 a[112:115], a[76:79], a[36:39], a[112:115]
    ds_read_b64_tr_b16 a[90:91], v196 offset:16192
    v_mfma_f32_16x16x32_bf16 a[116:119], a[72:75], a[40:43], a[116:119]
    ds_read_b64_tr_b16 a[92:93], v196 offset:21568
    v_mfma_f32_16x16x32_bf16 a[116:119], a[76:79], a[44:47], a[116:119]
    ds_read_b64_tr_b16 a[94:95], v196 offset:23360
    v_mfma_f32_16x16x32_bf16 a[120:123], a[72:75], a[48:51], a[120:123]
    ds_read_b128 a[8:11], v194 offset:2048
    v_mfma_f32_16x16x32_bf16 a[120:123], a[76:79], a[52:55], a[120:123]
    ds_read_b128 a[12:15], v195 offset:2048
    s_add_u32 m0, s68, s69
    v_mfma_f32_16x16x32_bf16 a[124:127], a[72:75], a[56:59], a[124:127]
    buffer_load_dwordx4 v191, s[12:15], s65 offen offset:0 lds
    v_mfma_f32_16x16x32_bf16 a[124:127], a[76:79], a[60:63], a[124:127]
    s_waitcnt lgkmcnt(6)
    v_mfma_f32_16x16x32_bf16 v[32:35], a[80:83], a[32:35], v[32:35]
    ds_read_b64_tr_b16 a[64:65], v196 offset:96
    v_mfma_f32_16x16x32_bf16 v[32:35], a[84:87], a[36:39], v[32:35]
    ds_read_b64_tr_b16 a[66:67], v196 offset:1888
    v_mfma_f32_16x16x32_bf16 v[36:39], a[80:83], a[40:43], v[36:39]
    ds_read_b64_tr_b16 a[68:69], v196 offset:7264
    v_mfma_f32_16x16x32_bf16 v[36:39], a[84:87], a[44:47], v[36:39]
    ds_read_b64_tr_b16 a[70:71], v196 offset:9056
    v_mfma_f32_16x16x32_bf16 v[40:43], a[80:83], a[48:51], v[40:43]
    ds_read_b128 a[16:19], v194 offset:4096
    v_mfma_f32_16x16x32_bf16 v[40:43], a[84:87], a[52:55], v[40:43]
    ds_read_b128 a[20:23], v195 offset:4096
    v_mfma_f32_16x16x32_bf16 v[44:47], a[80:83], a[56:59], v[44:47]
    buffer_load_dwordx4 v192, s[12:15], s65 offen offset:1024 lds
    v_mfma_f32_16x16x32_bf16 v[44:47], a[84:87], a[60:63], v[44:47]
    s_waitcnt lgkmcnt(6)
    v_mfma_f32_16x16x32_bf16 a[128:131], a[88:91], a[32:35], a[128:131]
    ds_read_b64_tr_b16 a[72:73], v196 offset:14432
    v_mfma_f32_16x16x32_bf16 a[128:131], a[92:95], a[36:39], a[128:131]
    ds_read_b64_tr_b16 a[74:75], v196 offset:16224
    v_mfma_f32_16x16x32_bf16 a[132:135], a[88:91], a[40:43], a[132:135]
    ds_read_b64_tr_b16 a[76:77], v196 offset:21600
    v_mfma_f32_16x16x32_bf16 a[132:135], a[92:95], a[44:47], a[132:135]
    ds_read_b64_tr_b16 a[78:79], v196 offset:23392
    v_mfma_f32_16x16x32_bf16 a[136:139], a[88:91], a[48:51], a[136:139]
    ds_read_b128 a[24:27], v194 offset:6144
    v_mfma_f32_16x16x32_bf16 a[136:139], a[92:95], a[52:55], a[136:139]
    ds_read_b128 a[28:31], v195 offset:6144
    v_mfma_f32_16x16x32_bf16 a[140:143], a[88:91], a[56:59], a[140:143]
    buffer_load_dwordx4 v193, s[12:15], s65 offen offset:2048 lds
    v_mfma_f32_16x16x32_bf16 a[140:143], a[92:95], a[60:63], a[140:143]
    s_waitcnt lgkmcnt(6)
    s_add_u32 s64, s64, 458752
    v_mfma_f32_16x16x32_bf16 v[48:51], a[64:67], a[32:35], v[48:51]
    ds_read_b64_tr_b16 a[80:81], v196 offset:128
    s_add_u32 s65, s65, 393216
    v_mfma_f32_16x16x32_bf16 v[48:51], a[68:71], a[36:39], v[48:51]
    ds_read_b64_tr_b16 a[82:83], v196 offset:1920
    s_add_u32 s69, s69, 40960
    v_mfma_f32_16x16x32_bf16 v[52:55], a[64:67], a[40:43], v[52:55]
    ds_read_b64_tr_b16 a[84:85], v196 offset:7296
    s_cmp_eq_u32 s69, 122880
    v_mfma_f32_16x16x32_bf16 v[52:55], a[68:71], a[44:47], v[52:55]
    ds_read_b64_tr_b16 a[86:87], v196 offset:9088
    s_cselect_b32 s69, 0, s69
    v_mfma_f32_16x16x32_bf16 v[56:59], a[64:67], a[48:51], v[56:59]
    v_mfma_f32_16x16x32_bf16 v[56:59], a[68:71], a[52:55], v[56:59]
    v_mfma_f32_16x16x32_bf16 v[60:63], a[64:67], a[56:59], v[60:63]
    v_mfma_f32_16x16x32_bf16 v[60:63], a[68:71], a[60:63], v[60:63]
    s_waitcnt lgkmcnt(4)
    v_mfma_f32_16x16x32_bf16 a[144:147], a[72:75], a[32:35], a[144:147]
    ds_read_b64_tr_b16 a[88:89], v196 offset:14464
    v_mfma_f32_16x16x32_bf16 a[144:147], a[76:79], a[36:39], a[144:147]
    ds_read_b64_tr_b16 a[90:91], v196 offset:16256
    v_mfma_f32_16x16x32_bf16 a[148:151], a[72:75], a[40:43], a[148:151]
    ds_read_b64_tr_b16 a[92:93], v196 offset:21632
    v_mfma_f32_16x16x32_bf16 a[148:151], a[76:79], a[44:47], a[148:151]
    ds_read_b64_tr_b16 a[94:95], v196 offset:23424
    s_mov_b32 m0, s66
    v_mfma_f32_16x16x32_bf16 a[152:155], a[72:75], a[48:51], a[152:155]
    buffer_load_dwordx4 v176, s[4:7], s63 offen offset:0 lds
    v_mfma_f32_16x16x32_bf16 a[152:155], a[76:79], a[52:55], a[152:155]
    v_mfma_f32_16x16x32_bf16 a[156:159], a[72:75], a[56:59], a[156:159]
    buffer_load_dwordx4 v177, s[4:7], s63 offen offset:1024 lds
    v_mfma_f32_16x16x32_bf16 a[156:159], a[76:79], a[60:63], a[156:159]
    s_waitcnt lgkmcnt(4)
    v_mfma_f32_16x16x32_bf16 v[64:67], a[80:83], a[32:35], v[64:67]
    ds_read_b64_tr_b16 a[64:65], v196 offset:160
    v_mfma_f32_16x16x32_bf16 v[64:67], a[84:87], a[36:39], v[64:67]
    ds_read_b64_tr_b16 a[66:67], v196 offset:1952
    v_mfma_f32_16x16x32_bf16 v[68:71], a[80:83], a[40:43], v[68:71]
    ds_read_b64_tr_b16 a[68:69], v196 offset:7328
    v_mfma_f32_16x16x32_bf16 v[68:71], a[84:87], a[44:47], v[68:71]
    ds_read_b64_tr_b16 a[70:71], v196 offset:9120
    v_mfma_f32_16x16x32_bf16 v[72:75], a[80:83], a[48:51], v[72:75]
    buffer_load_dwordx4 v178, s[4:7], s63 offen offset:2048 lds
    v_mfma_f32_16x16x32_bf16 v[72:75], a[84:87], a[52:55], v[72:75]
    v_mfma_f32_16x16x32_bf16 v[76:79], a[80:83], a[56:59], v[76:79]
    v_mfma_f32_16x16x32_bf16 v[76:79], a[84:87], a[60:63], v[76:79]
    s_waitcnt lgkmcnt(4)
    v_mfma_f32_16x16x32_bf16 a[160:163], a[88:91], a[32:35], a[160:163]
    ds_read_b64_tr_b16 a[72:73], v196 offset:14496
    v_mfma_f32_16x16x32_bf16 a[160:163], a[92:95], a[36:39], a[160:163]
    ds_read_b64_tr_b16 a[74:75], v196 offset:16288
    v_mfma_f32_16x16x32_bf16 a[164:167], a[88:91], a[40:43], a[164:167]
    ds_read_b64_tr_b16 a[76:77], v196 offset:21664
    v_mfma_f32_16x16x32_bf16 a[164:167], a[92:95], a[44:47], a[164:167]
    ds_read_b64_tr_b16 a[78:79], v196 offset:23456
    v_mfma_f32_16x16x32_bf16 a[168:171], a[88:91], a[48:51], a[168:171]
    buffer_load_dwordx4 v179, s[4:7], s63 offen offset:3072 lds
    v_mfma_f32_16x16x32_bf16 a[168:171], a[92:95], a[52:55], a[168:171]
    s_add_u32 m0, m0, 4096
    v_mfma_f32_16x16x32_bf16 a[172:175], a[88:91], a[56:59], a[172:175]
    buffer_load_dwordx4 v180, s[4:7], s63 offen offset:0 lds
    v_mfma_f32_16x16x32_bf16 a[172:175], a[92:95], a[60:63], a[172:175]
    s_waitcnt lgkmcnt(4)
    v_mfma_f32_16x16x32_bf16 v[80:83], a[64:67], a[32:35], v[80:83]
    ds_read_b64_tr_b16 a[80:81], v196 offset:192
    v_mfma_f32_16x16x32_bf16 v[80:83], a[68:71], a[36:39], v[80:83]
    ds_read_b64_tr_b16 a[82:83], v196 offset:1984
    v_mfma_f32_16x16x32_bf16 v[84:87], a[64:67], a[40:43], v[84:87]
    ds_read_b64_tr_b16 a[84:85], v196 offset:7360
    v_mfma_f32_16x16x32_bf16 v[84:87], a[68:71], a[44:47], v[84:87]
    ds_read_b64_tr_b16 a[86:87], v196 offset:9152
    v_mfma_f32_16x16x32_bf16 v[88:91], a[64:67], a[48:51], v[88:91]
    s_add_u32 s70, s70, 40960
    buffer_load_dwordx4 v181, s[4:7], s63 offen offset:1024 lds
    v_mfma_f32_16x16x32_bf16 v[88:91], a[68:71], a[52:55], v[88:91]
    s_cmp_eq_u32 s70, 122880
    v_mfma_f32_16x16x32_bf16 v[92:95], a[64:67], a[56:59], v[92:95]
    s_cselect_b32 s70, 0, s70
    v_mfma_f32_16x16x32_bf16 v[92:95], a[68:71], a[60:63], v[92:95]
    s_waitcnt lgkmcnt(4)
    v_mfma_f32_16x16x32_bf16 a[176:179], a[72:75], a[32:35], a[176:179]
    ds_read_b64_tr_b16 a[88:89], v196 offset:14528
    v_mfma_f32_16x16x32_bf16 a[176:179], a[76:79], a[36:39], a[176:179]
    ds_read_b64_tr_b16 a[90:91], v196 offset:16320
    v_mfma_f32_16x16x32_bf16 a[180:183], a[72:75], a[40:43], a[180:183]
    ds_read_b64_tr_b16 a[92:93], v196 offset:21696
    v_mfma_f32_16x16x32_bf16 a[180:183], a[76:79], a[44:47], a[180:183]
    ds_read_b64_tr_b16 a[94:95], v196 offset:23488
    v_mfma_f32_16x16x32_bf16 a[184:187], a[72:75], a[48:51], a[184:187]
    buffer_load_dwordx4 v182, s[4:7], s63 offen offset:2048 lds
    v_add_u32 v196, s70, v199
    v_mfma_f32_16x16x32_bf16 a[184:187], a[76:79], a[52:55], a[184:187]
    v_add_u32 v197, s70, v200
    v_mfma_f32_16x16x32_bf16 a[188:191], a[72:75], a[56:59], a[188:191]
    v_add_u32 v198, s70, v201
    v_mfma_f32_16x16x32_bf16 a[188:191], a[76:79], a[60:63], a[188:191]
    s_waitcnt lgkmcnt(0)
    v_mfma_f32_16x16x32_bf16 v[96:99], a[80:83], a[32:35], v[96:99]
    s_waitcnt vmcnt(7)
    s_barrier
    v_mfma_f32_16x16x32_bf16 v[96:99], a[84:87], a[36:39], v[96:99]
    ds_read_b64_tr_b16 a[64:65], v197 offset:1024
    v_mfma_f32_16x16x32_bf16 v[100:103], a[80:83], a[40:43], v[100:103]
    ds_read_b64_tr_b16 a[66:67], v197 offset:1280
    v_mfma_f32_16x16x32_bf16 v[100:103], a[84:87], a[44:47], v[100:103]
    ds_read_b64_tr_b16 a[68:69], v197 offset:7168
    v_mfma_f32_16x16x32_bf16 v[104:107], a[80:83], a[48:51], v[104:107]
    ds_read_b64_tr_b16 a[70:71], v197 offset:7424
    v_mfma_f32_16x16x32_bf16 v[104:107], a[84:87], a[52:55], v[104:107]
    v_mfma_f32_16x16x32_bf16 v[108:111], a[80:83], a[56:59], v[108:111]
    buffer_load_dwordx4 v183, s[4:7], s63 offen offset:3072 lds
    v_mfma_f32_16x16x32_bf16 v[108:111], a[84:87], a[60:63], v[108:111]
    s_waitcnt lgkmcnt(4)
    s_add_u32 s63, s63, 128
    v_mfma_f32_16x16x32_bf16 a[192:195], a[88:91], a[32:35], a[192:195]
    ds_read_b64_tr_b16 a[72:73], v198 offset:1024
    v_mfma_f32_16x16x32_bf16 a[192:195], a[92:95], a[36:39], a[192:195]
    ds_read_b64_tr_b16 a[74:75], v198 offset:1280
    v_mfma_f32_16x16x32_bf16 a[196:199], a[88:91], a[40:43], a[196:199]
    ds_read_b64_tr_b16 a[76:77], v198 offset:7168
    v_mfma_f32_16x16x32_bf16 a[196:199], a[92:95], a[44:47], a[196:199]
    ds_read_b64_tr_b16 a[78:79], v198 offset:7424
    v_mfma_f32_16x16x32_bf16 a[200:203], a[88:91], a[48:51], a[200:203]
    buffer_load_dword v248, v207, s[32:35], s76 offen
    v_mfma_f32_16x16x32_bf16 a[200:203], a[92:95], a[52:55], a[200:203]
    s_add_u32 s76, s76, s77
    v_mfma_f32_16x16x32_bf16 a[204:207], a[88:91], a[56:59], a[204:207]
    v_mfma_f32_16x16x32_bf16 a[204:207], a[92:95], a[60:63], a[204:207]
    s_waitcnt lgkmcnt(4)
    v_mfma_f32_16x16x32_bf16 v[112:115], a[64:67], a[0:3], v[112:115]
    ds_read_b64_tr_b16 a[80:81], v197 offset:2048
    v_mfma_f32_16x16x32_bf16 v[112:115], a[68:71], a[4:7], v[112:115]
    ds_read_b64_tr_b16 a[82:83], v197 offset:2304
    v_mfma_f32_16x16x32_bf16 v[116:119], a[64:67], a[8:11], v[116:119]
    ds_read_b64_tr_b16 a[84:85], v197 offset:8192
    v_mfma_f32_16x16x32_bf16 v[116:119], a[68:71], a[12:15], v[116:119]
    ds_read_b64_tr_b16 a[86:87], v197 offset:8448
    v_mfma_f32_16x16x32_bf16 v[120:123], a[64:67], a[16:19], v[120:123]
    s_add_u32 m0, s67, s69
    v_mfma_f32_16x16x32_bf16 v[120:123], a[68:71], a[20:23], v[120:123]
    buffer_load_dwordx4 v184, s[8:11], s64 offen offset:0 lds
    v_mfma_f32_16x16x32_bf16 v[124:127], a[64:67], a[24:27], v[124:127]
    v_mfma_f32_16x16x32_bf16 v[124:127], a[68:71], a[28:31], v[124:127]
    s_waitcnt lgkmcnt(4)
    v_mfma_f32_16x16x32_bf16 v[128:131], a[72:75], a[0:3], v[128:131]
    ds_read_b64_tr_b16 a[88:89], v198 offset:2048
    v_mfma_f32_16x16x32_bf16 v[128:131], a[76:79], a[4:7], v[128:131]
    ds_read_b64_tr_b16 a[90:91], v198 offset:2304
    v_mfma_f32_16x16x32_bf16 v[132:135], a[72:75], a[8:11], v[132:135]
    ds_read_b64_tr_b16 a[92:93], v198 offset:8192
    v_mfma_f32_16x16x32_bf16 v[132:135], a[76:79], a[12:15], v[132:135]
    ds_read_b64_tr_b16 a[94:95], v198 offset:8448
    v_mfma_f32_16x16x32_bf16 v[136:139], a[72:75], a[16:19], v[136:139]
    v_mfma_f32_16x16x32_bf16 v[136:139], a[76:79], a[20:23], v[136:139]
    v_mfma_f32_16x16x32_bf16 v[140:143], a[72:75], a[24:27], v[140:143]
    buffer_load_dwordx4 v185, s[8:11], s64 offen offset:1024 lds
    v_mfma_f32_16x16x32_bf16 v[140:143], a[76:79], a[28:31], v[140:143]
    s_waitcnt lgkmcnt(4)
    v_mfma_f32_16x16x32_bf16 v[144:147], a[0:3], a[80:83], v[144:147]
    ds_read_b64_tr_b16 a[64:65], v197 offset:0
    v_mfma_f32_16x16x32_bf16 v[144:147], a[4:7], a[84:87], v[144:147]
    ds_read_b64_tr_b16 a[66:67], v197 offset:256
    v_mfma_f32_16x16x32_bf16 v[148:151], a[8:11], a[80:83], v[148:151]
    ds_read_b64_tr_b16 a[68:69], v197 offset:6144
    v_mfma_f32_16x16x32_bf16 v[148:151], a[12:15], a[84:87], v[148:151]
    ds_read_b64_tr_b16 a[70:71], v197 offset:6400
    v_mfma_f32_16x16x32_bf16 v[152:155], a[16:19], a[80:83], v[152:155]
    v_mfma_f32_16x16x32_bf16 v[152:155], a[20:23], a[84:87], v[152:155]
    v_mfma_f32_16x16x32_bf16 v[156:159], a[24:27], a[80:83], v[156:159]
    buffer_load_dwordx4 v186, s[8:11], s64 offen offset:2048 lds
    v_mfma_f32_16x16x32_bf16 v[156:159], a[28:31], a[84:87], v[156:159]
    s_waitcnt lgkmcnt(4)
    v_mfma_f32_16x16x32_bf16 v[160:163], a[0:3], a[88:91], v[160:163]
    ds_read_b64_tr_b16 a[72:73], v198 offset:0
    v_mfma_f32_16x16x32_bf16 v[160:163], a[4:7], a[92:95], v[160:163]
    ds_read_b64_tr_b16 a[74:75], v198 offset:256
    v_mfma_f32_16x16x32_bf16 v[164:167], a[8:11], a[88:91], v[164:167]
    ds_read_b64_tr_b16 a[76:77], v198 offset:6144
    v_mfma_f32_16x16x32_bf16 v[164:167], a[12:15], a[92:95], v[164:167]
    ds_read_b64_tr_b16 a[78:79], v198 offset:6400
    v_mfma_f32_16x16x32_bf16 v[168:171], a[16:19], a[88:91], v[168:171]
    v_mfma_f32_16x16x32_bf16 v[168:171], a[20:23], a[92:95], v[168:171]
    v_mfma_f32_16x16x32_bf16 v[172:175], a[24:27], a[88:91], v[172:175]
    v_mfma_f32_16x16x32_bf16 v[172:175], a[28:31], a[92:95], v[172:175]
    s_waitcnt lgkmcnt(4)
    v_mfma_f32_16x16x32_bf16 a[208:211], a[64:67], a[0:3], a[208:211]
    ds_read_b64_tr_b16 a[80:81], v196 offset:0
    v_mfma_f32_16x16x32_bf16 a[208:211], a[68:71], a[4:7], a[208:211]
    ds_read_b64_tr_b16 a[82:83], v196 offset:1792
    v_mfma_f32_16x16x32_bf16 a[212:215], a[64:67], a[8:11], a[212:215]
    ds_read_b64_tr_b16 a[84:85], v196 offset:7168
    v_mfma_f32_16x16x32_bf16 a[212:215], a[68:71], a[12:15], a[212:215]
    ds_read_b64_tr_b16 a[86:87], v196 offset:8960
    v_mfma_f32_16x16x32_bf16 a[216:219], a[64:67], a[16:19], a[216:219]
    v_mfma_f32_16x16x32_bf16 a[216:219], a[68:71], a[20:23], a[216:219]
    buffer_load_dwordx4 v187, s[8:11], s64 offen offset:3072 lds
    v_mfma_f32_16x16x32_bf16 a[220:223], a[64:67], a[24:27], a[220:223]
    v_mfma_f32_16x16x32_bf16 a[220:223], a[68:71], a[28:31], a[220:223]
    s_waitcnt lgkmcnt(4)
    v_mfma_f32_16x16x32_bf16 a[224:227], a[72:75], a[0:3], a[224:227]
    ds_read_b64_tr_b16 a[88:89], v196 offset:14336
    v_mfma_f32_16x16x32_bf16 a[224:227], a[76:79], a[4:7], a[224:227]
    ds_read_b64_tr_b16 a[90:91], v196 offset:16128
    v_mfma_f32_16x16x32_bf16 a[228:231], a[72:75], a[8:11], a[228:231]
    ds_read_b64_tr_b16 a[92:93], v196 offset:21504
    v_mfma_f32_16x16x32_bf16 a[228:231], a[76:79], a[12:15], a[228:231]
    ds_read_b64_tr_b16 a[94:95], v196 offset:23296
    v_mfma_f32_16x16x32_bf16 a[232:235], a[72:75], a[16:19], a[232:235]
    v_mfma_f32_16x16x32_bf16 a[232:235], a[76:79], a[20:23], a[232:235]
    s_add_u32 m0, m0, 4096
    v_mfma_f32_16x16x32_bf16 a[236:239], a[72:75], a[24:27], a[236:239]
    buffer_load_dwordx4 v188, s[8:11], s64 offen offset:0 lds
    v_mfma_f32_16x16x32_bf16 a[236:239], a[76:79], a[28:31], a[236:239]
    s_waitcnt lgkmcnt(4)
    v_mfma_f32_16x16x32_bf16 v[0:3], a[80:83], a[0:3], v[0:3]
    ds_read_b64_tr_b16 a[64:65], v196 offset:32
    v_mfma_f32_16x16x32_bf16 v[0:3], a[84:87], a[4:7], v[0:3]
    ds_read_b64_tr_b16 a[66:67], v196 offset:1824
    v_mfma_f32_16x16x32_bf16 v[4:7], a[80:83], a[8:11], v[4:7]
    ds_read_b64_tr_b16 a[68:69], v196 offset:7200
    v_mfma_f32_16x16x32_bf16 v[4:7], a[84:87], a[12:15], v[4:7]
    ds_read_b64_tr_b16 a[70:71], v196 offset:8992
    v_mfma_f32_16x16x32_bf16 v[8:11], a[80:83], a[16:19], v[8:11]
    v_mfma_f32_16x16x32_bf16 v[8:11], a[84:87], a[20:23], v[8:11]
    v_mfma_f32_16x16x32_bf16 v[12:15], a[80:83], a[24:27], v[12:15]
    buffer_load_dwordx4 v189, s[8:11], s64 offen offset:1024 lds
    v_mfma_f32_16x16x32_bf16 v[12:15], a[84:87], a[28:31], v[12:15]
    s_waitcnt lgkmcnt(4)
    v_mfma_f32_16x16x32_bf16 a[96:99], a[88:91], a[0:3], a[96:99]
    ds_read_b64_tr_b16 a[72:73], v196 offset:14368
    v_mfma_f32_16x16x32_bf16 a[96:99], a[92:95], a[4:7], a[96:99]
    ds_read_b64_tr_b16 a[74:75], v196 offset:16160
    v_mfma_f32_16x16x32_bf16 a[100:103], a[88:91], a[8:11], a[100:103]
    ds_read_b64_tr_b16 a[76:77], v196 offset:21536
    v_mfma_f32_16x16x32_bf16 a[100:103], a[92:95], a[12:15], a[100:103]
    ds_read_b64_tr_b16 a[78:79], v196 offset:23328
    v_mfma_f32_16x16x32_bf16 a[104:107], a[88:91], a[16:19], a[104:107]
    v_mfma_f32_16x16x32_bf16 a[104:107], a[92:95], a[20:23], a[104:107]
    v_mfma_f32_16x16x32_bf16 a[108:111], a[88:91], a[24:27], a[108:111]
    buffer_load_dwordx4 v190, s[8:11], s64 offen offset:2048 lds
    v_mfma_f32_16x16x32_bf16 a[108:111], a[92:95], a[28:31], a[108:111]
    s_waitcnt lgkmcnt(4)
    v_mfma_f32_16x16x32_bf16 v[16:19], a[64:67], a[0:3], v[16:19]
    ds_read_b64_tr_b16 a[80:81], v196 offset:64
    v_mfma_f32_16x16x32_bf16 v[16:19], a[68:71], a[4:7], v[16:19]
    ds_read_b64_tr_b16 a[82:83], v196 offset:1856
    v_mfma_f32_16x16x32_bf16 v[20:23], a[64:67], a[8:11], v[20:23]
    ds_read_b64_tr_b16 a[84:85], v196 offset:7232
    s_waitcnt vmcnt(8)
    v_mfma_f32_16x16x32_bf16 v[20:23], a[68:71], a[12:15], v[20:23]
    ds_read_b64_tr_b16 a[86:87], v196 offset:9024
    v_mfma_f32_16x16x32_bf16 v[24:27], a[64:67], a[16:19], v[24:27]
    ds_read_b128 a[32:35], v194 offset:0
    v_mfma_f32_16x16x32_bf16 v[24:27], a[68:71], a[20:23], v[24:27]
    ds_read_b128 a[36:39], v195 offset:0
    v_mfma_f32_16x16x32_bf16 v[28:31], a[64:67], a[24:27], v[28:31]
    v_mfma_f32_16x16x32_bf16 v[28:31], a[68:71], a[28:31], v[28:31]
    s_waitcnt lgkmcnt(6)
    v_mfma_f32_16x16x32_bf16 a[112:115], a[72:75], a[0:3], a[112:115]
    ds_read_b64_tr_b16 a[88:89], v196 offset:14400
    v_mfma_f32_16x16x32_bf16 a[112:115], a[76:79], a[4:7], a[112:115]
    ds_read_b64_tr_b16 a[90:91], v196 offset:16192
    v_mfma_f32_16x16x32_bf16 a[116:119], a[72:75], a[8:11], a[116:119]
    ds_read_b64_tr_b16 a[92:93], v196 offset:21568
    v_mfma_f32_16x16x32_bf16 a[116:119], a[76:79], a[12:15], a[116:119]
    ds_read_b64_tr_b16 a[94:95], v196 offset:23360
    v_mfma_f32_16x16x32_bf16 a[120:123], a[72:75], a[16:19], a[120:123]
    ds_read_b128 a[40:43], v194 offset:2048
    v_mfma_f32_16x16x32_bf16 a[120:123], a[76:79], a[20:23], a[120:123]
    ds_read_b128 a[44:47], v195 offset:2048
    s_add_u32 m0, s68, s69
    v_mfma_f32_16x16x32_bf16 a[124:127], a[72:75], a[24:27], a[124:127]
    buffer_load_dwordx4 v191, s[12:15], s65 offen offset:0 lds
    v_mfma_f32_16x16x32_bf16 a[124:127], a[76:79], a[28:31], a[124:127]
    s_waitcnt lgkmcnt(6)
    v_mfma_f32_16x16x32_bf16 v[32:35], a[80:83], a[0:3], v[32:35]
    ds_read_b64_tr_b16 a[64:65], v196 offset:96
    v_mfma_f32_16x16x32_bf16 v[32:35], a[84:87], a[4:7], v[32:35]
    ds_read_b64_tr_b16 a[66:67], v196 offset:1888
    v_mfma_f32_16x16x32_bf16 v[36:39], a[80:83], a[8:11], v[36:39]
    ds_read_b64_tr_b16 a[68:69], v196 offset:7264
    v_mfma_f32_16x16x32_bf16 v[36:39], a[84:87], a[12:15], v[36:39]
    ds_read_b64_tr_b16 a[70:71], v196 offset:9056
    v_mfma_f32_16x16x32_bf16 v[40:43], a[80:83], a[16:19], v[40:43]
    ds_read_b128 a[48:51], v194 offset:4096
    v_mfma_f32_16x16x32_bf16 v[40:43], a[84:87], a[20:23], v[40:43]
    ds_read_b128 a[52:55], v195 offset:4096
    v_mfma_f32_16x16x32_bf16 v[44:47], a[80:83], a[24:27], v[44:47]
    buffer_load_dwordx4 v192, s[12:15], s65 offen offset:1024 lds
    v_mfma_f32_16x16x32_bf16 v[44:47], a[84:87], a[28:31], v[44:47]
    s_waitcnt lgkmcnt(6)
    v_mfma_f32_16x16x32_bf16 a[128:131], a[88:91], a[0:3], a[128:131]
    ds_read_b64_tr_b16 a[72:73], v196 offset:14432
    v_mfma_f32_16x16x32_bf16 a[128:131], a[92:95], a[4:7], a[128:131]
    ds_read_b64_tr_b16 a[74:75], v196 offset:16224
    v_mfma_f32_16x16x32_bf16 a[132:135], a[88:91], a[8:11], a[132:135]
    ds_read_b64_tr_b16 a[76:77], v196 offset:21600
    v_mfma_f32_16x16x32_bf16 a[132:135], a[92:95], a[12:15], a[132:135]
    ds_read_b64_tr_b16 a[78:79], v196 offset:23392
    v_mfma_f32_16x16x32_bf16 a[136:139], a[88:91], a[16:19], a[136:139]
    ds_read_b128 a[56:59], v194 offset:6144
    v_mfma_f32_16x16x32_bf16 a[136:139], a[92:95], a[20:23], a[136:139]
    ds_read_b128 a[60:63], v195 offset:6144
    v_mfma_f32_16x16x32_bf16 a[140:143], a[88:91], a[24:27], a[140:143]
    buffer_load_dwordx4 v193, s[12:15], s65 offen offset:2048 lds
    v_mfma_f32_16x16x32_bf16 a[140:143], a[92:95], a[28:31], a[140:143]
    s_waitcnt lgkmcnt(6)
    s_add_u32 s64, s64, 458752
    v_mfma_f32_16x16x32_bf16 v[48:51], a[64:67], a[0:3], v[48:51]
    ds_read_b64_tr_b16 a[80:81], v196 offset:128
    s_add_u32 s65, s65, 393216
    v_mfma_f32_16x16x32_bf16 v[48:51], a[68:71], a[4:7], v[48:51]
    ds_read_b64_tr_b16 a[82:83], v196 offset:1920
    s_add_u32 s69, s69, 40960
    v_mfma_f32_16x16x32_bf16 v[52:55], a[64:67], a[8:11], v[52:55]
    ds_read_b64_tr_b16 a[84:85], v196 offset:7296
    s_cmp_eq_u32 s69, 122880
    v_mfma_f32_16x16x32_bf16 v[52:55], a[68:71], a[12:15], v[52:55]
    ds_read_b64_tr_b16 a[86:87], v196 offset:9088
    s_cselect_b32 s69, 0, s69
    v_mfma_f32_16x16x32_bf16 v[56:59], a[64:67], a[16:19], v[56:59]
    v_mfma_f32_16x16x32_bf16 v[56:59], a[68:71], a[20:23], v[56:59]
    v_mfma_f32_16x16x32_bf16 v[60:63], a[64:67], a[24:27], v[60:63]
    v_mfma_f32_16x16x32_bf16 v[60:63], a[68:71], a[28:31], v[60:63]
    s_waitcnt lgkmcnt(4)
    v_mfma_f32_16x16x32_bf16 a[144:147], a[72:75], a[0:3], a[144:147]
    ds_read_b64_tr_b16 a[88:89], v196 offset:14464
    v_mfma_f32_16x16x32_bf16 a[144:147], a[76:79], a[4:7], a[144:147]
    ds_read_b64_tr_b16 a[90:91], v196 offset:16256
    v_mfma_f32_16x16x32_bf16 a[148:151], a[72:75], a[8:11], a[148:151]
    ds_read_b64_tr_b16 a[92:93], v196 offset:21632
    v_mfma_f32_16x16x32_bf16 a[148:151], a[76:79], a[12:15], a[148:151]
    ds_read_b64_tr_b16 a[94:95], v196 offset:23424
    s_mov_b32 m0, s66
    v_mfma_f32_16x16x32_bf16 a[152:155], a[72:75], a[16:19], a[152:155]
    buffer_load_dwordx4 v176, s[4:7], s63 offen offset:0 lds
    v_mfma_f32_16x16x32_bf16 a[152:155], a[76:79], a[20:23], a[152:155]
    v_mfma_f32_16x16x32_bf16 a[156:159], a[72:75], a[24:27], a[156:159]
    buffer_load_dwordx4 v177, s[4:7], s63 offen offset:1024 lds
    v_mfma_f32_16x16x32_bf16 a[156:159], a[76:79], a[28:31], a[156:159]
    s_waitcnt lgkmcnt(4)
    v_mfma_f32_16x16x32_bf16 v[64:67], a[80:83], a[0:3], v[64:67]
    ds_read_b64_tr_b16 a[64:65], v196 offset:160
    v_mfma_f32_16x16x32_bf16 v[64:67], a[84:87], a[4:7], v[64:67]
    ds_read_b64_tr_b16 a[66:67], v196 offset:1952
    v_mfma_f32_16x16x32_bf16 v[68:71], a[80:83], a[8:11], v[68:71]
    ds_read_b64_tr_b16 a[68:69], v196 offset:7328
    v_mfma_f32_16x16x32_bf16 v[68:71], a[84:87], a[12:15], v[68:71]
    ds_read_b64_tr_b16 a[70:71], v196 offset:9120
    v_mfma_f32_16x16x32_bf16 v[72:75], a[80:83], a[16:19], v[72:75]
    buffer_load_dwordx4 v178, s[4:7], s63 offen offset:2048 lds
    v_mfma_f32_16x16x32_bf16 v[72:75], a[84:87], a[20:23], v[72:75]
    v_mfma_f32_16x16x32_bf16 v[76:79], a[80:83], a[24:27], v[76:79]
    v_mfma_f32_16x16x32_bf16 v[76:79], a[84:87], a[28:31], v[76:79]
    s_waitcnt lgkmcnt(4)
    v_mfma_f32_16x16x32_bf16 a[160:163], a[88:91], a[0:3], a[160:163]
    ds_read_b64_tr_b16 a[72:73], v196 offset:14496
    v_mfma_f32_16x16x32_bf16 a[160:163], a[92:95], a[4:7], a[160:163]
    ds_read_b64_tr_b16 a[74:75], v196 offset:16288
    v_mfma_f32_16x16x32_bf16 a[164:167], a[88:91], a[8:11], a[164:167]
    ds_read_b64_tr_b16 a[76:77], v196 offset:21664
    v_mfma_f32_16x16x32_bf16 a[164:167], a[92:95], a[12:15], a[164:167]
    ds_read_b64_tr_b16 a[78:79], v196 offset:23456
    v_mfma_f32_16x16x32_bf16 a[168:171], a[88:91], a[16:19], a[168:171]
    buffer_load_dwordx4 v179, s[4:7], s63 offen offset:3072 lds
    v_mfma_f32_16x16x32_bf16 a[168:171], a[92:95], a[20:23], a[168:171]
    s_add_u32 m0, m0, 4096
    v_mfma_f32_16x16x32_bf16 a[172:175], a[88:91], a[24:27], a[172:175]
    buffer_load_dwordx4 v180, s[4:7], s63 offen offset:0 lds
    v_mfma_f32_16x16x32_bf16 a[172:175], a[92:95], a[28:31], a[172:175]
    s_waitcnt lgkmcnt(4)
    v_mfma_f32_16x16x32_bf16 v[80:83], a[64:67], a[0:3], v[80:83]
    ds_read_b64_tr_b16 a[80:81], v196 offset:192
    v_mfma_f32_16x16x32_bf16 v[80:83], a[68:71], a[4:7], v[80:83]
    ds_read_b64_tr_b16 a[82:83], v196 offset:1984
    v_mfma_f32_16x16x32_bf16 v[84:87], a[64:67], a[8:11], v[84:87]
    ds_read_b64_tr_b16 a[84:85], v196 offset:7360
    v_mfma_f32_16x16x32_bf16 v[84:87], a[68:71], a[12:15], v[84:87]
    ds_read_b64_tr_b16 a[86:87], v196 offset:9152
    v_mfma_f32_16x16x32_bf16 v[88:91], a[64:67], a[16:19], v[88:91]
    s_add_u32 s70, s70, 40960
    buffer_load_dwordx4 v181, s[4:7], s63 offen offset:1024 lds
    v_mfma_f32_16x16x32_bf16 v[88:91], a[68:71], a[20:23], v[88:91]
    s_cmp_eq_u32 s70, 122880
    v_mfma_f32_16x16x32_bf16 v[92:95], a[64:67], a[24:27], v[92:95]
    s_cselect_b32 s70, 0, s70
    v_mfma_f32_16x16x32_bf16 v[92:95], a[68:71], a[28:31], v[92:95]
    s_waitcnt lgkmcnt(4)
    v_mfma_f32_16x16x32_bf16 a[176:179], a[72:75], a[0:3], a[176:179]
    ds_read_b64_tr_b16 a[88:89], v196 offset:14528
    v_mfma_f32_16x16x32_bf16 a[176:179], a[76:79], a[4:7], a[176:179]
    ds_read_b64_tr_b16 a[90:91], v196 offset:16320
    v_mfma_f32_16x16x32_bf16 a[180:183], a[72:75], a[8:11], a[180:183]
    ds_read_b64_tr_b16 a[92:93], v196 offset:21696
    v_mfma_f32_16x16x32_bf16 a[180:183], a[76:79], a[12:15], a[180:183]
    ds_read_b64_tr_b16 a[94:95], v196 offset:23488
    v_mfma_f32_16x16x32_bf16 a[184:187], a[72:75], a[16:19], a[184:187]
    buffer_load_dwordx4 v182, s[4:7], s63 offen offset:2048 lds
    v_add_u32 v196, s70, v199
    v_mfma_f32_16x16x32_bf16 a[184:187], a[76:79], a[20:23], a[184:187]
    v_add_u32 v197, s70, v200
    v_mfma_f32_16x16x32_bf16 a[188:191], a[72:75], a[24:27], a[188:191]
    v_add_u32 v198, s70, v201
    v_mfma_f32_16x16x32_bf16 a[188:191], a[76:79], a[28:31], a[188:191]
    s_waitcnt lgkmcnt(0)
    v_mfma_f32_16x16x32_bf16 v[96:99], a[80:83], a[0:3], v[96:99]
    s_waitcnt vmcnt(7)
    s_barrier
    v_mfma_f32_16x16x32_bf16 v[96:99], a[84:87], a[4:7], v[96:99]
    ds_read_b64_tr_b16 a[64:65], v197 offset:1024
    v_mfma_f32_16x16x32_bf16 v[100:103], a[80:83], a[8:11], v[100:103]
    ds_read_b64_tr_b16 a[66:67], v197 offset:1280
    v_mfma_f32_16x16x32_bf16 v[100:103], a[84:87], a[12:15], v[100:103]
    ds_read_b64_tr_b16 a[68:69], v197 offset:7168
    v_mfma_f32_16x16x32_bf16 v[104:107], a[80:83], a[16:19], v[104:107]
    ds_read_b64_tr_b16 a[70:71], v197 offset:7424
    v_mfma_f32_16x16x32_bf16 v[104:107], a[84:87], a[20:23], v[104:107]
    v_mfma_f32_16x16x32_bf16 v[108:111], a[80:83], a[24:27], v[108:111]
    buffer_load_dwordx4 v183, s[4:7], s63 offen offset:3072 lds
    v_mfma_f32_16x16x32_bf16 v[108:111], a[84:87], a[28:31], v[108:111]
    s_waitcnt lgkmcnt(4)
    s_add_u32 s63, s63, 128
    v_mfma_f32_16x16x32_bf16 a[192:195], a[88:91], a[0:3], a[192:195]
    ds_read_b64_tr_b16 a[72:73], v198 offset:1024
    v_mfma_f32_16x16x32_bf16 a[192:195], a[92:95], a[4:7], a[192:195]
    ds_read_b64_tr_b16 a[74:75], v198 offset:1280
    v_mfma_f32_16x16x32_bf16 a[196:199], a[88:91], a[8:11], a[196:199]
    ds_read_b64_tr_b16 a[76:77], v198 offset:7168
    v_mfma_f32_16x16x32_bf16 a[196:199], a[92:95], a[12:15], a[196:199]
    ds_read_b64_tr_b16 a[78:79], v198 offset:7424
    v_mfma_f32_16x16x32_bf16 a[200:203], a[88:91], a[16:19], a[200:203]
    buffer_load_dword v248, v207, s[32:35], s76 offen
    v_mfma_f32_16x16x32_bf16 a[200:203], a[92:95], a[20:23], a[200:203]
    s_add_u32 s76, s76, s77
    v_mfma_f32_16x16x32_bf16 a[204:207], a[88:91], a[24:27], a[204:207]
    v_mfma_f32_16x16x32_bf16 a[204:207], a[92:95], a[28:31], a[204:207]
    s_waitcnt lgkmcnt(4)
    s_sub_u32 s38, s38, 1
    s_cmp_lg_u32 s38, 0
    s_cbranch_scc1 p1_loop
    v_mfma_f32_16x16x32_bf16 v[112:115], a[64:67], a[32:35], v[112:115]
    ds_read_b64_tr_b16 a[80:81], v197 offset:2048
    v_mfma_f32_16x16x32_bf16 v[112:115], a[68:71], a[36:39], v[112:115]
    ds_read_b64_tr_b16 a[82:83], v197 offset:2304
    v_mfma_f32_16x16x32_bf16 v[116:119], a[64:67], a[40:43], v[116:119]
    ds_read_b64_tr_b16 a[84:85], v197 offset:8192
    v_mfma_f32_16x16x32_bf16 v[116:119], a[68:71], a[44:47], v[116:119]
    ds_read_b64_tr_b16 a[86:87], v197 offset:8448
    s_add_u32 m0, s67, s69
    v_mfma_f32_16x16x32_bf16 v[120:123], a[64:67], a[48:51], v[120:123]
    buffer_load_dwordx4 v184, s[8:11], s64 offen offset:0 lds
    v_mfma_f32_16x16x32_bf16 v[120:123], a[68:71], a[52:55], v[120:123]
    v_mfma_f32_16x16x32_bf16 v[124:127], a[64:67], a[56:59], v[124:127]
    buffer_load_dwordx4 v185, s[8:11], s64 offen offset:1024 lds
    v_mfma_f32_16x16x32_bf16 v[124:127], a[68:71], a[60:63], v[124:127]
    s_waitcnt lgkmcnt(4)
    v_mfma_f32_16x16x32_bf16 v[128:131], a[72:75], a[32:35], v[128:131]
    ds_read_b64_tr_b16 a[88:89], v198 offset:2048
    s_mov_b32 s24, s56
    v_mfma_f32_16x16x32_bf16 v[128:131], a[76:79], a[36:39], v[128:131]
    ds_read_b64_tr_b16 a[90:91], v198 offset:2304
    s_mov_b32 s25, s57
    v_mfma_f32_16x16x32_bf16 v[132:135], a[72:75], a[40:43], v[132:135]
    ds_read_b64_tr_b16 a[92:93], v198 offset:8192
    s_mov_b32 s26, 0x400000
    v_mfma_f32_16x16x32_bf16 v[132:135], a[76:79], a[44:47], v[132:135]
    ds_read_b64_tr_b16 a[94:95], v198 offset:8448
    s_mov_b32 s27, 0x20000
    v_mfma_f32_16x16x32_bf16 v[136:139], a[72:75], a[48:51], v[136:139]
    s_lshr_b32 s39, s3, 1
    v_mfma_f32_16x16x32_bf16 v[136:139], a[76:79], a[52:55], v[136:139]
    buffer_load_dwordx4 v186, s[8:11], s64 offen offset:2048 lds
    s_lshl_b32 s39, s39, 14
    v_mfma_f32_16x16x32_bf16 v[140:143], a[72:75], a[56:59], v[140:143]
    s_and_b32 s78, s3, 1
    v_mfma_f32_16x16x32_bf16 v[140:143], a[76:79], a[60:63], v[140:143]
    s_waitcnt lgkmcnt(4)
    s_lshl_b32 s78, s78, 12
    v_mfma_f32_16x16x32_bf16 v[144:147], a[32:35], a[80:83], v[144:147]
    ds_read_b64_tr_b16 a[64:65], v197 offset:0
    s_add_u32 s39, s39, s78
    v_mfma_f32_16x16x32_bf16 v[144:147], a[36:39], a[84:87], v[144:147]
    ds_read_b64_tr_b16 a[66:67], v197 offset:256
    v_mfma_f32_16x16x32_bf16 v[148:151], a[40:43], a[80:83], v[148:151]
    ds_read_b64_tr_b16 a[68:69], v197 offset:6144
    v_mfma_f32_16x16x32_bf16 v[148:151], a[44:47], a[84:87], v[148:151]
    ds_read_b64_tr_b16 a[70:71], v197 offset:6400
    v_mfma_f32_16x16x32_bf16 v[152:155], a[48:51], a[80:83], v[152:155]
    buffer_load_dwordx4 v187, s[8:11], s64 offen offset:3072 lds
    v_mfma_f32_16x16x32_bf16 v[152:155], a[52:55], a[84:87], v[152:155]
    s_add_u32 m0, m0, 4096
    v_mfma_f32_16x16x32_bf16 v[156:159], a[56:59], a[80:83], v[156:159]
    buffer_load_dwordx4 v188, s[8:11], s64 offen offset:0 lds
    v_mfma_f32_16x16x32_bf16 v[156:159], a[60:63], a[84:87], v[156:159]
    s_waitcnt lgkmcnt(4)
    v_mfma_f32_16x16x32_bf16 v[160:163], a[32:35], a[88:91], v[160:163]
    ds_read_b64_tr_b16 a[72:73], v198 offset:0
    v_mfma_f32_16x16x32_bf16 v[160:163], a[36:39], a[92:95], v[160:163]
    ds_read_b64_tr_b16 a[74:75], v198 offset:256
    v_mfma_f32_16x16x32_bf16 v[164:167], a[40:43], a[88:91], v[164:167]
    ds_read_b64_tr_b16 a[76:77], v198 offset:6144
    v_mfma_f32_16x16x32_bf16 v[164:167], a[44:47], a[92:95], v[164:167]
    ds_read_b64_tr_b16 a[78:79], v198 offset:6400
    v_mfma_f32_16x16x32_bf16 v[168:171], a[48:51], a[88:91], v[168:171]
    v_mfma_f32_16x16x32_bf16 v[168:171], a[52:55], a[92:95], v[168:171]
    buffer_load_dwordx4 v189, s[8:11], s64 offen offset:1024 lds
    v_mfma_f32_16x16x32_bf16 v[172:175], a[56:59], a[88:91], v[172:175]
    v_mfma_f32_16x16x32_bf16 v[172:175], a[60:63], a[92:95], v[172:175]
    s_waitcnt lgkmcnt(4)
    v_mfma_f32_16x16x32_bf16 a[208:211], a[64:67], a[32:35], a[208:211]
    ds_read_b64_tr_b16 a[80:81], v196 offset:0
    v_mfma_f32_16x16x32_bf16 a[208:211], a[68:71], a[36:39], a[208:211]
    ds_read_b64_tr_b16 a[82:83], v196 offset:1792
    v_mfma_f32_16x16x32_bf16 a[212:215], a[64:67], a[40:43], a[212:215]
    ds_read_b64_tr_b16 a[84:85], v196 offset:7168
    v_mfma_f32_16x16x32_bf16 a[212:215], a[68:71], a[44:47], a[212:215]
    ds_read_b64_tr_b16 a[86:87], v196 offset:8960
    v_mfma_f32_16x16x32_bf16 a[216:219], a[64:67], a[48:51], a[216:219]
    buffer_load_dwordx4 v190, s[8:11], s64 offen offset:2048 lds
    v_mfma_f32_16x16x32_bf16 a[216:219], a[68:71], a[52:55], a[216:219]
    s_add_u32 m0, s68, s69
    v_mfma_f32_16x16x32_bf16 a[220:223], a[64:67], a[56:59], a[220:223]
    buffer_load_dwordx4 v191, s[12:15], s65 offen offset:0 lds
    v_mfma_f32_16x16x32_bf16 a[220:223], a[68:71], a[60:63], a[220:223]
    s_waitcnt lgkmcnt(4)
    v_mfma_f32_16x16x32_bf16 a[224:227], a[72:75], a[32:35], a[224:227]
    ds_read_b64_tr_b16 a[88:89], v196 offset:14336
    v_mfma_f32_16x16x32_bf16 a[224:227], a[76:79], a[36:39], a[224:227]
    ds_read_b64_tr_b16 a[90:91], v196 offset:16128
    v_mfma_f32_16x16x32_bf16 a[228:231], a[72:75], a[40:43], a[228:231]
    ds_read_b64_tr_b16 a[92:93], v196 offset:21504
    v_mfma_f32_16x16x32_bf16 a[228:231], a[76:79], a[44:47], a[228:231]
    ds_read_b64_tr_b16 a[94:95], v196 offset:23296
    v_mfma_f32_16x16x32_bf16 a[232:235], a[72:75], a[48:51], a[232:235]
    v_mfma_f32_16x16x32_bf16 a[232:235], a[76:79], a[52:55], a[232:235]
    buffer_load_dwordx4 v192, s[12:15], s65 offen offset:1024 lds
    v_mfma_f32_16x16x32_bf16 a[236:239], a[72:75], a[56:59], a[236:239]
    v_mfma_f32_16x16x32_bf16 a[236:239], a[76:79], a[60:63], a[236:239]
    s_waitcnt lgkmcnt(4)
    v_mfma_f32_16x16x32_bf16 v[0:3], a[80:83], a[32:35], v[0:3]
    ds_read_b64_tr_b16 a[64:65], v196 offset:32
    v_mfma_f32_16x16x32_bf16 v[0:3], a[84:87], a[36:39], v[0:3]
    ds_read_b64_tr_b16 a[66:67], v196 offset:1824
    v_mfma_f32_16x16x32_bf16 v[4:7], a[80:83], a[40:43], v[4:7]
    ds_read_b64_tr_b16 a[68:69], v196 offset:7200
    v_mfma_f32_16x16x32_bf16 v[4:7], a[84:87], a[44:47], v[4:7]
    ds_read_b64_tr_b16 a[70:71], v196 offset:8992
    v_mfma_f32_16x16x32_bf16 v[8:11], a[80:83], a[48:51], v[8:11]
    buffer_load_dwordx4 v193, s[12:15], s65 offen offset:2048 lds
    v_mfma_f32_16x16x32_bf16 v[8:11], a[84:87], a[52:55], v[8:11]
    s_add_u32 s64, s64, 458752
    v_mfma_f32_16x16x32_bf16 v[12:15], a[80:83], a[56:59], v[12:15]
    s_add_u32 s65, s65, 393216
    v_mfma_f32_16x16x32_bf16 v[12:15], a[84:87], a[60:63], v[12:15]
    s_waitcnt lgkmcnt(4)
    s_add_u32 s69, s69, 40960
    v_mfma_f32_16x16x32_bf16 a[96:99], a[88:91], a[32:35], a[96:99]
    ds_read_b64_tr_b16 a[72:73], v196 offset:14368
    s_cmp_eq_u32 s69, 122880
    v_mfma_f32_16x16x32_bf16 a[96:99], a[92:95], a[36:39], a[96:99]
    ds_read_b64_tr_b16 a[74:75], v196 offset:16160
    s_cselect_b32 s69, 0, s69
    v_mfma_f32_16x16x32_bf16 a[100:103], a[88:91], a[40:43], a[100:103]
    ds_read_b64_tr_b16 a[76:77], v196 offset:21536
    v_mfma_f32_16x16x32_bf16 a[100:103], a[92:95], a[44:47], a[100:103]
    ds_read_b64_tr_b16 a[78:79], v196 offset:23328
    s_add_u32 m0, s67, s69
    v_mfma_f32_16x16x32_bf16 a[104:107], a[88:91], a[48:51], a[104:107]
    buffer_load_dwordx4 v184, s[8:11], s64 offen offset:0 lds
    v_mfma_f32_16x16x32_bf16 a[104:107], a[92:95], a[52:55], a[104:107]
    v_mfma_f32_16x16x32_bf16 a[108:111], a[88:91], a[56:59], a[108:111]
    buffer_load_dwordx4 v185, s[8:11], s64 offen offset:1024 lds
    v_mfma_f32_16x16x32_bf16 a[108:111], a[92:95], a[60:63], a[108:111]
    s_waitcnt lgkmcnt(4)
    v_mfma_f32_16x16x32_bf16 v[16:19], a[64:67], a[32:35], v[16:19]
    ds_read_b64_tr_b16 a[80:81], v196 offset:64
    v_mfma_f32_16x16x32_bf16 v[16:19], a[68:71], a[36:39], v[16:19]
    ds_read_b64_tr_b16 a[82:83], v196 offset:1856
    v_mfma_f32_16x16x32_bf16 v[20:23], a[64:67], a[40:43], v[20:23]
    ds_read_b64_tr_b16 a[84:85], v196 offset:7232
    s_waitcnt vmcnt(13)
    v_mfma_f32_16x16x32_bf16 v[20:23], a[68:71], a[44:47], v[20:23]
    ds_read_b64_tr_b16 a[86:87], v196 offset:9024
    v_mfma_f32_16x16x32_bf16 v[24:27], a[64:67], a[48:51], v[24:27]
    ds_read_b128 a[0:3], v194 offset:0
    v_mfma_f32_16x16x32_bf16 v[24:27], a[68:71], a[52:55], v[24:27]
    ds_read_b128 a[4:7], v195 offset:0
    v_mfma_f32_16x16x32_bf16 v[28:31], a[64:67], a[56:59], v[28:31]
    buffer_load_dwordx4 v186, s[8:11], s64 offen offset:2048 lds
    v_mfma_f32_16x16x32_bf16 v[28:31], a[68:71], a[60:63], v[28:31]
    s_waitcnt lgkmcnt(6)
    v_mfma_f32_16x16x32_bf16 a[112:115], a[72:75], a[32:35], a[112:115]
    ds_read_b64_tr_b16 a[88:89], v196 offset:14400
    v_lshrrev_b32 v218, 4, v255
    v_mfma_f32_16x16x32_bf16 a[112:115], a[76:79], a[36:39], a[112:115]
    ds_read_b64_tr_b16 a[90:91], v196 offset:16192
    v_mfma_f32_16x16x32_bf16 a[116:119], a[72:75], a[40:43], a[116:119]
    ds_read_b64_tr_b16 a[92:93], v196 offset:21568
    v_lshlrev_b32 v202, 9, v218
    v_mfma_f32_16x16x32_bf16 a[116:119], a[76:79], a[44:47], a[116:119]
    ds_read_b64_tr_b16 a[94:95], v196 offset:23360
    v_mfma_f32_16x16x32_bf16 a[120:123], a[72:75], a[48:51], a[120:123]
    ds_read_b128 a[8:11], v194 offset:2048
    v_and_b32 v218, 15, v255
    v_mfma_f32_16x16x32_bf16 a[120:123], a[76:79], a[52:55], a[120:123]
    ds_read_b128 a[12:15], v195 offset:2048
    v_mfma_f32_16x16x32_bf16 a[124:127], a[72:75], a[56:59], a[124:127]
    buffer_load_dwordx4 v187, s[8:11], s64 offen offset:3072 lds
    v_lshl_add_u32 v203, v218, 4, v202
    v_mfma_f32_16x16x32_bf16 a[124:127], a[76:79], a[60:63], a[124:127]
    s_waitcnt lgkmcnt(6)
    v_mfma_f32_16x16x32_bf16 v[32:35], a[80:83], a[32:35], v[32:35]
    ds_read_b64_tr_b16 a[64:65], v196 offset:96
    v_bfe_u32 v218, v255, 2, 2
    v_mfma_f32_16x16x32_bf16 v[32:35], a[84:87], a[36:39], v[32:35]
    ds_read_b64_tr_b16 a[66:67], v196 offset:1888
    s_add_u32 m0, m0, 4096
    v_mfma_f32_16x16x32_bf16 v[36:39], a[80:83], a[40:43], v[36:39]
    ds_read_b64_tr_b16 a[68:69], v196 offset:7264
    buffer_load_dwordx4 v188, s[8:11], s64 offen offset:0 lds
    v_lshl_add_u32 v202, v218, 7, v202
    v_mfma_f32_16x16x32_bf16 v[36:39], a[84:87], a[44:47], v[36:39]
    ds_read_b64_tr_b16 a[70:71], v196 offset:9056
    v_mfma_f32_16x16x32_bf16 v[40:43], a[80:83], a[48:51], v[40:43]
    ds_read_b128 a[16:19], v194 offset:4096
    v_and_b32 v218, 3, v255
    v_mfma_f32_16x16x32_bf16 v[40:43], a[84:87], a[52:55], v[40:43]
    ds_read_b128 a[20:23], v195 offset:4096
    v_mfma_f32_16x16x32_bf16 v[44:47], a[80:83], a[56:59], v[44:47]
    buffer_load_dwordx4 v189, s[8:11], s64 offen offset:1024 lds
    v_lshl_add_u32 v202, v218, 4, v202
    v_mfma_f32_16x16x32_bf16 v[44:47], a[84:87], a[60:63], v[44:47]
    s_waitcnt lgkmcnt(6)
    v_mfma_f32_16x16x32_bf16 a[128:131], a[88:91], a[32:35], a[128:131]
    ds_read_b64_tr_b16 a[72:73], v196 offset:14432
    v_add_u32 v204, s39, v202
    v_mfma_f32_16x16x32_bf16 a[128:131], a[92:95], a[36:39], a[128:131]
    ds_read_b64_tr_b16 a[74:75], v196 offset:16224
    v_mfma_f32_16x16x32_bf16 a[132:135], a[88:91], a[40:43], a[132:135]
    ds_read_b64_tr_b16 a[76:77], v196 offset:21600
    buffer_load_dwordx4 v190, s[8:11], s64 offen offset:2048 lds
    v_add_u32 v205, s39, v203
    v_mfma_f32_16x16x32_bf16 a[132:135], a[92:95], a[44:47], a[132:135]
    ds_read_b64_tr_b16 a[78:79], v196 offset:23392
    v_mfma_f32_16x16x32_bf16 a[136:139], a[88:91], a[48:51], a[136:139]
    ds_read_b128 a[24:27], v194 offset:6144
    v_add_u32 v206, s66, v202
    v_mfma_f32_16x16x32_bf16 a[136:139], a[92:95], a[52:55], a[136:139]
    ds_read_b128 a[28:31], v195 offset:6144
    s_add_u32 m0, s68, s69
    v_mfma_f32_16x16x32_bf16 a[140:143], a[88:91], a[56:59], a[140:143]
    buffer_load_dwordx4 v191, s[12:15], s65 offen offset:0 lds
    v_mov_b32 v244, 0xdddd
    v_mfma_f32_16x16x32_bf16 a[140:143], a[92:95], a[60:63], a[140:143]
    s_waitcnt lgkmcnt(6)
    v_mfma_f32_16x16x32_bf16 v[48:51], a[64:67], a[32:35], v[48:51]
    ds_read_b64_tr_b16 a[80:81], v196 offset:128
    v_and_b32 v216, 7, v255
    v_mfma_f32_16x16x32_bf16 v[48:51], a[68:71], a[36:39], v[48:51]
    ds_read_b64_tr_b16 a[82:83], v196 offset:1920
    v_mfma_f32_16x16x32_bf16 v[52:55], a[64:67], a[40:43], v[52:55]
    ds_read_b64_tr_b16 a[84:85], v196 offset:7296
    v_mov_b32 v217, 0x3f803f80
    v_mfma_f32_16x16x32_bf16 v[52:55], a[68:71], a[44:47], v[52:55]
    ds_read_b64_tr_b16 a[86:87], v196 offset:9088
    v_mfma_f32_16x16x32_bf16 v[56:59], a[64:67], a[48:51], v[56:59]
    buffer_load_dwordx4 v192, s[12:15], s65 offen offset:1024 lds
    v_cmp_eq_u32 s[56:57], 0, v216
    v_mfma_f32_16x16x32_bf16 v[56:59], a[68:71], a[52:55], v[56:59]
    v_mfma_f32_16x16x32_bf16 v[60:63], a[64:67], a[56:59], v[60:63]
    buffer_load_dwordx4 v193, s[12:15], s65 offen offset:2048 lds
    v_cmp_eq_u32 s[58:59], 4, v216
    v_mfma_f32_16x16x32_bf16 v[60:63], a[68:71], a[60:63], v[60:63]
    s_waitcnt lgkmcnt(4)
    v_mfma_f32_16x16x32_bf16 a[144:147], a[72:75], a[32:35], a[144:147]
    ds_read_b64_tr_b16 a[88:89], v196 offset:14464
    v_bfe_u32 v216, v255, 2, 1
    v_mfma_f32_16x16x32_bf16 a[144:147], a[76:79], a[36:39], a[144:147]
    ds_read_b64_tr_b16 a[90:91], v196 offset:16256
    v_mfma_f32_16x16x32_bf16 a[148:151], a[72:75], a[40:43], a[148:151]
    ds_read_b64_tr_b16 a[92:93], v196 offset:21632
    v_cndmask_b32 v240, 0, v217, s[56:57]
    v_mfma_f32_16x16x32_bf16 a[148:151], a[76:79], a[44:47], a[148:151]
    ds_read_b64_tr_b16 a[94:95], v196 offset:23424
    s_mov_b32 m0, s66
    v_mfma_f32_16x16x32_bf16 a[152:155], a[72:75], a[48:51], a[152:155]
    buffer_load_dwordx4 v176, s[4:7], s63 offen offset:0 lds
    v_cndmask_b32 v241, 0, v217, s[56:57]
    v_mfma_f32_16x16x32_bf16 a[152:155], a[76:79], a[52:55], a[152:155]
    v_mfma_f32_16x16x32_bf16 a[156:159], a[72:75], a[56:59], a[156:159]
    buffer_load_dwordx4 v177, s[4:7], s63 offen offset:1024 lds
    v_cndmask_b32 v242, 0, v217, s[58:59]
    v_mfma_f32_16x16x32_bf16 a[156:159], a[76:79], a[60:63], a[156:159]
    s_waitcnt lgkmcnt(4)
    v_mfma_f32_16x16x32_bf16 v[64:67], a[80:83], a[32:35], v[64:67]
    ds_read_b64_tr_b16 a[64:65], v196 offset:160
    v_cndmask_b32 v243, 0, v217, s[58:59]
    v_mfma_f32_16x16x32_bf16 v[64:67], a[84:87], a[36:39], v[64:67]
    ds_read_b64_tr_b16 a[66:67], v196 offset:1952
    v_mfma_f32_16x16x32_bf16 v[68:71], a[80:83], a[40:43], v[68:71]
    ds_read_b64_tr_b16 a[68:69], v196 offset:7328
    v_lshlrev_b32 v245, 10, v216
    v_mfma_f32_16x16x32_bf16 v[68:71], a[84:87], a[44:47], v[68:71]
    ds_read_b64_tr_b16 a[70:71], v196 offset:9120
    v_mfma_f32_16x16x32_bf16 v[72:75], a[80:83], a[48:51], v[72:75]
    buffer_load_dwordx4 v178, s[4:7], s63 offen offset:2048 lds
    v_lshrrev_b32 v216, 5, v255
    v_mfma_f32_16x16x32_bf16 v[72:75], a[84:87], a[52:55], v[72:75]
    v_mfma_f32_16x16x32_bf16 v[76:79], a[80:83], a[56:59], v[76:79]
    buffer_load_dwordx4 v179, s[4:7], s63 offen offset:3072 lds
    v_lshl_add_u32 v245, v216, 8, v245
    v_mfma_f32_16x16x32_bf16 v[76:79], a[84:87], a[60:63], v[76:79]
    s_waitcnt lgkmcnt(4)
    v_mfma_f32_16x16x32_bf16 a[160:163], a[88:91], a[32:35], a[160:163]
    ds_read_b64_tr_b16 a[72:73], v196 offset:14496
    v_bfe_u32 v216, v255, 3, 2
    v_mfma_f32_16x16x32_bf16 a[160:163], a[92:95], a[36:39], a[160:163]
    ds_read_b64_tr_b16 a[74:75], v196 offset:16288
    v_mfma_f32_16x16x32_bf16 a[164:167], a[88:91], a[40:43], a[164:167]
    ds_read_b64_tr_b16 a[76:77], v196 offset:21664
    v_lshl_add_u32 v245, v216, 6, v245
    v_mfma_f32_16x16x32_bf16 a[164:167], a[92:95], a[44:47], a[164:167]
    ds_read_b64_tr_b16 a[78:79], v196 offset:23456
    s_add_u32 m0, m0, 4096
    v_mfma_f32_16x16x32_bf16 a[168:171], a[88:91], a[48:51], a[168:171]
    buffer_load_dwordx4 v180, s[4:7], s63 offen offset:0 lds
    v_and_b32 v216, 3, v255
    v_mfma_f32_16x16x32_bf16 a[168:171], a[92:95], a[52:55], a[168:171]
    v_mfma_f32_16x16x32_bf16 a[172:175], a[88:91], a[56:59], a[172:175]
    buffer_load_dwordx4 v181, s[4:7], s63 offen offset:1024 lds
    v_lshl_add_u32 v245, v216, 4, v245
    v_mfma_f32_16x16x32_bf16 a[172:175], a[92:95], a[60:63], a[172:175]
    s_waitcnt lgkmcnt(4)
    v_mfma_f32_16x16x32_bf16 v[80:83], a[64:67], a[32:35], v[80:83]
    ds_read_b64_tr_b16 a[80:81], v196 offset:192
    v_add_u32 v246, 512, v245
    v_mfma_f32_16x16x32_bf16 v[80:83], a[68:71], a[36:39], v[80:83]
    ds_read_b64_tr_b16 a[82:83], v196 offset:1984
    v_mfma_f32_16x16x32_bf16 v[84:87], a[64:67], a[40:43], v[84:87]
    ds_read_b64_tr_b16 a[84:85], v196 offset:7360
    v_mfma_f32_16x16x32_bf16 v[84:87], a[68:71], a[44:47], v[84:87]
    ds_read_b64_tr_b16 a[86:87], v196 offset:9152
    v_mfma_f32_16x16x32_bf16 v[88:91], a[64:67], a[48:51], v[88:91]
    s_add_u32 s70, s70, 40960
    buffer_load_dwordx4 v182, s[4:7], s63 offen offset:2048 lds
    v_mfma_f32_16x16x32_bf16 v[88:91], a[68:71], a[52:55], v[88:91]
    s_cmp_eq_u32 s70, 122880
    v_mfma_f32_16x16x32_bf16 v[92:95], a[64:67], a[56:59], v[92:95]
    s_cselect_b32 s70, 0, s70
    buffer_load_dwordx4 v183, s[4:7], s63 offen offset:3072 lds
    v_mfma_f32_16x16x32_bf16 v[92:95], a[68:71], a[60:63], v[92:95]
    s_waitcnt lgkmcnt(4)
    s_add_u32 s63, s63, 128
    v_mfma_f32_16x16x32_bf16 a[176:179], a[72:75], a[32:35], a[176:179]
    ds_read_b64_tr_b16 a[88:89], v196 offset:14528
    v_mfma_f32_16x16x32_bf16 a[176:179], a[76:79], a[36:39], a[176:179]
    ds_read_b64_tr_b16 a[90:91], v196 offset:16320
    v_mfma_f32_16x16x32_bf16 a[180:183], a[72:75], a[40:43], a[180:183]
    ds_read_b64_tr_b16 a[92:93], v196 offset:21696
    v_mfma_f32_16x16x32_bf16 a[180:183], a[76:79], a[44:47], a[180:183]
    ds_read_b64_tr_b16 a[94:95], v196 offset:23488
    v_mfma_f32_16x16x32_bf16 a[184:187], a[72:75], a[48:51], a[184:187]
    v_add_u32 v196, s70, v199
    v_mfma_f32_16x16x32_bf16 a[184:187], a[76:79], a[52:55], a[184:187]
    v_add_u32 v197, s70, v200
    v_mfma_f32_16x16x32_bf16 a[188:191], a[72:75], a[56:59], a[188:191]
    v_add_u32 v198, s70, v201
    v_mfma_f32_16x16x32_bf16 a[188:191], a[76:79], a[60:63], a[188:191]
    s_waitcnt lgkmcnt(0)
    v_mfma_f32_16x16x32_bf16 v[96:99], a[80:83], a[32:35], v[96:99]
    s_waitcnt vmcnt(18)
    s_barrier
    v_mfma_f32_16x16x32_bf16 v[96:99], a[84:87], a[36:39], v[96:99]
    ds_read_b64_tr_b16 a[64:65], v197 offset:1024
    v_mfma_f32_16x16x32_bf16 v[100:103], a[80:83], a[40:43], v[100:103]
    ds_read_b64_tr_b16 a[66:67], v197 offset:1280
    v_mfma_f32_16x16x32_bf16 v[100:103], a[84:87], a[44:47], v[100:103]
    ds_read_b64_tr_b16 a[68:69], v197 offset:7168
    v_mfma_f32_16x16x32_bf16 v[104:107], a[80:83], a[48:51], v[104:107]
    ds_read_b64_tr_b16 a[70:71], v197 offset:7424
    v_mfma_f32_16x16x32_bf16 v[104:107], a[84:87], a[52:55], v[104:107]
    v_mfma_f32_16x16x32_bf16 v[108:111], a[80:83], a[56:59], v[108:111]
    v_mfma_f32_16x16x32_bf16 v[108:111], a[84:87], a[60:63], v[108:111]
    s_waitcnt lgkmcnt(4)
    v_mfma_f32_16x16x32_bf16 a[192:195], a[88:91], a[32:35], a[192:195]
    ds_read_b64_tr_b16 a[72:73], v198 offset:1024
    v_mfma_f32_16x16x32_bf16 a[192:195], a[92:95], a[36:39], a[192:195]
    ds_read_b64_tr_b16 a[74:75], v198 offset:1280
    v_mfma_f32_16x16x32_bf16 a[196:199], a[88:91], a[40:43], a[196:199]
    ds_read_b64_tr_b16 a[76:77], v198 offset:7168
    v_mfma_f32_16x16x32_bf16 a[196:199], a[92:95], a[44:47], a[196:199]
    ds_read_b64_tr_b16 a[78:79], v198 offset:7424
    v_mfma_f32_16x16x32_bf16 a[200:203], a[88:91], a[48:51], a[200:203]
    v_mfma_f32_16x16x32_bf16 a[200:203], a[92:95], a[52:55], a[200:203]
    v_mfma_f32_16x16x32_bf16 a[204:207], a[88:91], a[56:59], a[204:207]
    v_mfma_f32_16x16x32_bf16 a[204:207], a[92:95], a[60:63], a[204:207]
    s_waitcnt lgkmcnt(4)
    v_mfma_f32_16x16x32_bf16 v[112:115], a[64:67], a[0:3], v[112:115]
    ds_read_b64_tr_b16 a[80:81], v197 offset:2048
    s_mov_b32 s32, s54
    v_mfma_f32_16x16x32_bf16 v[112:115], a[68:71], a[4:7], v[112:115]
    ds_read_b64_tr_b16 a[82:83], v197 offset:2304
    s_mov_b32 s33, s55
    v_mfma_f32_16x16x32_bf16 v[116:119], a[64:67], a[8:11], v[116:119]
    ds_read_b64_tr_b16 a[84:85], v197 offset:8192
    s_mov_b32 s34, 0x800
    v_mfma_f32_16x16x32_bf16 v[116:119], a[68:71], a[12:15], v[116:119]
    ds_read_b64_tr_b16 a[86:87], v197 offset:8448
    s_mov_b32 s35, 0x20000
    v_mfma_f32_16x16x32_bf16 v[120:123], a[64:67], a[16:19], v[120:123]
    s_lshl_b32 s39, s41, 12
    v_mfma_f32_16x16x32_bf16 v[120:123], a[68:71], a[20:23], v[120:123]
    buffer_load_dword v251, v252, s[28:31], 0 offen sc1
    v_lshlrev_b32 v211, 5, v255
    v_mfma_f32_16x16x32_bf16 v[124:127], a[64:67], a[24:27], v[124:127]
    buffer_load_dwordx4 v[216:219], v211, s[4:7], s39 offen offset:0
    v_mfma_f32_16x16x32_bf16 v[124:127], a[68:71], a[28:31], v[124:127]
    s_lshl_b32 s41, s41, 3
    s_waitcnt lgkmcnt(4)
    v_mfma_f32_16x16x32_bf16 v[128:131], a[72:75], a[0:3], v[128:131]
    ds_read_b64_tr_b16 a[88:89], v198 offset:2048
    s_add_u32 s41, s41, 0x1e00000
    v_mfma_f32_16x16x32_bf16 v[128:131], a[76:79], a[4:7], v[128:131]
    ds_read_b64_tr_b16 a[90:91], v198 offset:2304
    s_mov_b32 s59, 0xffff0000
    v_mfma_f32_16x16x32_bf16 v[132:135], a[72:75], a[8:11], v[132:135]
    ds_read_b64_tr_b16 a[92:93], v198 offset:8192
    s_mov_b32 s58, 0x3e8293ee
    v_mfma_f32_16x16x32_bf16 v[132:135], a[76:79], a[12:15], v[132:135]
    ds_read_b64_tr_b16 a[94:95], v198 offset:8448
    s_lshl_b32 s78, s36, 2
    v_mfma_f32_16x16x32_bf16 v[136:139], a[72:75], a[16:19], v[136:139]
    buffer_load_dwordx4 v[220:223], v211, s[4:7], s39 offen offset:16
    s_add_u32 s78, s78, s3
    v_mfma_f32_16x16x32_bf16 v[136:139], a[76:79], a[20:23], v[136:139]
    s_lshl_b32 s71, s78, 12
    v_mfma_f32_16x16x32_bf16 v[140:143], a[72:75], a[24:27], v[140:143]
    buffer_load_dwordx4 v[224:227], v211, s[4:7], s39 offen offset:2048
    s_lshl_b32 s79, s37, 17
    v_mfma_f32_16x16x32_bf16 v[140:143], a[76:79], a[28:31], v[140:143]
    s_add_u32 s71, s71, s79
    s_waitcnt lgkmcnt(4)
    v_mfma_f32_16x16x32_bf16 v[144:147], a[0:3], a[80:83], v[144:147]
    ds_read_b64_tr_b16 a[64:65], v197 offset:0
    s_add_u32 s71, s71, 0x400000
    v_mfma_f32_16x16x32_bf16 v[144:147], a[4:7], a[84:87], v[144:147]
    ds_read_b64_tr_b16 a[66:67], v197 offset:256
    s_mul_i32 s78, s78, 589824
    v_mfma_f32_16x16x32_bf16 v[148:151], a[8:11], a[80:83], v[148:151]
    ds_read_b64_tr_b16 a[68:69], v197 offset:6144
    s_add_u32 s78, s78, 0xc00000
    v_mfma_f32_16x16x32_bf16 v[148:151], a[12:15], a[84:87], v[148:151]
    ds_read_b64_tr_b16 a[70:71], v197 offset:6400
    s_mul_i32 s79, s37, 7
    v_mfma_f32_16x16x32_bf16 v[152:155], a[16:19], a[80:83], v[152:155]
    buffer_load_dwordx4 v[228:231], v211, s[4:7], s39 offen offset:2064
    s_add_u32 s72, s79, 1
    v_mfma_f32_16x16x32_bf16 v[152:155], a[20:23], a[84:87], v[152:155]
    s_lshr_b32 s72, s72, 1
    v_mfma_f32_16x16x32_bf16 v[156:159], a[24:27], a[80:83], v[156:159]
    buffer_load_dwordx4 v[232:235], v211, s[32:35], 0 offen offset:0
    s_lshl_b32 s72, s72, 10
    v_mfma_f32_16x16x32_bf16 v[156:159], a[28:31], a[84:87], v[156:159]
    s_add_u32 s72, s72, s78
    v_add_u32 v192, s71, v254
    v_add_u32 v193, s71, v203
    s_waitcnt lgkmcnt(4)
    v_mfma_f32_16x16x32_bf16 v[160:163], a[0:3], a[88:91], v[160:163]
    ds_read_b64_tr_b16 a[72:73], v198 offset:0
    s_add_u32 s73, s72, 3072
    v_add_u32 v193, 0x400000, v193
    v_mfma_f32_16x16x32_bf16 v[160:163], a[4:7], a[92:95], v[160:163]
    ds_read_b64_tr_b16 a[74:75], v198 offset:256
    s_sub_u32 s79, s72, 1016
    v_mfma_f32_16x16x32_bf16 v[164:167], a[8:11], a[88:91], v[164:167]
    ds_read_b64_tr_b16 a[76:77], v198 offset:6144
    s_bitcmp1_b32 s37, 0
    s_cselect_b32 s73, s79, s73
    v_mfma_f32_16x16x32_bf16 v[164:167], a[12:15], a[92:95], v[164:167]
    ds_read_b64_tr_b16 a[78:79], v198 offset:6400
    s_lshl_b32 s74, s37, 7
    v_mfma_f32_16x16x32_bf16 v[168:171], a[16:19], a[88:91], v[168:171]
    buffer_load_dwordx4 v[236:239], v211, s[32:35], 0 offen offset:16
    s_add_u32 s74, s74, 0x1e02000
    v_mfma_f32_16x16x32_bf16 v[168:171], a[20:23], a[92:95], v[168:171]
    s_lshl_b32 s75, s36, 7
    v_mfma_f32_16x16x32_bf16 v[172:175], a[24:27], a[88:91], v[172:175]
    s_add_u32 s75, s75, 0x1e03000
    v_mfma_f32_16x16x32_bf16 v[172:175], a[28:31], a[92:95], v[172:175]
    s_lshl_b32 s67, s37, 17
    s_waitcnt lgkmcnt(4)
    v_mfma_f32_16x16x32_bf16 a[208:211], a[64:67], a[0:3], a[208:211]
    ds_read_b64_tr_b16 a[80:81], v196 offset:0
    s_lshl_b32 s64, s3, 11
    v_mfma_f32_16x16x32_bf16 a[208:211], a[68:71], a[4:7], a[208:211]
    ds_read_b64_tr_b16 a[82:83], v196 offset:1792
    s_add_u32 s67, s67, s64
    v_mfma_f32_16x16x32_bf16 a[212:215], a[64:67], a[8:11], a[212:215]
    ds_read_b64_tr_b16 a[84:85], v196 offset:7168
    s_add_u32 s67, s67, 0x3ffe00
    v_mfma_f32_16x16x32_bf16 a[212:215], a[68:71], a[12:15], a[212:215]
    ds_read_b64_tr_b16 a[86:87], v196 offset:8960
    s_waitcnt vmcnt(7)
    s_add_u32 s42, s60, s67
    s_addc_u32 s43, s61, 0
    v_mfma_f32_16x16x32_bf16 a[216:219], a[64:67], a[16:19], a[216:219]
    ds_read_b128 a[32:35], v194 offset:0
    s_add_u32 s48, s42, 0x400200
    s_addc_u32 s49, s43, 0
    v_mfma_f32_16x16x32_bf16 a[216:219], a[68:71], a[20:23], a[216:219]
    ds_read_b128 a[36:39], v195 offset:0
    s_movk_i32 s6, 2560
    v_mfma_f32_16x16x32_bf16 a[220:223], a[64:67], a[24:27], a[220:223]
    ds_read_b128 a[40:43], v194 offset:2048
    s_movk_i32 s10, 2048
    v_mfma_f32_16x16x32_bf16 a[220:223], a[68:71], a[28:31], a[220:223]
    ds_read_b128 a[44:47], v195 offset:2048
    s_add_u32 s65, s36, 1
    s_waitcnt lgkmcnt(8)
    v_mfma_f32_16x16x32_bf16 a[224:227], a[72:75], a[0:3], a[224:227]
    ds_read_b64_tr_b16 a[88:89], v196 offset:14336
    s_lshl_b32 s65, s65, 14
    v_mfma_f32_16x16x32_bf16 a[224:227], a[76:79], a[4:7], a[224:227]
    ds_read_b64_tr_b16 a[90:91], v196 offset:16128
    s_and_b32 s65, s65, 0x1ffff
    v_mfma_f32_16x16x32_bf16 a[228:231], a[72:75], a[8:11], a[228:231]
    ds_read_b64_tr_b16 a[92:93], v196 offset:21504
    s_mov_b32 s20, s52
    v_mfma_f32_16x16x32_bf16 a[228:231], a[76:79], a[12:15], a[228:231]
    ds_read_b64_tr_b16 a[94:95], v196 offset:23296
    s_mov_b32 s21, s53
    v_mfma_f32_16x16x32_bf16 a[232:235], a[72:75], a[16:19], a[232:235]
    ds_read_b128 a[48:51], v194 offset:4096
    s_mov_b32 s22, 0x700000
    v_mfma_f32_16x16x32_bf16 a[232:235], a[76:79], a[20:23], a[232:235]
    ds_read_b128 a[52:55], v195 offset:4096
    s_mov_b32 s23, 0x20000
    v_mfma_f32_16x16x32_bf16 a[236:239], a[72:75], a[24:27], a[236:239]
    ds_read_b128 a[56:59], v194 offset:6144
    s_getpc_b64 s[46:47]
ct1:
    s_add_u32 s46, s46, p2_code - ct1
    s_addc_u32 s47, s47, 0
    v_mfma_f32_16x16x32_bf16 a[236:239], a[76:79], a[28:31], a[236:239]
    s_waitcnt lgkmcnt(8)
    ds_read_b128 a[60:63], v195 offset:6144
    s_barrier
    s_lshr_b32 s62, s2, 3
    s_lshl_b32 s62, s62, 2
    v_mfma_f32_16x16x32_bf16 v[0:3], a[80:83], a[0:3], v[0:3]
    ds_read_b64_tr_b16 a[64:65], v197 offset:41984
    s_add_u32 s62, s62, s3
    s_mul_i32 s62, s62, 2
    v_min_u32 v215, 1, v255
    v_mfma_f32_16x16x32_bf16 v[0:3], a[84:87], a[4:7], v[0:3]
    ds_read_b64_tr_b16 a[66:67], v197 offset:42240
    v_add_lshl_u32 v215, s62, v215, 7
    v_mfma_f32_16x16x32_bf16 v[4:7], a[80:83], a[8:11], v[4:7]
    ds_read_b64_tr_b16 a[68:69], v197 offset:48128
    v_min_u32 v215, p3_code - p2_code - 64, v215
    v_mfma_f32_16x16x32_bf16 v[4:7], a[84:87], a[12:15], v[4:7]
    ds_read_b64_tr_b16 a[70:71], v197 offset:48384
    global_load_dword v248, v215, s[46:47]
    s_waitcnt vmcnt(1)
    v_mfma_f32_16x16x32_bf16 v[8:11], a[80:83], a[16:19], v[8:11]
    s_mul_i32 s79, s2, 3
    v_lshlrev_b32 v212, 16, v232
    v_lshlrev_b32 v213, 16, v216
    v_mfma_f32_16x16x32_bf16 v[8:11], a[84:87], a[20:23], v[8:11]
    s_add_u32 s79, s79, s3
    v_lshlrev_b32 v214, 16, v224
    v_mul_f32 v208, v212, v213
    v_mfma_f32_16x16x32_bf16 v[12:15], a[80:83], a[24:27], v[12:15]
    s_mov_b32 s69, 2457600
    v_mul_f32 v209, v212, v214
    v_and_b32 v232, s59, v232
    v_mfma_f32_16x16x32_bf16 v[12:15], a[84:87], a[28:31], v[12:15]
    s_mov_b32 s39, 0x700000
    v_and_b32 v216, s59, v216
    v_and_b32 v224, s59, v224
    s_waitcnt lgkmcnt(8)
    v_mfma_f32_16x16x32_bf16 a[96:99], a[88:91], a[0:3], a[96:99]
    ds_read_b64_tr_b16 a[72:73], v198 offset:41984
    s_cmp_eq_u32 s3, 3
    s_cselect_b32 s32, s44, s52
    v_fmac_f32 v208, v232, v216
    v_mfma_f32_16x16x32_bf16 a[96:99], a[92:95], a[4:7], a[96:99]
    ds_read_b64_tr_b16 a[74:75], v198 offset:42240
    s_cselect_b32 s33, s45, s53
    v_fmac_f32 v209, v232, v224
    v_mfma_f32_16x16x32_bf16 a[100:103], a[88:91], a[8:11], a[100:103]
    ds_read_b64_tr_b16 a[76:77], v198 offset:48128
    s_cselect_b32 s34, 0x200000, s39
    v_lshlrev_b32 v212, 16, v233
    v_mfma_f32_16x16x32_bf16 a[100:103], a[92:95], a[12:15], a[100:103]
    ds_read_b64_tr_b16 a[78:79], v198 offset:48384
    s_cselect_b32 s79, s2, s79
    v_lshlrev_b32 v213, 16, v217
    v_mfma_f32_16x16x32_bf16 a[104:107], a[88:91], a[16:19], a[104:107]
    s_cselect_b32 s39, 22, 25
    v_lshlrev_b32 v214, 16, v225
    v_fmac_f32 v208, v212, v213
    v_mfma_f32_16x16x32_bf16 a[104:107], a[92:95], a[20:23], a[104:107]
    s_cselect_b32 s69, 720896, s69
    v_fmac_f32 v209, v212, v214
    v_and_b32 v233, s59, v233
    v_mfma_f32_16x16x32_bf16 a[108:111], a[88:91], a[24:27], a[108:111]
    v_and_b32 v217, s59, v217
    v_and_b32 v225, s59, v225
    v_mfma_f32_16x16x32_bf16 a[108:111], a[92:95], a[28:31], a[108:111]
    s_mul_i32 s79, s79, s39
    v_fmac_f32 v208, v233, v217
    v_fmac_f32 v209, v233, v225
    s_waitcnt lgkmcnt(4)
    v_mfma_f32_16x16x32_bf16 v[112:115], a[64:67], a[32:35], v[112:115]
    ds_read_b64_tr_b16 a[80:81], v197 offset:43008
    s_mov_b32 s68, 0
    v_lshlrev_b32 v212, 16, v234
    v_mfma_f32_16x16x32_bf16 v[112:115], a[68:71], a[36:39], v[112:115]
    ds_read_b64_tr_b16 a[82:83], v197 offset:43264
    v_add_lshl_u32 v249, s79, v255, 7
    v_mfma_f32_16x16x32_bf16 v[116:119], a[64:67], a[40:43], v[116:119]
    ds_read_b64_tr_b16 a[84:85], v197 offset:49152
    v_mov_b32 v215, 0x7ff00000
    v_mfma_f32_16x16x32_bf16 v[116:119], a[68:71], a[44:47], v[116:119]
    ds_read_b64_tr_b16 a[86:87], v197 offset:49408
    v_cmp_gt_u32 s[56:57], s39, v255
    v_mfma_f32_16x16x32_bf16 v[120:123], a[64:67], a[48:51], v[120:123]
    v_lshlrev_b32 v213, 16, v218
    v_lshlrev_b32 v214, 16, v226
    v_mfma_f32_16x16x32_bf16 v[120:123], a[68:71], a[52:55], v[120:123]
    v_cndmask_b32 v249, v215, v249, s[56:57]
    v_fmac_f32 v208, v212, v213
    v_mfma_f32_16x16x32_bf16 v[124:127], a[64:67], a[56:59], v[124:127]
    v_fmac_f32 v209, v212, v214
    v_and_b32 v234, s59, v234
    v_mfma_f32_16x16x32_bf16 v[124:127], a[68:71], a[60:63], v[124:127]
    v_and_b32 v218, s59, v218
    v_and_b32 v226, s59, v226
    s_waitcnt lgkmcnt(4)
    v_mfma_f32_16x16x32_bf16 v[128:131], a[72:75], a[32:35], v[128:131]
    ds_read_b64_tr_b16 a[88:89], v198 offset:43008
    v_fmac_f32 v208, v234, v218
    v_mfma_f32_16x16x32_bf16 v[128:131], a[76:79], a[36:39], v[128:131]
    ds_read_b64_tr_b16 a[90:91], v198 offset:43264
    v_fmac_f32 v209, v234, v226
    v_mfma_f32_16x16x32_bf16 v[132:135], a[72:75], a[40:43], v[132:135]
    ds_read_b64_tr_b16 a[92:93], v198 offset:49152
    v_lshlrev_b32 v212, 16, v235
    v_mfma_f32_16x16x32_bf16 v[132:135], a[76:79], a[44:47], v[132:135]
    ds_read_b64_tr_b16 a[94:95], v198 offset:49408
    v_lshlrev_b32 v213, 16, v219
    v_mfma_f32_16x16x32_bf16 v[136:139], a[72:75], a[48:51], v[136:139]
    v_lshlrev_b32 v214, 16, v227
    v_fmac_f32 v208, v212, v213
    v_mfma_f32_16x16x32_bf16 v[136:139], a[76:79], a[52:55], v[136:139]
    v_fmac_f32 v209, v212, v214
    v_and_b32 v235, s59, v235
    v_mfma_f32_16x16x32_bf16 v[140:143], a[72:75], a[56:59], v[140:143]
    v_and_b32 v219, s59, v219
    v_and_b32 v227, s59, v227
    v_mfma_f32_16x16x32_bf16 v[140:143], a[76:79], a[60:63], v[140:143]
    v_fmac_f32 v208, v235, v219
    v_fmac_f32 v209, v235, v227
    s_waitcnt lgkmcnt(4)
    v_mfma_f32_16x16x32_bf16 v[144:147], a[32:35], a[80:83], v[144:147]
    ds_read_b64_tr_b16 a[64:65], v197 offset:40960
    v_lshlrev_b32 v212, 16, v236
    v_mfma_f32_16x16x32_bf16 v[144:147], a[36:39], a[84:87], v[144:147]
    ds_read_b64_tr_b16 a[66:67], v197 offset:41216
    v_cvt_pk_bf16_f32 v180, v112, v113
    v_mfma_f32_16x16x32_bf16 v[148:151], a[40:43], a[80:83], v[148:151]
    ds_read_b64_tr_b16 a[68:69], v197 offset:47104
    v_cvt_pk_bf16_f32 v181, v114, v115
    v_mfma_f32_16x16x32_bf16 v[148:151], a[44:47], a[84:87], v[148:151]
    ds_read_b64_tr_b16 a[70:71], v197 offset:47360
    v_cvt_pk_bf16_f32 v182, v128, v129
    v_mfma_f32_16x16x32_bf16 v[152:155], a[48:51], a[80:83], v[152:155]
    v_cvt_pk_bf16_f32 v183, v130, v131
    v_mfma_f32_16x16x32_bf16 v[152:155], a[52:55], a[84:87], v[152:155]
    buffer_store_dwordx4 v[180:183], v192, s[16:19], 0 offen offset:0 sc1
    ds_write_b128 v204, v[180:183] offset:0
    v_cvt_pk_bf16_f32 v184, v116, v117
    v_mfma_f32_16x16x32_bf16 v[156:159], a[56:59], a[80:83], v[156:159]
    v_cvt_pk_bf16_f32 v185, v118, v119
    v_cvt_pk_bf16_f32 v186, v132, v133
    v_mfma_f32_16x16x32_bf16 v[156:159], a[60:63], a[84:87], v[156:159]
    v_cvt_pk_bf16_f32 v187, v134, v135
    s_waitcnt lgkmcnt(5)
    v_mfma_f32_16x16x32_bf16 v[160:163], a[32:35], a[88:91], v[160:163]
    ds_read_b64_tr_b16 a[72:73], v198 offset:40960
    buffer_store_dwordx4 v[184:187], v192, s[16:19], 0 offen offset:1024 sc1
    v_mfma_f32_16x16x32_bf16 v[160:163], a[36:39], a[92:95], v[160:163]
    ds_read_b64_tr_b16 a[74:75], v198 offset:41216
    ds_write_b128 v204, v[184:187] offset:64
    v_cvt_pk_bf16_f32 v188, v120, v121
    v_mfma_f32_16x16x32_bf16 v[164:167], a[40:43], a[88:91], v[164:167]
    ds_read_b64_tr_b16 a[76:77], v198 offset:47104
    v_cvt_pk_bf16_f32 v189, v122, v123
    v_mfma_f32_16x16x32_bf16 v[164:167], a[44:47], a[92:95], v[164:167]
    ds_read_b64_tr_b16 a[78:79], v198 offset:47360
    v_cvt_pk_bf16_f32 v190, v136, v137
    v_mfma_f32_16x16x32_bf16 v[168:171], a[48:51], a[88:91], v[168:171]
    v_cvt_pk_bf16_f32 v191, v138, v139
    v_mfma_f32_16x16x32_bf16 v[168:171], a[52:55], a[92:95], v[168:171]
    buffer_store_dwordx4 v[188:191], v192, s[16:19], 0 offen offset:2048 sc1
    ds_write_b128 v204, v[188:191] offset:2048
    v_cvt_pk_bf16_f32 v176, v124, v125
    v_mfma_f32_16x16x32_bf16 v[172:175], a[56:59], a[88:91], v[172:175]
    v_cvt_pk_bf16_f32 v177, v126, v127
    v_cvt_pk_bf16_f32 v178, v140, v141
    v_mfma_f32_16x16x32_bf16 v[172:175], a[60:63], a[92:95], v[172:175]
    v_cvt_pk_bf16_f32 v179, v142, v143
    s_waitcnt lgkmcnt(7)
    v_mfma_f32_16x16x32_bf16 a[208:211], a[64:67], a[32:35], a[208:211]
    ds_read_b64_tr_b16 a[80:81], v196 offset:40960
    buffer_store_dwordx4 v[176:179], v192, s[16:19], 0 offen offset:3072 sc1
    v_mfma_f32_16x16x32_bf16 a[208:211], a[68:71], a[36:39], a[208:211]
    ds_read_b64_tr_b16 a[82:83], v196 offset:42752
    ds_write_b128 v204, v[176:179] offset:2112
    v_cvt_pk_bf16_f32 v180, v144, v145
    v_mfma_f32_16x16x32_bf16 a[212:215], a[64:67], a[40:43], a[212:215]
    ds_read_b64_tr_b16 a[84:85], v196 offset:48128
    v_cvt_pk_bf16_f32 v181, v146, v147
    v_mfma_f32_16x16x32_bf16 a[212:215], a[68:71], a[44:47], a[212:215]
    ds_read_b64_tr_b16 a[86:87], v196 offset:49920
    v_cvt_pk_bf16_f32 v182, v148, v149
    v_mfma_f32_16x16x32_bf16 a[216:219], a[64:67], a[48:51], a[216:219]
    v_cvt_pk_bf16_f32 v183, v150, v151
    v_mfma_f32_16x16x32_bf16 a[216:219], a[68:71], a[52:55], a[216:219]
    buffer_store_dwordx4 v[180:183], v193, s[16:19], 0 offen offset:0 sc1
    ds_write_b128 v205, v[180:183] offset:8192
    v_cvt_pk_bf16_f32 v184, v152, v153
    v_mfma_f32_16x16x32_bf16 a[220:223], a[64:67], a[56:59], a[220:223]
    v_cvt_pk_bf16_f32 v185, v154, v155
    v_cvt_pk_bf16_f32 v186, v156, v157
    v_mfma_f32_16x16x32_bf16 a[220:223], a[68:71], a[60:63], a[220:223]
    v_cvt_pk_bf16_f32 v187, v158, v159
    s_waitcnt lgkmcnt(7)
    v_mfma_f32_16x16x32_bf16 a[224:227], a[72:75], a[32:35], a[224:227]
    ds_read_b64_tr_b16 a[88:89], v196 offset:55296
    buffer_store_dwordx4 v[184:187], v193, s[16:19], 0 offen offset:2048 sc1
    v_mfma_f32_16x16x32_bf16 a[224:227], a[76:79], a[36:39], a[224:227]
    ds_read_b64_tr_b16 a[90:91], v196 offset:57088
    ds_write_b128 v205, v[184:187] offset:10240
    v_cvt_pk_bf16_f32 v188, v160, v161
    v_mfma_f32_16x16x32_bf16 a[228:231], a[72:75], a[40:43], a[228:231]
    ds_read_b64_tr_b16 a[92:93], v196 offset:62464
    v_cvt_pk_bf16_f32 v189, v162, v163
    v_mfma_f32_16x16x32_bf16 a[228:231], a[76:79], a[44:47], a[228:231]
    ds_read_b64_tr_b16 a[94:95], v196 offset:64256
    v_cvt_pk_bf16_f32 v190, v164, v165
    v_mfma_f32_16x16x32_bf16 a[232:235], a[72:75], a[48:51], a[232:235]
    v_cvt_pk_bf16_f32 v191, v166, v167
    v_mfma_f32_16x16x32_bf16 a[232:235], a[76:79], a[52:55], a[232:235]
    buffer_store_dwordx4 v[188:191], v193, s[16:19], 0 offen offset:256 sc1
    ds_write_b128 v205, v[188:191] offset:8448
    v_cvt_pk_bf16_f32 v176, v168, v169
    v_mfma_f32_16x16x32_bf16 a[236:239], a[72:75], a[56:59], a[236:239]
    v_cvt_pk_bf16_f32 v177, v170, v171
    v_cvt_pk_bf16_f32 v178, v172, v173
    v_mfma_f32_16x16x32_bf16 a[236:239], a[76:79], a[60:63], a[236:239]
    v_cvt_pk_bf16_f32 v179, v174, v175
    s_waitcnt lgkmcnt(7)
    v_mfma_f32_16x16x32_bf16 v[0:3], a[80:83], a[32:35], v[0:3]
    ds_read_b64_tr_b16 a[64:65], v196 offset:32
    buffer_store_dwordx4 v[176:179], v193, s[16:19], 0 offen offset:2304 sc1
    v_mfma_f32_16x16x32_bf16 v[0:3], a[84:87], a[36:39], v[0:3]
    ds_read_b64_tr_b16 a[66:67], v196 offset:1824
    ds_write_b128 v205, v[176:179] offset:10496
    v_accvgpr_read_b32 v112, a208
    v_mfma_f32_16x16x32_bf16 v[4:7], a[80:83], a[40:43], v[4:7]
    ds_read_b64_tr_b16 a[68:69], v196 offset:7200
    v_accvgpr_read_b32 v113, a209
    v_mfma_f32_16x16x32_bf16 v[4:7], a[84:87], a[44:47], v[4:7]
    ds_read_b64_tr_b16 a[70:71], v196 offset:8992
    v_accvgpr_read_b32 v114, a210
    v_mfma_f32_16x16x32_bf16 v[8:11], a[80:83], a[48:51], v[8:11]
    v_accvgpr_read_b32 v115, a211
    v_accvgpr_read_b32 v116, a224
    v_mfma_f32_16x16x32_bf16 v[8:11], a[84:87], a[52:55], v[8:11]
    v_accvgpr_read_b32 v117, a225
    v_accvgpr_read_b32 v118, a226
    v_mfma_f32_16x16x32_bf16 v[12:15], a[80:83], a[56:59], v[12:15]
    v_accvgpr_read_b32 v119, a227
    v_mul_f32 v112, s58, v112
    v_mfma_f32_16x16x32_bf16 v[12:15], a[84:87], a[60:63], v[12:15]
    v_mul_f32 v113, s58, v113
    v_mul_f32 v114, s58, v114
    s_waitcnt lgkmcnt(6)
    v_mfma_f32_16x16x32_bf16 a[96:99], a[88:91], a[32:35], a[96:99]
    ds_read_b64_tr_b16 a[72:73], v196 offset:40992
    v_mul_f32 v115, s58, v115
    v_mfma_f32_16x16x32_bf16 a[96:99], a[92:95], a[36:39], a[96:99]
    ds_read_b64_tr_b16 a[74:75], v196 offset:42784
    v_mul_f32 v116, s58, v116
    v_mfma_f32_16x16x32_bf16 a[100:103], a[88:91], a[40:43], a[100:103]
    ds_read_b64_tr_b16 a[76:77], v196 offset:48160
    v_mul_f32 v117, s58, v117
    v_mfma_f32_16x16x32_bf16 a[100:103], a[92:95], a[44:47], a[100:103]
    ds_read_b64_tr_b16 a[78:79], v196 offset:49952
    v_mul_f32 v118, s58, v118
    v_mfma_f32_16x16x32_bf16 a[104:107], a[88:91], a[48:51], a[104:107]
    v_mul_f32 v119, s58, v119
    v_cvt_pk_bf16_f32 v180, v112, v113
    v_mfma_f32_16x16x32_bf16 a[104:107], a[92:95], a[52:55], a[104:107]
    v_cvt_pk_bf16_f32 v181, v114, v115
    v_cvt_pk_bf16_f32 v182, v116, v117
    v_mfma_f32_16x16x32_bf16 a[108:111], a[88:91], a[56:59], a[108:111]
    v_cvt_pk_bf16_f32 v183, v118, v119
    v_mfma_f32_16x16x32_bf16 a[108:111], a[92:95], a[60:63], a[108:111]
    ds_write_b128 v206, v[180:183] offset:0
    v_accvgpr_read_b32 v120, a212
    s_waitcnt lgkmcnt(5)
    v_mfma_f32_16x16x32_bf16 v[16:19], a[64:67], a[0:3], v[16:19]
    ds_read_b64_tr_b16 a[80:81], v196 offset:14368
    v_accvgpr_read_b32 v121, a213
    v_mfma_f32_16x16x32_bf16 v[16:19], a[68:71], a[4:7], v[16:19]
    ds_read_b64_tr_b16 a[82:83], v196 offset:16160
    v_accvgpr_read_b32 v122, a214
    v_mfma_f32_16x16x32_bf16 v[20:23], a[64:67], a[8:11], v[20:23]
    ds_read_b64_tr_b16 a[84:85], v196 offset:21536
    v_accvgpr_read_b32 v123, a215
    v_mfma_f32_16x16x32_bf16 v[20:23], a[68:71], a[12:15], v[20:23]
    ds_read_b64_tr_b16 a[86:87], v196 offset:23328
    v_accvgpr_read_b32 v124, a228
    v_mfma_f32_16x16x32_bf16 v[24:27], a[64:67], a[16:19], v[24:27]
    v_accvgpr_read_b32 v125, a229
    v_accvgpr_read_b32 v126, a230
    v_mfma_f32_16x16x32_bf16 v[24:27], a[68:71], a[20:23], v[24:27]
    v_accvgpr_read_b32 v127, a231
    v_mul_f32 v120, s58, v120
    v_mfma_f32_16x16x32_bf16 v[28:31], a[64:67], a[24:27], v[28:31]
    v_mul_f32 v121, s58, v121
    v_mul_f32 v122, s58, v122
    v_mfma_f32_16x16x32_bf16 v[28:31], a[68:71], a[28:31], v[28:31]
    v_mul_f32 v123, s58, v123
    v_mul_f32 v124, s58, v124
    s_waitcnt lgkmcnt(5)
    v_mfma_f32_16x16x32_bf16 v[16:19], a[72:75], a[32:35], v[16:19]
    ds_read_b64_tr_b16 a[88:89], v196 offset:55328
    v_mul_f32 v125, s58, v125
    v_mfma_f32_16x16x32_bf16 v[16:19], a[76:79], a[36:39], v[16:19]
    ds_read_b64_tr_b16 a[90:91], v196 offset:57120
    v_mul_f32 v126, s58, v126
    v_mfma_f32_16x16x32_bf16 v[20:23], a[72:75], a[40:43], v[20:23]
    ds_read_b64_tr_b16 a[92:93], v196 offset:62496
    v_mul_f32 v127, s58, v127
    v_mfma_f32_16x16x32_bf16 v[20:23], a[76:79], a[44:47], v[20:23]
    ds_read_b64_tr_b16 a[94:95], v196 offset:64288
    v_cvt_pk_bf16_f32 v184, v120, v121
    v_mfma_f32_16x16x32_bf16 v[24:27], a[72:75], a[48:51], v[24:27]
    v_cvt_pk_bf16_f32 v185, v122, v123
    v_cvt_pk_bf16_f32 v186, v124, v125
    v_mfma_f32_16x16x32_bf16 v[24:27], a[76:79], a[52:55], v[24:27]
    v_cvt_pk_bf16_f32 v187, v126, v127
    v_mfma_f32_16x16x32_bf16 v[28:31], a[72:75], a[56:59], v[28:31]
    ds_write_b128 v206, v[184:187] offset:64
    v_accvgpr_read_b32 v112, a216
    v_mfma_f32_16x16x32_bf16 v[28:31], a[76:79], a[60:63], v[28:31]
    v_accvgpr_read_b32 v113, a217
    v_accvgpr_read_b32 v114, a218
    s_waitcnt lgkmcnt(5)
    v_mfma_f32_16x16x32_bf16 a[112:115], a[80:83], a[0:3], a[112:115]
    ds_read_b64_tr_b16 a[64:65], v196 offset:64
    v_accvgpr_read_b32 v115, a219
    v_mfma_f32_16x16x32_bf16 a[112:115], a[84:87], a[4:7], a[112:115]
    ds_read_b64_tr_b16 a[66:67], v196 offset:1856
    v_accvgpr_read_b32 v116, a232
    v_mfma_f32_16x16x32_bf16 a[116:119], a[80:83], a[8:11], a[116:119]
    ds_read_b64_tr_b16 a[68:69], v196 offset:7232
    v_accvgpr_read_b32 v117, a233
    v_mfma_f32_16x16x32_bf16 a[116:119], a[84:87], a[12:15], a[116:119]
    ds_read_b64_tr_b16 a[70:71], v196 offset:9024
    v_accvgpr_read_b32 v118, a234
    v_mfma_f32_16x16x32_bf16 a[120:123], a[80:83], a[16:19], a[120:123]
    v_accvgpr_read_b32 v119, a235
    v_mul_f32 v112, s58, v112
    v_mfma_f32_16x16x32_bf16 a[120:123], a[84:87], a[20:23], a[120:123]
    v_mul_f32 v113, s58, v113
    v_mul_f32 v114, s58, v114
    v_mfma_f32_16x16x32_bf16 a[124:127], a[80:83], a[24:27], a[124:127]
    v_mul_f32 v115, s58, v115
    v_mul_f32 v116, s58, v116
    v_mfma_f32_16x16x32_bf16 a[124:127], a[84:87], a[28:31], a[124:127]
    v_mul_f32 v117, s58, v117
    v_mul_f32 v118, s58, v118
    s_waitcnt lgkmcnt(5)
    v_mfma_f32_16x16x32_bf16 a[112:115], a[88:91], a[32:35], a[112:115]
    ds_read_b64_tr_b16 a[72:73], v196 offset:41024
    v_mul_f32 v119, s58, v119
    v_mfma_f32_16x16x32_bf16 a[112:115], a[92:95], a[36:39], a[112:115]
    ds_read_b64_tr_b16 a[74:75], v196 offset:42816
    v_cvt_pk_bf16_f32 v188, v112, v113
    v_mfma_f32_16x16x32_bf16 a[116:119], a[88:91], a[40:43], a[116:119]
    ds_read_b64_tr_b16 a[76:77], v196 offset:48192
    v_cvt_pk_bf16_f32 v189, v114, v115
    v_mfma_f32_16x16x32_bf16 a[116:119], a[92:95], a[44:47], a[116:119]
    ds_read_b64_tr_b16 a[78:79], v196 offset:49984
    v_cvt_pk_bf16_f32 v190, v116, v117
    v_mfma_f32_16x16x32_bf16 a[120:123], a[88:91], a[48:51], a[120:123]
    v_cvt_pk_bf16_f32 v191, v118, v119
    v_mfma_f32_16x16x32_bf16 a[120:123], a[92:95], a[52:55], a[120:123]
    ds_write_b128 v206, v[188:191] offset:2048
    v_accvgpr_read_b32 v120, a220
    v_mfma_f32_16x16x32_bf16 a[124:127], a[88:91], a[56:59], a[124:127]
    v_accvgpr_read_b32 v121, a221
    v_accvgpr_read_b32 v122, a222
    v_mfma_f32_16x16x32_bf16 a[124:127], a[92:95], a[60:63], a[124:127]
    v_accvgpr_read_b32 v123, a223
    v_accvgpr_read_b32 v124, a236
p2_code:
    s_waitcnt lgkmcnt(5)
    v_mfma_f32_16x16x32_bf16 v[32:35], a[64:67], a[0:3], v[32:35]
    ds_read_b64_tr_b16 a[80:81], v196 offset:14400
    v_accvgpr_read_b32 v125, a237
    v_mfma_f32_16x16x32_bf16 v[32:35], a[68:71], a[4:7], v[32:35]
    ds_read_b64_tr_b16 a[82:83], v196 offset:16192
    v_accvgpr_read_b32 v126, a238
    v_mfma_f32_16x16x32_bf16 v[36:39], a[64:67], a[8:11], v[36:39]
    ds_read_b64_tr_b16 a[84:85], v196 offset:21568
    v_accvgpr_read_b32 v127, a239
    v_mfma_f32_16x16x32_bf16 v[36:39], a[68:71], a[12:15], v[36:39]
    ds_read_b64_tr_b16 a[86:87], v196 offset:23360
    v_mul_f32 v120, s58, v120
    v_mfma_f32_16x16x32_bf16 v[40:43], a[64:67], a[16:19], v[40:43]
    v_mul_f32 v121, s58, v121
    v_mul_f32 v122, s58, v122
    v_mfma_f32_16x16x32_bf16 v[40:43], a[68:71], a[20:23], v[40:43]
    v_mul_f32 v123, s58, v123
    v_mul_f32 v124, s58, v124
    v_mfma_f32_16x16x32_bf16 v[44:47], a[64:67], a[24:27], v[44:47]
    v_mul_f32 v125, s58, v125
    v_mul_f32 v126, s58, v126
    v_mfma_f32_16x16x32_bf16 v[44:47], a[68:71], a[28:31], v[44:47]
    v_mul_f32 v127, s58, v127
    v_cvt_pk_bf16_f32 v176, v120, v121
    s_waitcnt lgkmcnt(5)
    v_mfma_f32_16x16x32_bf16 v[32:35], a[72:75], a[32:35], v[32:35]
    ds_read_b64_tr_b16 a[88:89], v196 offset:55360
    v_cvt_pk_bf16_f32 v177, v122, v123
    v_mfma_f32_16x16x32_bf16 v[32:35], a[76:79], a[36:39], v[32:35]
    ds_read_b64_tr_b16 a[90:91], v196 offset:57152
    v_cvt_pk_bf16_f32 v178, v124, v125
    v_mfma_f32_16x16x32_bf16 v[36:39], a[72:75], a[40:43], v[36:39]
    ds_read_b64_tr_b16 a[92:93], v196 offset:62528
    v_cvt_pk_bf16_f32 v179, v126, v127
    v_mfma_f32_16x16x32_bf16 v[36:39], a[76:79], a[44:47], v[36:39]
    ds_read_b64_tr_b16 a[94:95], v196 offset:64320
    ds_write_b128 v206, v[176:179] offset:2112
    v_lshlrev_b32 v213, 16, v220
    v_mfma_f32_16x16x32_bf16 v[40:43], a[72:75], a[48:51], v[40:43]
    v_lshlrev_b32 v214, 16, v228
    v_fmac_f32 v208, v212, v213
    v_mfma_f32_16x16x32_bf16 v[40:43], a[76:79], a[52:55], v[40:43]
    v_fmac_f32 v209, v212, v214
    v_and_b32 v236, s59, v236
    v_mfma_f32_16x16x32_bf16 v[44:47], a[72:75], a[56:59], v[44:47]
    v_and_b32 v220, s59, v220
    v_and_b32 v228, s59, v228
    v_mfma_f32_16x16x32_bf16 v[44:47], a[76:79], a[60:63], v[44:47]
    v_fmac_f32 v208, v236, v220
    v_fmac_f32 v209, v236, v228
    s_waitcnt lgkmcnt(5)
    v_mfma_f32_16x16x32_bf16 a[128:131], a[80:83], a[0:3], a[128:131]
    ds_read_b64_tr_b16 a[64:65], v196 offset:96
    v_lshlrev_b32 v212, 16, v237
    v_mfma_f32_16x16x32_bf16 a[128:131], a[84:87], a[4:7], a[128:131]
    ds_read_b64_tr_b16 a[66:67], v196 offset:1888
    v_lshlrev_b32 v213, 16, v221
    v_mfma_f32_16x16x32_bf16 a[132:135], a[80:83], a[8:11], a[132:135]
    ds_read_b64_tr_b16 a[68:69], v196 offset:7264
    v_lshlrev_b32 v214, 16, v229
    v_mfma_f32_16x16x32_bf16 a[132:135], a[84:87], a[12:15], a[132:135]
    ds_read_b64_tr_b16 a[70:71], v196 offset:9056
    v_fmac_f32 v208, v212, v213
    v_mfma_f32_16x16x32_bf16 a[136:139], a[80:83], a[16:19], a[136:139]
    v_fmac_f32 v209, v212, v214
    v_and_b32 v237, s59, v237
    v_mfma_f32_16x16x32_bf16 a[136:139], a[84:87], a[20:23], a[136:139]
    v_and_b32 v221, s59, v221
    v_and_b32 v229, s59, v229
    v_mfma_f32_16x16x32_bf16 a[140:143], a[80:83], a[24:27], a[140:143]
    v_fmac_f32 v208, v237, v221
    v_fmac_f32 v209, v237, v229
    v_mfma_f32_16x16x32_bf16 a[140:143], a[84:87], a[28:31], a[140:143]
    v_lshlrev_b32 v212, 16, v238
    v_lshlrev_b32 v213, 16, v222
    s_waitcnt lgkmcnt(5)
    v_mfma_f32_16x16x32_bf16 a[128:131], a[88:91], a[32:35], a[128:131]
    ds_read_b64_tr_b16 a[72:73], v196 offset:41056
    v_lshlrev_b32 v214, 16, v230
    v_mfma_f32_16x16x32_bf16 a[128:131], a[92:95], a[36:39], a[128:131]
    ds_read_b64_tr_b16 a[74:75], v196 offset:42848
    v_fmac_f32 v208, v212, v213
    v_mfma_f32_16x16x32_bf16 a[132:135], a[88:91], a[40:43], a[132:135]
    ds_read_b64_tr_b16 a[76:77], v196 offset:48224
    v_fmac_f32 v209, v212, v214
    v_mfma_f32_16x16x32_bf16 a[132:135], a[92:95], a[44:47], a[132:135]
    ds_read_b64_tr_b16 a[78:79], v196 offset:50016
    v_and_b32 v238, s59, v238
    v_mfma_f32_16x16x32_bf16 a[136:139], a[88:91], a[48:51], a[136:139]
    v_and_b32 v222, s59, v222
    v_and_b32 v230, s59, v230
    v_mfma_f32_16x16x32_bf16 a[136:139], a[92:95], a[52:55], a[136:139]
    v_fmac_f32 v208, v238, v222
    v_fmac_f32 v209, v238, v230
    v_mfma_f32_16x16x32_bf16 a[140:143], a[88:91], a[56:59], a[140:143]
    s_waitcnt vmcnt(0)
    v_readfirstlane_b32 s62, v251
    s_nop 0
    s_cmp_ge_u32 s62, 32
    s_cbranch_scc0 init_spin
init_ok:
    buffer_atomic_add v253, v252, s[16:19], s74 offen sc1
    v_lshlrev_b32 v212, 16, v239
    v_lshlrev_b32 v213, 16, v223
    v_mfma_f32_16x16x32_bf16 a[140:143], a[92:95], a[60:63], a[140:143]
    v_lshlrev_b32 v214, 16, v231
    v_fmac_f32 v208, v212, v213
    s_waitcnt lgkmcnt(4)
    v_mfma_f32_16x16x32_bf16 v[48:51], a[64:67], a[0:3], v[48:51]
    ds_read_b64_tr_b16 a[80:81], v196 offset:14432
    v_fmac_f32 v209, v212, v214
    v_mfma_f32_16x16x32_bf16 v[48:51], a[68:71], a[4:7], v[48:51]
    ds_read_b64_tr_b16 a[82:83], v196 offset:16224
    v_and_b32 v239, s59, v239
    v_mfma_f32_16x16x32_bf16 v[52:55], a[64:67], a[8:11], v[52:55]
    ds_read_b64_tr_b16 a[84:85], v196 offset:21600
    v_and_b32 v223, s59, v223
    v_mfma_f32_16x16x32_bf16 v[52:55], a[68:71], a[12:15], v[52:55]
    ds_read_b64_tr_b16 a[86:87], v196 offset:23392
    v_and_b32 v231, s59, v231
    v_mfma_f32_16x16x32_bf16 v[56:59], a[64:67], a[16:19], v[56:59]
    v_fmac_f32 v208, v239, v223
    v_fmac_f32 v209, v239, v231
    v_mfma_f32_16x16x32_bf16 v[56:59], a[68:71], a[20:23], v[56:59]
    v_mov_b32 v210, 0x7ff00000
    v_cmp_eq_u32 vcc, 63, v255
    v_mfma_f32_16x16x32_bf16 v[60:63], a[64:67], a[24:27], v[60:63]
    v_add_f32_dpp v208, v208, v208 row_shr:1 bound_ctrl:0
    v_add_f32_dpp v209, v209, v209 row_shr:1 bound_ctrl:0
    v_mfma_f32_16x16x32_bf16 v[60:63], a[68:71], a[28:31], v[60:63]
    v_add_f32_dpp v208, v208, v208 row_shr:2 bound_ctrl:0
    v_add_f32_dpp v209, v209, v209 row_shr:2 bound_ctrl:0
    s_waitcnt lgkmcnt(4)
    v_mfma_f32_16x16x32_bf16 v[48:51], a[72:75], a[32:35], v[48:51]
    ds_read_b64_tr_b16 a[88:89], v196 offset:55392
    v_add_f32_dpp v208, v208, v208 row_shr:4 bound_ctrl:0
    v_mfma_f32_16x16x32_bf16 v[48:51], a[76:79], a[36:39], v[48:51]
    ds_read_b64_tr_b16 a[90:91], v196 offset:57184
    v_add_f32_dpp v209, v209, v209 row_shr:4 bound_ctrl:0
    v_mfma_f32_16x16x32_bf16 v[52:55], a[72:75], a[40:43], v[52:55]
    ds_read_b64_tr_b16 a[92:93], v196 offset:62560
    v_add_f32_dpp v208, v208, v208 row_shr:8 bound_ctrl:0
    v_mfma_f32_16x16x32_bf16 v[52:55], a[76:79], a[44:47], v[52:55]
    ds_read_b64_tr_b16 a[94:95], v196 offset:64352
    v_add_f32_dpp v209, v209, v209 row_shr:8 bound_ctrl:0
    v_mfma_f32_16x16x32_bf16 v[56:59], a[72:75], a[48:51], v[56:59]
    v_add_f32_dpp v208, v208, v208 row_bcast:15 row_mask:0xa
    v_add_f32_dpp v209, v209, v209 row_bcast:15 row_mask:0xa
    v_mfma_f32_16x16x32_bf16 v[56:59], a[76:79], a[52:55], v[56:59]
    v_add_f32_dpp v208, v208, v208 row_bcast:31 row_mask:0xc
    v_add_f32_dpp v209, v209, v209 row_bcast:31 row_mask:0xc
    v_mfma_f32_16x16x32_bf16 v[60:63], a[72:75], a[56:59], v[60:63]
    v_mul_f32 v208, 0xbfb8aa3b, v208
    v_mul_f32 v209, 0xbfb8aa3b, v209
    v_mfma_f32_16x16x32_bf16 v[60:63], a[76:79], a[60:63], v[60:63]
    v_exp_f32 v208, v208
    v_exp_f32 v209, v209
    s_waitcnt lgkmcnt(4)
    v_mfma_f32_16x16x32_bf16 a[144:147], a[80:83], a[0:3], a[144:147]
    ds_read_b64_tr_b16 a[64:65], v196 offset:128
    v_add_f32 v208, 1.0, v208
    v_mfma_f32_16x16x32_bf16 a[144:147], a[84:87], a[4:7], a[144:147]
    ds_read_b64_tr_b16 a[66:67], v196 offset:1920
    v_add_f32 v209, 1.0, v209
    v_mfma_f32_16x16x32_bf16 a[148:151], a[80:83], a[8:11], a[148:151]
    ds_read_b64_tr_b16 a[68:69], v196 offset:7296
    v_rcp_f32 v208, v208
    v_mfma_f32_16x16x32_bf16 a[148:151], a[84:87], a[12:15], a[148:151]
    ds_read_b64_tr_b16 a[70:71], v196 offset:9088
    v_rcp_f32 v209, v209
    v_mfma_f32_16x16x32_bf16 a[152:155], a[80:83], a[16:19], a[152:155]
    v_cndmask_b32 v210, v210, 0, vcc
    v_mfma_f32_16x16x32_bf16 a[152:155], a[84:87], a[20:23], a[152:155]
    buffer_store_dwordx2 v[208:209], v210, s[16:19], s41 offen sc1
    v_mfma_f32_16x16x32_bf16 a[156:159], a[80:83], a[24:27], a[156:159]
    v_accvgpr_read_b32 v212, a96
    v_accvgpr_read_b32 v213, a97
    v_mfma_f32_16x16x32_bf16 a[156:159], a[84:87], a[28:31], a[156:159]
    v_accvgpr_read_b32 v214, a98
    v_accvgpr_read_b32 v215, a99
    s_waitcnt lgkmcnt(4)
    v_mfma_f32_16x16x32_bf16 a[144:147], a[88:91], a[32:35], a[144:147]
    ds_read_b64_tr_b16 a[72:73], v196 offset:41088
    v_mul_f32 v212, v212, v0
    v_mfma_f32_16x16x32_bf16 a[144:147], a[92:95], a[36:39], a[144:147]
    ds_read_b64_tr_b16 a[74:75], v196 offset:42880
    v_mul_f32 v213, v213, v1
    v_mfma_f32_16x16x32_bf16 a[148:151], a[88:91], a[40:43], a[148:151]
    ds_read_b64_tr_b16 a[76:77], v196 offset:48256
    v_mul_f32 v214, v214, v2
    v_mfma_f32_16x16x32_bf16 a[148:151], a[92:95], a[44:47], a[148:151]
    ds_read_b64_tr_b16 a[78:79], v196 offset:50048
    v_mul_f32 v215, v215, v3
    v_mfma_f32_16x16x32_bf16 a[152:155], a[88:91], a[48:51], a[152:155]
    s_barrier
    v_add_u32 v136, s66, v254
    v_add_u32 v137, 65536, v254
    v_mfma_f32_16x16x32_bf16 a[152:155], a[92:95], a[52:55], a[152:155]
    ds_read_b128 a[240:243], v136 offset:0
    v_cvt_pk_bf16_f32 v144, v212, v213
    v_mfma_f32_16x16x32_bf16 a[156:159], a[88:91], a[56:59], a[156:159]
    ds_read_b128 a[244:247], v136 offset:1024
    v_cvt_pk_bf16_f32 v145, v214, v215
    v_mfma_f32_16x16x32_bf16 a[156:159], a[92:95], a[60:63], a[156:159]
    ds_read_b128 a[248:251], v136 offset:2048
    v_accvgpr_read_b32 v216, a100
    s_waitcnt lgkmcnt(7)
    v_mfma_f32_16x16x32_bf16 v[64:67], a[64:67], a[0:3], v[64:67]
    ds_read_b64_tr_b16 a[80:81], v196 offset:14464
    v_accvgpr_read_b32 v217, a101
    v_mfma_f32_16x16x32_bf16 v[64:67], a[68:71], a[4:7], v[64:67]
    ds_read_b64_tr_b16 a[82:83], v196 offset:16256
    v_accvgpr_read_b32 v218, a102
    v_mfma_f32_16x16x32_bf16 v[68:71], a[64:67], a[8:11], v[68:71]
    ds_read_b64_tr_b16 a[84:85], v196 offset:21632
    v_accvgpr_read_b32 v219, a103
    v_mfma_f32_16x16x32_bf16 v[68:71], a[68:71], a[12:15], v[68:71]
    ds_read_b64_tr_b16 a[86:87], v196 offset:23424
    v_mul_f32 v216, v216, v4
    v_mfma_f32_16x16x32_bf16 v[72:75], a[64:67], a[16:19], v[72:75]
    ds_read_b128 a[252:255], v136 offset:3072
    v_mul_f32 v217, v217, v5
    v_mfma_f32_16x16x32_bf16 v[72:75], a[68:71], a[20:23], v[72:75]
    ds_read_b128 a[208:211], v254 offset:0
    v_mul_f32 v218, v218, v6
    v_mfma_f32_16x16x32_bf16 v[76:79], a[64:67], a[24:27], v[76:79]
    ds_read_b128 a[212:215], v254 offset:1024
    v_mul_f32 v219, v219, v7
    v_mfma_f32_16x16x32_bf16 v[76:79], a[68:71], a[28:31], v[76:79]
    ds_read_b128 a[216:219], v254 offset:2048
    v_cvt_pk_bf16_f32 v148, v216, v217
    s_waitcnt lgkmcnt(11)
    v_mfma_f32_16x16x32_bf16 v[64:67], a[72:75], a[32:35], v[64:67]
    ds_read_b64_tr_b16 a[88:89], v196 offset:55424
    v_cvt_pk_bf16_f32 v149, v218, v219
    v_mfma_f32_16x16x32_bf16 v[64:67], a[76:79], a[36:39], v[64:67]
    ds_read_b64_tr_b16 a[90:91], v196 offset:57216
    v_accvgpr_read_b32 v220, a104
    v_mfma_f32_16x16x32_bf16 v[68:71], a[72:75], a[40:43], v[68:71]
    ds_read_b64_tr_b16 a[92:93], v196 offset:62592
    v_accvgpr_read_b32 v221, a105
    v_mfma_f32_16x16x32_bf16 v[68:71], a[76:79], a[44:47], v[68:71]
    ds_read_b64_tr_b16 a[94:95], v196 offset:64384
    v_accvgpr_read_b32 v222, a106
    v_mfma_f32_16x16x32_bf16 v[72:75], a[72:75], a[48:51], v[72:75]
    ds_read_b128 a[220:223], v254 offset:3072
    v_accvgpr_read_b32 v223, a107
    v_mfma_f32_16x16x32_bf16 v[72:75], a[76:79], a[52:55], v[72:75]
    ds_read_b128 a[224:227], v254 offset:8192
    v_mul_f32 v220, v220, v8
    v_mfma_f32_16x16x32_bf16 v[76:79], a[72:75], a[56:59], v[76:79]
    ds_read_b128 a[228:231], v254 offset:9216
    v_mul_f32 v221, v221, v9
    v_mfma_f32_16x16x32_bf16 v[76:79], a[76:79], a[60:63], v[76:79]
    v_mul_f32 v222, v222, v10
    v_mul_f32 v223, v223, v11
    s_waitcnt lgkmcnt(11)
    v_mfma_f32_16x16x32_bf16 a[160:163], a[80:83], a[0:3], a[160:163]
    ds_read_b64_tr_b16 a[64:65], v196 offset:160
    v_cvt_pk_bf16_f32 v152, v220, v221
    v_mfma_f32_16x16x32_bf16 a[160:163], a[84:87], a[4:7], a[160:163]
    ds_read_b64_tr_b16 a[66:67], v196 offset:1952
    v_cvt_pk_bf16_f32 v153, v222, v223
    v_mfma_f32_16x16x32_bf16 a[164:167], a[80:83], a[8:11], a[164:167]
    ds_read_b64_tr_b16 a[68:69], v196 offset:7328
    v_accvgpr_read_b32 v224, a108
    v_mfma_f32_16x16x32_bf16 a[164:167], a[84:87], a[12:15], a[164:167]
    ds_read_b64_tr_b16 a[70:71], v196 offset:9120
    v_accvgpr_read_b32 v225, a109
    v_mfma_f32_16x16x32_bf16 a[168:171], a[80:83], a[16:19], a[168:171]
    v_accvgpr_read_b32 v226, a110
    v_accvgpr_read_b32 v227, a111
    v_mfma_f32_16x16x32_bf16 a[168:171], a[84:87], a[20:23], a[168:171]
    v_mul_f32 v224, v224, v12
    v_mul_f32 v225, v225, v13
    v_mfma_f32_16x16x32_bf16 a[172:175], a[80:83], a[24:27], a[172:175]
    v_mul_f32 v226, v226, v14
    v_mul_f32 v227, v227, v15
    v_mfma_f32_16x16x32_bf16 a[172:175], a[84:87], a[28:31], a[172:175]
    v_cvt_pk_bf16_f32 v156, v224, v225
    v_cvt_pk_bf16_f32 v157, v226, v227
    s_waitcnt lgkmcnt(7)
    v_mfma_f32_16x16x32_bf16 a[160:163], a[88:91], a[32:35], a[160:163]
    ds_read_b64_tr_b16 a[72:73], v196 offset:41120
    v_accvgpr_read_b32 v228, a112
    v_mfma_f32_16x16x32_bf16 a[160:163], a[92:95], a[36:39], a[160:163]
    ds_read_b64_tr_b16 a[74:75], v196 offset:42912
    v_accvgpr_read_b32 v229, a113
    v_mfma_f32_16x16x32_bf16 a[164:167], a[88:91], a[40:43], a[164:167]
    ds_read_b64_tr_b16 a[76:77], v196 offset:48288
    v_accvgpr_read_b32 v230, a114
    v_mfma_f32_16x16x32_bf16 a[164:167], a[92:95], a[44:47], a[164:167]
    ds_read_b64_tr_b16 a[78:79], v196 offset:50080
    v_accvgpr_read_b32 v231, a115
    v_mfma_f32_16x16x32_bf16 a[168:171], a[88:91], a[48:51], a[168:171]
    v_mul_f32 v228, v228, v16
    v_mul_f32 v229, v229, v17
    v_mfma_f32_16x16x32_bf16 a[168:171], a[92:95], a[52:55], a[168:171]
    v_mul_f32 v230, v230, v18
    v_mul_f32 v231, v231, v19
    v_mfma_f32_16x16x32_bf16 a[172:175], a[88:91], a[56:59], a[172:175]
    v_cvt_pk_bf16_f32 v146, v228, v229
    v_cvt_pk_bf16_f32 v147, v230, v231
    v_mfma_f32_16x16x32_bf16 a[172:175], a[92:95], a[60:63], a[172:175]
    v_accvgpr_read_b32 v232, a116
    v_accvgpr_read_b32 v233, a117
    s_waitcnt lgkmcnt(4)
    v_mfma_f32_16x16x32_bf16 v[80:83], a[64:67], a[0:3], v[80:83]
    ds_read_b64_tr_b16 a[80:81], v196 offset:14496
    v_accvgpr_read_b32 v234, a118
    v_mfma_f32_16x16x32_bf16 v[80:83], a[68:71], a[4:7], v[80:83]
    ds_read_b64_tr_b16 a[82:83], v196 offset:16288
    v_accvgpr_read_b32 v235, a119
    v_mfma_f32_16x16x32_bf16 v[84:87], a[64:67], a[8:11], v[84:87]
    ds_read_b64_tr_b16 a[84:85], v196 offset:21664
    v_mul_f32 v232, v232, v20
    v_mfma_f32_16x16x32_bf16 v[84:87], a[68:71], a[12:15], v[84:87]
    ds_read_b64_tr_b16 a[86:87], v196 offset:23456
    v_mul_f32 v233, v233, v21
    v_mfma_f32_16x16x32_bf16 v[88:91], a[64:67], a[16:19], v[88:91]
    v_mul_f32 v234, v234, v22
    v_mul_f32 v235, v235, v23
    v_mfma_f32_16x16x32_bf16 v[88:91], a[68:71], a[20:23], v[88:91]
    v_cvt_pk_bf16_f32 v150, v232, v233
    v_cvt_pk_bf16_f32 v151, v234, v235
    v_mfma_f32_16x16x32_bf16 v[92:95], a[64:67], a[24:27], v[92:95]
    v_accvgpr_read_b32 v236, a120
    v_accvgpr_read_b32 v237, a121
    v_mfma_f32_16x16x32_bf16 v[92:95], a[68:71], a[28:31], v[92:95]
    v_accvgpr_read_b32 v238, a122
    v_accvgpr_read_b32 v239, a123
    s_waitcnt lgkmcnt(4)
    v_mfma_f32_16x16x32_bf16 v[80:83], a[72:75], a[32:35], v[80:83]
    ds_read_b64_tr_b16 a[88:89], v196 offset:55456
    v_mul_f32 v236, v236, v24
    v_mfma_f32_16x16x32_bf16 v[80:83], a[76:79], a[36:39], v[80:83]
    ds_read_b64_tr_b16 a[90:91], v196 offset:57248
    v_mul_f32 v237, v237, v25
    v_mfma_f32_16x16x32_bf16 v[84:87], a[72:75], a[40:43], v[84:87]
    ds_read_b64_tr_b16 a[92:93], v196 offset:62624
    v_mul_f32 v238, v238, v26
    v_mfma_f32_16x16x32_bf16 v[84:87], a[76:79], a[44:47], v[84:87]
    ds_read_b64_tr_b16 a[94:95], v196 offset:64416
    v_mul_f32 v239, v239, v27
    v_mfma_f32_16x16x32_bf16 v[88:91], a[72:75], a[48:51], v[88:91]
    v_cvt_pk_bf16_f32 v154, v236, v237
    v_cvt_pk_bf16_f32 v155, v238, v239
    v_mfma_f32_16x16x32_bf16 v[88:91], a[76:79], a[52:55], v[88:91]
    v_accvgpr_read_b32 v208, a124
    v_accvgpr_read_b32 v209, a125
    v_mfma_f32_16x16x32_bf16 v[92:95], a[72:75], a[56:59], v[92:95]
    v_accvgpr_read_b32 v210, a126
    v_accvgpr_read_b32 v211, a127
    v_mfma_f32_16x16x32_bf16 v[92:95], a[76:79], a[60:63], v[92:95]
    v_mul_f32 v208, v208, v28
    v_mul_f32 v209, v209, v29
    s_waitcnt lgkmcnt(4)
    v_mfma_f32_16x16x32_bf16 a[176:179], a[80:83], a[0:3], a[176:179]
    ds_read_b64_tr_b16 a[64:65], v196 offset:192
    v_mul_f32 v210, v210, v30
    v_mfma_f32_16x16x32_bf16 a[176:179], a[84:87], a[4:7], a[176:179]
    ds_read_b64_tr_b16 a[66:67], v196 offset:1984
    v_mul_f32 v211, v211, v31
    v_mfma_f32_16x16x32_bf16 a[180:183], a[80:83], a[8:11], a[180:183]
    ds_read_b64_tr_b16 a[68:69], v196 offset:7360
    v_cvt_pk_bf16_f32 v158, v208, v209
    v_mfma_f32_16x16x32_bf16 a[180:183], a[84:87], a[12:15], a[180:183]
    ds_read_b64_tr_b16 a[70:71], v196 offset:9152
    v_cvt_pk_bf16_f32 v159, v210, v211
    v_mfma_f32_16x16x32_bf16 a[184:187], a[80:83], a[16:19], a[184:187]
    v_accvgpr_read_b32 v212, a128
    v_accvgpr_read_b32 v213, a129
    v_mfma_f32_16x16x32_bf16 a[184:187], a[84:87], a[20:23], a[184:187]
    v_accvgpr_read_b32 v214, a130
    v_accvgpr_read_b32 v215, a131
    v_mfma_f32_16x16x32_bf16 a[188:191], a[80:83], a[24:27], a[188:191]
    v_mul_f32 v212, v212, v32
    v_mul_f32 v213, v213, v33
    v_mfma_f32_16x16x32_bf16 a[188:191], a[84:87], a[28:31], a[188:191]
    v_mul_f32 v214, v214, v34
    v_mul_f32 v215, v215, v35
    s_waitcnt lgkmcnt(4)
    v_mfma_f32_16x16x32_bf16 a[176:179], a[88:91], a[32:35], a[176:179]
    ds_read_b64_tr_b16 a[72:73], v196 offset:41152
    v_cvt_pk_bf16_f32 v160, v212, v213
    v_mfma_f32_16x16x32_bf16 a[176:179], a[92:95], a[36:39], a[176:179]
    ds_read_b64_tr_b16 a[74:75], v196 offset:42944
    v_cvt_pk_bf16_f32 v161, v214, v215
    v_mfma_f32_16x16x32_bf16 a[180:183], a[88:91], a[40:43], a[180:183]
    ds_read_b64_tr_b16 a[76:77], v196 offset:48320
    v_accvgpr_read_b32 v216, a132
    v_mfma_f32_16x16x32_bf16 a[180:183], a[92:95], a[44:47], a[180:183]
    ds_read_b64_tr_b16 a[78:79], v196 offset:50112
    v_accvgpr_read_b32 v217, a133
    v_mfma_f32_16x16x32_bf16 a[184:187], a[88:91], a[48:51], a[184:187]
    v_accvgpr_read_b32 v218, a134
    v_accvgpr_read_b32 v219, a135
    v_mfma_f32_16x16x32_bf16 a[184:187], a[92:95], a[52:55], a[184:187]
    v_mul_f32 v216, v216, v36
    v_mul_f32 v217, v217, v37
    v_mfma_f32_16x16x32_bf16 a[188:191], a[88:91], a[56:59], a[188:191]
    v_mul_f32 v218, v218, v38
    v_mul_f32 v219, v219, v39
    v_mfma_f32_16x16x32_bf16 a[188:191], a[92:95], a[60:63], a[188:191]
    v_cvt_pk_bf16_f32 v164, v216, v217
    v_cvt_pk_bf16_f32 v165, v218, v219
    s_waitcnt lgkmcnt(4)
    v_mfma_f32_16x16x32_bf16 v[96:99], a[64:67], a[0:3], v[96:99]
    ds_read_b64_tr_b16 a[80:81], v196 offset:14528
    v_accvgpr_read_b32 v220, a136
    v_mfma_f32_16x16x32_bf16 v[96:99], a[68:71], a[4:7], v[96:99]
    ds_read_b64_tr_b16 a[82:83], v196 offset:16320
    v_accvgpr_read_b32 v221, a137
    v_mfma_f32_16x16x32_bf16 v[100:103], a[64:67], a[8:11], v[100:103]
    ds_read_b64_tr_b16 a[84:85], v196 offset:21696
    v_accvgpr_read_b32 v222, a138
    v_mfma_f32_16x16x32_bf16 v[100:103], a[68:71], a[12:15], v[100:103]
    ds_read_b64_tr_b16 a[86:87], v196 offset:23488
    v_accvgpr_read_b32 v223, a139
    v_mfma_f32_16x16x32_bf16 v[104:107], a[64:67], a[16:19], v[104:107]
    v_mul_f32 v220, v220, v40
    v_mul_f32 v221, v221, v41
    v_mfma_f32_16x16x32_bf16 v[104:107], a[68:71], a[20:23], v[104:107]
    v_mul_f32 v222, v222, v42
    v_mul_f32 v223, v223, v43
    v_mfma_f32_16x16x32_bf16 v[108:111], a[64:67], a[24:27], v[108:111]
    v_cvt_pk_bf16_f32 v168, v220, v221
    v_cvt_pk_bf16_f32 v169, v222, v223
    v_mfma_f32_16x16x32_bf16 v[108:111], a[68:71], a[28:31], v[108:111]
    v_accvgpr_read_b32 v224, a140
    v_accvgpr_read_b32 v225, a141
    s_waitcnt lgkmcnt(4)
    v_mfma_f32_16x16x32_bf16 v[96:99], a[72:75], a[32:35], v[96:99]
    ds_read_b64_tr_b16 a[88:89], v196 offset:55488
    v_accvgpr_read_b32 v226, a142
    v_mfma_f32_16x16x32_bf16 v[96:99], a[76:79], a[36:39], v[96:99]
    ds_read_b64_tr_b16 a[90:91], v196 offset:57280
    v_accvgpr_read_b32 v227, a143
    v_mfma_f32_16x16x32_bf16 v[100:103], a[72:75], a[40:43], v[100:103]
    ds_read_b64_tr_b16 a[92:93], v196 offset:62656
    v_mul_f32 v224, v224, v44
    v_mfma_f32_16x16x32_bf16 v[100:103], a[76:79], a[44:47], v[100:103]
    ds_read_b64_tr_b16 a[94:95], v196 offset:64448
    v_mul_f32 v225, v225, v45
    v_mfma_f32_16x16x32_bf16 v[104:107], a[72:75], a[48:51], v[104:107]
    v_mul_f32 v226, v226, v46
    v_mul_f32 v227, v227, v47
    v_mfma_f32_16x16x32_bf16 v[104:107], a[76:79], a[52:55], v[104:107]
    v_cvt_pk_bf16_f32 v172, v224, v225
    v_cvt_pk_bf16_f32 v173, v226, v227
    v_mfma_f32_16x16x32_bf16 v[108:111], a[72:75], a[56:59], v[108:111]
    v_accvgpr_read_b32 v228, a144
    v_accvgpr_read_b32 v229, a145
    v_mfma_f32_16x16x32_bf16 v[108:111], a[76:79], a[60:63], v[108:111]
    v_accvgpr_read_b32 v230, a146
    v_accvgpr_read_b32 v231, a147
    s_waitcnt lgkmcnt(4)
    v_mfma_f32_16x16x32_bf16 a[192:195], a[80:83], a[0:3], a[192:195]
    v_mul_f32 v228, v228, v48
    v_mul_f32 v229, v229, v49
    v_mfma_f32_16x16x32_bf16 a[192:195], a[84:87], a[4:7], a[192:195]
    v_mul_f32 v230, v230, v50
    v_mul_f32 v231, v231, v51
    v_mfma_f32_16x16x32_bf16 a[196:199], a[80:83], a[8:11], a[196:199]
    v_cvt_pk_bf16_f32 v162, v228, v229
    v_cvt_pk_bf16_f32 v163, v230, v231
    v_mfma_f32_16x16x32_bf16 a[196:199], a[84:87], a[12:15], a[196:199]
    v_accvgpr_read_b32 v232, a148
    v_accvgpr_read_b32 v233, a149
    v_mfma_f32_16x16x32_bf16 a[200:203], a[80:83], a[16:19], a[200:203]
    v_accvgpr_read_b32 v234, a150
    v_accvgpr_read_b32 v235, a151
    v_mfma_f32_16x16x32_bf16 a[200:203], a[84:87], a[20:23], a[200:203]
    v_mul_f32 v232, v232, v52
    v_mul_f32 v233, v233, v53
    v_mfma_f32_16x16x32_bf16 a[204:207], a[80:83], a[24:27], a[204:207]
    v_mul_f32 v234, v234, v54
    v_mul_f32 v235, v235, v55
    v_mfma_f32_16x16x32_bf16 a[204:207], a[84:87], a[28:31], a[204:207]
    v_cvt_pk_bf16_f32 v166, v232, v233
    v_cvt_pk_bf16_f32 v167, v234, v235
    s_waitcnt lgkmcnt(0)
    v_mfma_f32_16x16x32_bf16 a[192:195], a[88:91], a[32:35], a[192:195]
    s_barrier
    v_accvgpr_read_b32 v236, a152
    v_accvgpr_read_b32 v237, a153
    v_mfma_f32_16x16x32_bf16 a[192:195], a[92:95], a[36:39], a[192:195]
    v_accvgpr_read_b32 v238, a154
    v_accvgpr_read_b32 v239, a155
    v_mfma_f32_16x16x32_bf16 a[196:199], a[88:91], a[40:43], a[196:199]
    v_mul_f32 v236, v236, v56
    v_mul_f32 v237, v237, v57
    v_mfma_f32_16x16x32_bf16 a[196:199], a[92:95], a[44:47], a[196:199]
    v_mul_f32 v238, v238, v58
    v_mul_f32 v239, v239, v59
    v_mfma_f32_16x16x32_bf16 a[200:203], a[88:91], a[48:51], a[200:203]
    v_cvt_pk_bf16_f32 v170, v236, v237
    v_cvt_pk_bf16_f32 v171, v238, v239
    v_mfma_f32_16x16x32_bf16 a[200:203], a[92:95], a[52:55], a[200:203]
    v_accvgpr_read_b32 v208, a156
    v_accvgpr_read_b32 v209, a157
    v_mfma_f32_16x16x32_bf16 a[204:207], a[88:91], a[56:59], a[204:207]
    v_accvgpr_read_b32 v210, a158
    v_accvgpr_read_b32 v211, a159
    v_mfma_f32_16x16x32_bf16 a[204:207], a[92:95], a[60:63], a[204:207]
    v_mul_f32 v208, v208, v60
    v_mul_f32 v209, v209, v61
    s_waitcnt lgkmcnt(0)
    v_mfma_f32_32x32x16_bf16 v[0:15], a[208:211], a[240:243], 0
    v_mfma_f32_32x32x16_bf16 v[0:15], a[212:215], a[244:247], v[0:15]
    v_mfma_f32_32x32x16_bf16 v[16:31], a[208:211], a[248:251], 0
    v_mfma_f32_32x32x16_bf16 v[16:31], a[212:215], a[252:255], v[16:31]
    s_nop 3
    v_mul_f32 v210, v210, v62
    v_mul_f32 v211, v211, v63
    v_cvt_pk_bf16_f32 v174, v208, v209
    v_cvt_pk_bf16_f32 v175, v210, v211
    v_accvgpr_read_b32 v212, a160
    v_accvgpr_read_b32 v213, a161
    v_accvgpr_read_b32 v214, a162
    v_accvgpr_read_b32 v215, a163
    v_mul_f32 v212, v212, v64
    v_mul_f32 v213, v213, v65
    v_mul_f32 v214, v214, v66
    v_mul_f32 v215, v215, v67
    v_cvt_pk_bf16_f32 v176, v212, v213
    v_cvt_pk_bf16_f32 v177, v214, v215
    v_accvgpr_read_b32 v216, a164
    v_accvgpr_read_b32 v217, a165
    v_accvgpr_read_b32 v218, a166
    v_accvgpr_read_b32 v219, a167
    v_mul_f32 v216, v216, v68
    v_mul_f32 v217, v217, v69
    v_mul_f32 v218, v218, v70
    v_mul_f32 v219, v219, v71
    v_cvt_pk_bf16_f32 v180, v216, v217
    v_cvt_pk_bf16_f32 v181, v218, v219
    v_accvgpr_read_b32 v220, a168
    v_accvgpr_read_b32 v221, a169
    v_accvgpr_read_b32 v222, a170
    v_accvgpr_read_b32 v223, a171
    v_mul_f32 v220, v220, v72
    v_mul_f32 v221, v221, v73
    v_mul_f32 v222, v222, v74
    v_mul_f32 v223, v223, v75
    v_cvt_pk_bf16_f32 v184, v220, v221
    v_cvt_pk_bf16_f32 v185, v222, v223
    v_accvgpr_read_b32 v224, a172
    v_accvgpr_read_b32 v225, a173
    v_accvgpr_read_b32 v226, a174
    v_accvgpr_read_b32 v227, a175
    v_mul_f32 v224, v224, v76
    v_mul_f32 v225, v225, v77
    v_mul_f32 v226, v226, v78
    v_mul_f32 v227, v227, v79
    v_cvt_pk_bf16_f32 v188, v224, v225
    v_cvt_pk_bf16_f32 v189, v226, v227
    v_accvgpr_read_b32 v228, a176
    v_accvgpr_read_b32 v229, a177
    v_accvgpr_read_b32 v230, a178
    v_accvgpr_read_b32 v231, a179
    v_mul_f32 v228, v228, v80
    v_mul_f32 v229, v229, v81
    v_mul_f32 v230, v230, v82
    v_mul_f32 v231, v231, v83
    v_cvt_pk_bf16_f32 v178, v228, v229
    v_cvt_pk_bf16_f32 v179, v230, v231
    v_accvgpr_read_b32 v232, a180
    v_accvgpr_read_b32 v233, a181
    v_accvgpr_read_b32 v234, a182
    v_accvgpr_read_b32 v235, a183
    v_mul_f32 v232, v232, v84
    v_mul_f32 v233, v233, v85
    v_mul_f32 v234, v234, v86
    v_mul_f32 v235, v235, v87
    v_cvt_pk_bf16_f32 v182, v232, v233
    v_cvt_pk_bf16_f32 v183, v234, v235
    v_accvgpr_read_b32 v236, a184
    v_accvgpr_read_b32 v237, a185
    v_accvgpr_read_b32 v238, a186
    v_accvgpr_read_b32 v239, a187
    v_mul_f32 v236, v236, v88
    v_mul_f32 v237, v237, v89
    v_mul_f32 v238, v238, v90
    v_mul_f32 v239, v239, v91
    v_cvt_pk_bf16_f32 v186, v236, v237
    v_cvt_pk_bf16_f32 v187, v238, v239
    v_accvgpr_read_b32 v208, a188
    v_accvgpr_read_b32 v209, a189
    v_accvgpr_read_b32 v210, a190
    v_accvgpr_read_b32 v211, a191
    v_mul_f32 v208, v208, v92
    v_mul_f32 v209, v209, v93
    v_mul_f32 v210, v210, v94
    v_mul_f32 v211, v211, v95
    v_cvt_pk_bf16_f32 v190, v208, v209
    v_cvt_pk_bf16_f32 v191, v210, v211
    v_accvgpr_read_b32 v212, a192
    v_accvgpr_read_b32 v213, a193
    v_accvgpr_read_b32 v214, a194
    v_accvgpr_read_b32 v215, a195
    v_mul_f32 v212, v212, v96
    v_mul_f32 v213, v213, v97
    v_mul_f32 v214, v214, v98
    v_mul_f32 v215, v215, v99
    v_cvt_pk_bf16_f32 v128, v212, v213
    v_cvt_pk_bf16_f32 v129, v214, v215
    v_accvgpr_read_b32 v216, a196
    v_accvgpr_read_b32 v217, a197
    v_accvgpr_read_b32 v218, a198
    v_accvgpr_read_b32 v219, a199
    v_mul_f32 v216, v216, v100
    v_mul_f32 v217, v217, v101
    v_mul_f32 v218, v218, v102
    v_mul_f32 v219, v219, v103
    v_cvt_pk_bf16_f32 v130, v216, v217
    v_cvt_pk_bf16_f32 v131, v218, v219
    v_accvgpr_read_b32 v220, a200
    v_accvgpr_read_b32 v221, a201
    v_accvgpr_read_b32 v222, a202
    v_accvgpr_read_b32 v223, a203
    v_mul_f32 v220, v220, v104
    v_mul_f32 v221, v221, v105
    v_mul_f32 v222, v222, v106
    v_mul_f32 v223, v223, v107
    v_cvt_pk_bf16_f32 v132, v220, v221
    v_cvt_pk_bf16_f32 v133, v222, v223
    v_accvgpr_read_b32 v224, a204
    v_accvgpr_read_b32 v225, a205
    v_accvgpr_read_b32 v226, a206
    v_accvgpr_read_b32 v227, a207
    v_mul_f32 v224, v224, v108
    v_mul_f32 v225, v225, v109
    v_mul_f32 v226, v226, v110
    v_mul_f32 v227, v227, v111
    v_cvt_pk_bf16_f32 v134, v224, v225
    v_cvt_pk_bf16_f32 v135, v226, v227
    v_max3_f32 v214, v0, v1, v2
    v_max3_f32 v214, v214, v3, v4
    v_max3_f32 v214, v214, v5, v6
    v_max3_f32 v214, v214, v7, v8
    v_max3_f32 v214, v214, v9, v10
    v_max3_f32 v214, v214, v11, v12
    v_max3_f32 v214, v214, v13, v14
    v_max_f32 v214, v214, v15
    v_mov_b32 v215, v214
    v_mov_b32 v192, 0
    v_mov_b32 v193, 0
    v_permlane32_swap_b32 v214, v215
    v_max_f32 v214, v214, v215
    v_sub_f32 v32, 0, v214
    v_sub_f32 v33, 0, v214
    v_sub_f32 v34, 0, v214
    v_sub_f32 v35, 0, v214
    v_sub_f32 v36, 0, v214
    v_sub_f32 v37, 0, v214
    v_sub_f32 v38, 0, v214
    v_sub_f32 v39, 0, v214
    v_sub_f32 v40, 0, v214
    v_sub_f32 v41, 0, v214
    v_sub_f32 v42, 0, v214
    v_sub_f32 v43, 0, v214
    v_sub_f32 v44, 0, v214
    v_sub_f32 v45, 0, v214
    v_sub_f32 v46, 0, v214
    v_sub_f32 v47, 0, v214
    v_mov_b32 v194, 0
    v_mov_b32 v195, 0
    v_mfma_f32_32x32x16_bf16 v[0:15], a[208:211], a[240:243], v[32:47]
    v_mfma_f32_32x32x16_bf16 v[0:15], a[212:215], a[244:247], v[0:15]
    v_mfma_f32_32x32x16_bf16 v[64:79], v[192:195], v[192:195], 0
    v_mfma_f32_32x32x16_bf16 v[80:95], v[192:195], v[192:195], 0
    v_max3_f32 v216, v16, v17, v18
    v_max3_f32 v216, v216, v19, v20
    v_max3_f32 v216, v216, v21, v22
    v_max3_f32 v216, v216, v23, v24
    v_max3_f32 v216, v216, v25, v26
    v_max3_f32 v216, v216, v27, v28
    v_max3_f32 v216, v216, v29, v30
    v_max_f32 v216, v216, v31
    v_mov_b32 v217, v216
    v_mov_b32 v196, 0
    v_mov_b32 v197, 0
    v_permlane32_swap_b32 v216, v217
    v_max_f32 v216, v216, v217
    v_sub_f32 v48, 0, v216
    v_sub_f32 v49, 0, v216
    v_sub_f32 v50, 0, v216
    v_sub_f32 v51, 0, v216
    v_sub_f32 v52, 0, v216
    v_sub_f32 v53, 0, v216
    v_sub_f32 v54, 0, v216
    v_sub_f32 v55, 0, v216
    v_sub_f32 v56, 0, v216
    v_sub_f32 v57, 0, v216
    v_sub_f32 v58, 0, v216
    v_sub_f32 v59, 0, v216
    v_sub_f32 v60, 0, v216
    v_sub_f32 v61, 0, v216
    v_sub_f32 v62, 0, v216
    v_sub_f32 v63, 0, v216
    v_mov_b32 v198, 0
    v_mov_b32 v199, 0
    v_mfma_f32_32x32x16_bf16 v[16:31], a[208:211], a[248:251], v[48:63]
    v_exp_f32 v0, v0
    v_exp_f32 v1, v1
    v_exp_f32 v2, v2
    v_exp_f32 v3, v3
    v_exp_f32 v4, v4
    v_exp_f32 v5, v5
    v_mfma_f32_32x32x16_bf16 v[16:31], a[212:215], a[252:255], v[16:31]
    v_exp_f32 v6, v6
    v_exp_f32 v7, v7
    v_exp_f32 v8, v8
    ds_read_b128 a[232:235], v254 offset:10240
    v_exp_f32 v9, v9
    v_exp_f32 v10, v10
    v_exp_f32 v11, v11
    v_exp_f32 v12, v12
    v_exp_f32 v13, v13
    s_waitcnt lgkmcnt(1)
    ds_read_b128 a[236:239], v254 offset:11264
    v_exp_f32 v14, v14
    v_exp_f32 v15, v15
    v_mfma_f32_32x32x16_bf16 v[96:111], a[216:219], a[240:243], v[32:47]
    v_exp_f32 v16, v16
    v_exp_f32 v17, v17
    v_exp_f32 v18, v18
    v_smfmac_f32_32x32x32_bf16 v[64:79], a[224:227], v[0:7], v244
    buffer_load_dword v251, v252, s[16:19], s74 offen sc1
    v_exp_f32 v19, v19
    v_exp_f32 v20, v20
    v_exp_f32 v21, v21
    v_mfma_f32_32x32x16_bf16 v[96:111], a[220:223], a[244:247], v[96:111]
    v_exp_f32 v22, v22
    v_exp_f32 v23, v23
    v_exp_f32 v24, v24
    v_smfmac_f32_16x16x64_bf16 v[192:195], v[240:243], v[0:7], v244
    ds_read_b128 a[208:211], v254 offset:4096
    v_exp_f32 v25, v25
    v_exp_f32 v26, v26
    v_smfmac_f32_32x32x32_bf16 v[64:79], a[228:231], v[8:15], v244
    v_exp_f32 v27, v27
    v_exp_f32 v28, v28
    v_exp_f32 v29, v29
    v_smfmac_f32_16x16x64_bf16 v[192:195], v[240:243], v[8:15], v244
    s_waitcnt lgkmcnt(1)
    ds_read_b128 a[212:215], v254 offset:5120
    v_exp_f32 v30, v30
    v_exp_f32 v31, v31
    v_mfma_f32_32x32x16_bf16 v[112:127], a[216:219], a[248:251], v[48:63]
    v_exp_f32 v96, v96
    v_exp_f32 v97, v97
    v_exp_f32 v98, v98
    v_smfmac_f32_32x32x32_bf16 v[80:95], a[224:227], v[16:23], v244
    v_exp_f32 v99, v99
    v_exp_f32 v100, v100
    v_exp_f32 v101, v101
    v_mfma_f32_32x32x16_bf16 v[112:127], a[220:223], a[252:255], v[112:127]
    v_exp_f32 v102, v102
    v_exp_f32 v103, v103
    v_exp_f32 v104, v104
    v_smfmac_f32_16x16x64_bf16 v[196:199], v[240:243], v[16:23], v244
    ds_read_b128 a[192:195], v254 offset:12288
    v_exp_f32 v105, v105
    v_exp_f32 v106, v106
    v_smfmac_f32_32x32x32_bf16 v[80:95], a[228:231], v[24:31], v244
    v_exp_f32 v107, v107
    v_exp_f32 v108, v108
    v_exp_f32 v109, v109
    v_smfmac_f32_16x16x64_bf16 v[196:199], v[240:243], v[24:31], v244
    s_waitcnt lgkmcnt(1)
    ds_read_b128 a[196:199], v254 offset:13312
    v_exp_f32 v110, v110
    v_exp_f32 v111, v111
    v_mfma_f32_32x32x16_bf16 v[0:15], a[208:211], a[240:243], v[32:47]
    s_waitcnt vmcnt(0)
    v_exp_f32 v112, v112
    v_exp_f32 v113, v113
    v_exp_f32 v114, v114
    v_smfmac_f32_32x32x32_bf16 v[64:79], a[232:235], v[96:103], v244
    v_readfirstlane_b32 s62, v251
    s_nop 0
    s_cmp_ge_u32 s62, 32
    s_cbranch_scc0 kv_spin
kv_ok:
    v_exp_f32 v115, v115
    v_exp_f32 v116, v116
    v_exp_f32 v117, v117
    v_mfma_f32_32x32x16_bf16 v[0:15], a[212:215], a[244:247], v[0:15]
    v_exp_f32 v118, v118
    v_exp_f32 v119, v119
    v_exp_f32 v120, v120
    v_smfmac_f32_16x16x64_bf16 v[192:195], v[240:243], v[96:103], v244
    ds_read_b128 a[216:219], v254 offset:6144
    v_exp_f32 v121, v121
    v_exp_f32 v122, v122
    v_smfmac_f32_32x32x32_bf16 v[64:79], a[236:239], v[104:111], v244
    s_add_u32 s4, s42, s65
    s_addc_u32 s5, s43, 0
    v_exp_f32 v123, v123
    v_exp_f32 v124, v124
    v_exp_f32 v125, v125
    v_smfmac_f32_16x16x64_bf16 v[192:195], v[240:243], v[104:111], v244
    s_waitcnt lgkmcnt(1)
    ds_read_b128 a[220:223], v254 offset:7168
    v_exp_f32 v126, v126
    v_exp_f32 v127, v127
    v_mfma_f32_32x32x16_bf16 v[16:31], a[208:211], a[248:251], v[48:63]
    s_add_u32 m0, s64, 32768
    v_exp_f32 v0, v0
    v_exp_f32 v1, v1
    v_exp_f32 v2, v2
    v_smfmac_f32_32x32x32_bf16 v[80:95], a[232:235], v[112:119], v244
    buffer_load_dwordx4 v246, s[4:7], 0 offen offset:0 sc1 lds
    v_exp_f32 v3, v3
    v_exp_f32 v4, v4
    v_exp_f32 v5, v5
    v_mfma_f32_32x32x16_bf16 v[16:31], a[212:215], a[252:255], v[16:31]
    buffer_load_dwordx4 v245, s[4:7], 0 offen offset:1024 sc1 lds
    v_exp_f32 v6, v6
    v_exp_f32 v7, v7
    v_exp_f32 v8, v8
    v_smfmac_f32_16x16x64_bf16 v[196:199], v[240:243], v[112:119], v244
    ds_read_b128 a[200:203], v254 offset:14336
    v_exp_f32 v9, v9
    v_exp_f32 v10, v10
    v_smfmac_f32_32x32x32_bf16 v[80:95], a[236:239], v[120:127], v244
    s_add_u32 s8, s48, s65
    s_addc_u32 s9, s49, 0
    v_exp_f32 v11, v11
    v_exp_f32 v12, v12
    v_exp_f32 v13, v13
    v_smfmac_f32_16x16x64_bf16 v[196:199], v[240:243], v[120:127], v244
    s_waitcnt lgkmcnt(1)
    ds_read_b128 a[204:207], v254 offset:15360
    v_exp_f32 v14, v14
    v_exp_f32 v15, v15
    v_mfma_f32_32x32x16_bf16 v[96:111], a[216:219], a[240:243], v[32:47]
    s_add_u32 m0, s64, 40960
    v_exp_f32 v16, v16
    v_exp_f32 v17, v17
    v_exp_f32 v18, v18
    v_smfmac_f32_32x32x32_bf16 v[64:79], a[192:195], v[0:7], v244
    buffer_load_dwordx4 v254, s[8:11], 0 offen offset:0 sc1 lds
    v_exp_f32 v19, v19
    v_exp_f32 v20, v20
    v_exp_f32 v21, v21
    v_mfma_f32_32x32x16_bf16 v[96:111], a[220:223], a[244:247], v[96:111]
    buffer_load_dwordx4 v254, s[8:11], 0 offen offset:1024 sc1 lds
    s_add_u32 s65, s65, 8192
    v_exp_f32 v22, v22
    v_exp_f32 v23, v23
    v_exp_f32 v24, v24
    v_smfmac_f32_16x16x64_bf16 v[192:195], v[240:243], v[0:7], v244
    ds_read_b128 a[208:211], v254 offset:16384
    v_exp_f32 v25, v25
    v_exp_f32 v26, v26
    v_smfmac_f32_32x32x32_bf16 v[64:79], a[196:199], v[8:15], v244
    s_and_b32 s65, s65, 0x1ffff
    v_exp_f32 v27, v27
    v_exp_f32 v28, v28
    v_exp_f32 v29, v29
    v_smfmac_f32_16x16x64_bf16 v[192:195], v[240:243], v[8:15], v244
    s_waitcnt lgkmcnt(1)
    ds_read_b128 a[212:215], v254 offset:17408
    v_exp_f32 v30, v30
    v_exp_f32 v31, v31
    v_mfma_f32_32x32x16_bf16 v[112:127], a[216:219], a[248:251], v[48:63]
    v_exp_f32 v96, v96
    v_exp_f32 v97, v97
    v_exp_f32 v98, v98
    v_smfmac_f32_32x32x32_bf16 v[80:95], a[192:195], v[16:23], v244
    s_add_u32 s4, s42, s65
    s_addc_u32 s5, s43, 0
    v_exp_f32 v99, v99
    v_exp_f32 v100, v100
    v_exp_f32 v101, v101
    v_mfma_f32_32x32x16_bf16 v[112:127], a[220:223], a[252:255], v[112:127]
    s_add_u32 m0, s64, 49152
    v_exp_f32 v102, v102
    v_exp_f32 v103, v103
    v_exp_f32 v104, v104
    v_smfmac_f32_16x16x64_bf16 v[196:199], v[240:243], v[16:23], v244
    ds_read_b128 a[224:227], v254 offset:24576
    buffer_load_dwordx4 v246, s[4:7], 0 offen offset:0 sc1 lds
    v_exp_f32 v105, v105
    v_exp_f32 v106, v106
    v_smfmac_f32_32x32x32_bf16 v[80:95], a[196:199], v[24:31], v244
    buffer_load_dwordx4 v245, s[4:7], 0 offen offset:1024 sc1 lds
    s_add_u32 s8, s48, s65
    s_addc_u32 s9, s49, 0
    v_exp_f32 v107, v107
    v_exp_f32 v108, v108
    v_exp_f32 v109, v109
    v_smfmac_f32_16x16x64_bf16 v[196:199], v[240:243], v[24:31], v244
    s_waitcnt lgkmcnt(1)
    ds_read_b128 a[228:231], v254 offset:25600
    v_exp_f32 v110, v110
    v_exp_f32 v111, v111
    v_mfma_f32_32x32x16_bf16 v[0:15], a[208:211], a[240:243], v[32:47]
    s_add_u32 m0, s64, 57344
    v_exp_f32 v112, v112
    v_exp_f32 v113, v113
    v_exp_f32 v114, v114
    v_smfmac_f32_32x32x32_bf16 v[64:79], a[200:203], v[96:103], v244
    buffer_load_dwordx4 v254, s[8:11], 0 offen offset:0 sc1 lds
    v_exp_f32 v115, v115
    v_exp_f32 v116, v116
    v_exp_f32 v117, v117
    v_mfma_f32_32x32x16_bf16 v[0:15], a[212:215], a[244:247], v[0:15]
    buffer_load_dwordx4 v254, s[8:11], 0 offen offset:1024 sc1 lds
    s_add_u32 s65, s65, 8192
    v_exp_f32 v118, v118
    v_exp_f32 v119, v119
    v_exp_f32 v120, v120
    v_smfmac_f32_16x16x64_bf16 v[192:195], v[240:243], v[96:103], v244
    ds_read_b128 a[216:219], v254 offset:18432
    v_exp_f32 v121, v121
    v_exp_f32 v122, v122
    v_smfmac_f32_32x32x32_bf16 v[64:79], a[204:207], v[104:111], v244
    s_and_b32 s65, s65, 0x1ffff
    v_exp_f32 v123, v123
    v_exp_f32 v124, v124
    v_exp_f32 v125, v125
    v_smfmac_f32_16x16x64_bf16 v[192:195], v[240:243], v[104:111], v244
    s_waitcnt lgkmcnt(1)
    ds_read_b128 a[220:223], v254 offset:19456
    v_exp_f32 v126, v126
    v_exp_f32 v127, v127
    v_mfma_f32_32x32x16_bf16 v[16:31], a[208:211], a[248:251], v[48:63]
    v_exp_f32 v0, v0
    v_exp_f32 v1, v1
    v_exp_f32 v2, v2
    v_smfmac_f32_32x32x32_bf16 v[80:95], a[200:203], v[112:119], v244
    s_add_u32 s4, s42, s65
    s_addc_u32 s5, s43, 0
    v_exp_f32 v3, v3
    v_exp_f32 v4, v4
    v_exp_f32 v5, v5
    v_mfma_f32_32x32x16_bf16 v[16:31], a[212:215], a[252:255], v[16:31]
    s_add_u32 m0, s64, 65536
    v_exp_f32 v6, v6
    v_exp_f32 v7, v7
    v_exp_f32 v8, v8
    v_smfmac_f32_16x16x64_bf16 v[196:199], v[240:243], v[112:119], v244
    ds_read_b128 a[232:235], v254 offset:26624
    buffer_load_dwordx4 v246, s[4:7], 0 offen offset:0 sc1 lds
    v_exp_f32 v9, v9
    v_exp_f32 v10, v10
    v_smfmac_f32_32x32x32_bf16 v[80:95], a[204:207], v[120:127], v244
    buffer_load_dwordx4 v245, s[4:7], 0 offen offset:1024 sc1 lds
    s_add_u32 s8, s48, s65
    s_addc_u32 s9, s49, 0
    v_exp_f32 v11, v11
    v_exp_f32 v12, v12
    v_exp_f32 v13, v13
    v_smfmac_f32_16x16x64_bf16 v[196:199], v[240:243], v[120:127], v244
    s_waitcnt lgkmcnt(1)
    ds_read_b128 a[236:239], v254 offset:27648
    v_exp_f32 v14, v14
    v_exp_f32 v15, v15
    v_mfma_f32_32x32x16_bf16 v[96:111], a[216:219], a[240:243], v[32:47]
    s_add_u32 m0, s64, 73728
    v_exp_f32 v16, v16
    v_exp_f32 v17, v17
    v_exp_f32 v18, v18
    v_smfmac_f32_32x32x32_bf16 v[64:79], a[224:227], v[0:7], v244
    buffer_load_dwordx4 v254, s[8:11], 0 offen offset:0 sc1 lds
    v_exp_f32 v19, v19
    v_exp_f32 v20, v20
    v_exp_f32 v21, v21
    v_mfma_f32_32x32x16_bf16 v[96:111], a[220:223], a[244:247], v[96:111]
    buffer_load_dwordx4 v254, s[8:11], 0 offen offset:1024 sc1 lds
    s_add_u32 s65, s65, 8192
    v_exp_f32 v22, v22
    v_exp_f32 v23, v23
    v_exp_f32 v24, v24
    v_smfmac_f32_16x16x64_bf16 v[192:195], v[240:243], v[0:7], v244
    ds_read_b128 a[208:211], v254 offset:20480
    v_exp_f32 v25, v25
    v_exp_f32 v26, v26
    v_smfmac_f32_32x32x32_bf16 v[64:79], a[228:231], v[8:15], v244
    s_and_b32 s65, s65, 0x1ffff
    v_exp_f32 v27, v27
    v_exp_f32 v28, v28
    v_exp_f32 v29, v29
    v_smfmac_f32_16x16x64_bf16 v[192:195], v[240:243], v[8:15], v244
    s_waitcnt lgkmcnt(1)
    ds_read_b128 a[212:215], v254 offset:21504
    v_exp_f32 v30, v30
    v_exp_f32 v31, v31
    v_mfma_f32_32x32x16_bf16 v[112:127], a[216:219], a[248:251], v[48:63]
    v_exp_f32 v96, v96
    v_exp_f32 v97, v97
    v_exp_f32 v98, v98
    v_smfmac_f32_32x32x32_bf16 v[80:95], a[224:227], v[16:23], v244
    s_add_u32 s4, s42, s65
    s_addc_u32 s5, s43, 0
    v_exp_f32 v99, v99
    v_exp_f32 v100, v100
    v_exp_f32 v101, v101
    v_mfma_f32_32x32x16_bf16 v[112:127], a[220:223], a[252:255], v[112:127]
    s_add_u32 m0, s64, 81920
    v_exp_f32 v102, v102
    v_exp_f32 v103, v103
    v_exp_f32 v104, v104
    v_smfmac_f32_16x16x64_bf16 v[196:199], v[240:243], v[16:23], v244
    ds_read_b128 a[192:195], v254 offset:28672
    buffer_load_dwordx4 v246, s[4:7], 0 offen offset:0 sc1 lds
    v_exp_f32 v105, v105
    v_exp_f32 v106, v106
    v_smfmac_f32_32x32x32_bf16 v[80:95], a[228:231], v[24:31], v244
    buffer_load_dwordx4 v245, s[4:7], 0 offen offset:1024 sc1 lds
    s_add_u32 s8, s48, s65
    s_addc_u32 s9, s49, 0
    v_exp_f32 v107, v107
    v_exp_f32 v108, v108
    v_exp_f32 v109, v109
    v_smfmac_f32_16x16x64_bf16 v[196:199], v[240:243], v[24:31], v244
    s_waitcnt lgkmcnt(1)
    ds_read_b128 a[196:199], v254 offset:29696
    v_exp_f32 v110, v110
    v_exp_f32 v111, v111
    v_mfma_f32_32x32x16_bf16 v[0:15], a[208:211], a[240:243], v[32:47]
    s_add_u32 m0, s64, 90112
    v_exp_f32 v112, v112
    v_exp_f32 v113, v113
    v_exp_f32 v114, v114
    v_smfmac_f32_32x32x32_bf16 v[64:79], a[232:235], v[96:103], v244
    buffer_load_dwordx4 v254, s[8:11], 0 offen offset:0 sc1 lds
    v_exp_f32 v115, v115
    v_exp_f32 v116, v116
    v_exp_f32 v117, v117
    v_mfma_f32_32x32x16_bf16 v[0:15], a[212:215], a[244:247], v[0:15]
    buffer_load_dwordx4 v254, s[8:11], 0 offen offset:1024 sc1 lds
    s_add_u32 s65, s65, 8192
    v_exp_f32 v118, v118
    v_exp_f32 v119, v119
    v_exp_f32 v120, v120
    v_smfmac_f32_16x16x64_bf16 v[192:195], v[240:243], v[96:103], v244
    ds_read_b128 a[216:219], v254 offset:22528
    v_exp_f32 v121, v121
    v_exp_f32 v122, v122
    v_smfmac_f32_32x32x32_bf16 v[64:79], a[236:239], v[104:111], v244
    s_and_b32 s65, s65, 0x1ffff
    v_exp_f32 v123, v123
    v_exp_f32 v124, v124
    v_exp_f32 v125, v125
    v_smfmac_f32_16x16x64_bf16 v[192:195], v[240:243], v[104:111], v244
    s_waitcnt lgkmcnt(1)
    ds_read_b128 a[220:223], v254 offset:23552
    v_exp_f32 v126, v126
    v_exp_f32 v127, v127
    v_mfma_f32_32x32x16_bf16 v[16:31], a[208:211], a[248:251], v[48:63]
    s_waitcnt vmcnt(12)
    v_exp_f32 v0, v0
    v_exp_f32 v1, v1
    v_exp_f32 v2, v2
    v_smfmac_f32_32x32x32_bf16 v[80:95], a[232:235], v[112:119], v244
    s_barrier
    v_exp_f32 v3, v3
    v_exp_f32 v4, v4
    v_exp_f32 v5, v5
    v_mfma_f32_32x32x16_bf16 v[16:31], a[212:215], a[252:255], v[16:31]
    v_exp_f32 v6, v6
    v_exp_f32 v7, v7
    v_exp_f32 v8, v8
    v_smfmac_f32_16x16x64_bf16 v[196:199], v[240:243], v[112:119], v244
    ds_read_b128 a[200:203], v254 offset:30720
    v_exp_f32 v9, v9
    v_exp_f32 v10, v10
    v_smfmac_f32_32x32x32_bf16 v[80:95], a[236:239], v[120:127], v244
    v_exp_f32 v11, v11
    v_exp_f32 v12, v12
    v_exp_f32 v13, v13
    v_smfmac_f32_16x16x64_bf16 v[196:199], v[240:243], v[120:127], v244
    s_waitcnt lgkmcnt(1)
    ds_read_b128 a[204:207], v254 offset:31744
    v_exp_f32 v14, v14
    v_exp_f32 v15, v15
    v_mfma_f32_32x32x16_bf16 v[96:111], a[216:219], a[240:243], v[32:47]
    buffer_load_dword v220, v249, s[32:35], s68 offen
    s_add_u32 s68, s68, s69
    v_exp_f32 v16, v16
    v_exp_f32 v17, v17
    v_exp_f32 v18, v18
    v_smfmac_f32_32x32x32_bf16 v[64:79], a[192:195], v[0:7], v244
    v_exp_f32 v19, v19
    v_exp_f32 v20, v20
    v_exp_f32 v21, v21
    v_mfma_f32_32x32x16_bf16 v[96:111], a[220:223], a[244:247], v[96:111]
    v_exp_f32 v22, v22
    v_exp_f32 v23, v23
    v_exp_f32 v24, v24
    v_smfmac_f32_16x16x64_bf16 v[192:195], v[240:243], v[0:7], v244
    ds_read_b128 a[208:211], v254 offset:32768
    v_exp_f32 v25, v25
    v_exp_f32 v26, v26
    v_smfmac_f32_32x32x32_bf16 v[64:79], a[196:199], v[8:15], v244
    v_exp_f32 v27, v27
    v_exp_f32 v28, v28
    v_exp_f32 v29, v29
    v_smfmac_f32_16x16x64_bf16 v[192:195], v[240:243], v[8:15], v244
    s_waitcnt lgkmcnt(1)
    ds_read_b128 a[212:215], v254 offset:33792
    v_exp_f32 v30, v30
    v_exp_f32 v31, v31
    v_mfma_f32_32x32x16_bf16 v[112:127], a[216:219], a[248:251], v[48:63]
    v_exp_f32 v96, v96
    v_exp_f32 v97, v97
    v_exp_f32 v98, v98
    v_smfmac_f32_32x32x32_bf16 v[80:95], a[192:195], v[16:23], v244
    v_exp_f32 v99, v99
    v_exp_f32 v100, v100
    v_exp_f32 v101, v101
    v_mfma_f32_32x32x16_bf16 v[112:127], a[220:223], a[252:255], v[112:127]
    v_exp_f32 v102, v102
    v_exp_f32 v103, v103
    v_exp_f32 v104, v104
    v_smfmac_f32_16x16x64_bf16 v[196:199], v[240:243], v[16:23], v244
    ds_read_b128 a[224:227], v254 offset:40960
    v_exp_f32 v105, v105
    v_exp_f32 v106, v106
    v_smfmac_f32_32x32x32_bf16 v[80:95], a[196:199], v[24:31], v244
    v_exp_f32 v107, v107
    v_exp_f32 v108, v108
    v_exp_f32 v109, v109
    v_smfmac_f32_16x16x64_bf16 v[196:199], v[240:243], v[24:31], v244
    s_waitcnt lgkmcnt(1)
    ds_read_b128 a[228:231], v254 offset:41984
    v_exp_f32 v110, v110
    v_exp_f32 v111, v111
    v_mfma_f32_32x32x16_bf16 v[0:15], a[208:211], a[240:243], v[32:47]
    v_exp_f32 v112, v112
    v_exp_f32 v113, v113
    v_exp_f32 v114, v114
    v_smfmac_f32_32x32x32_bf16 v[64:79], a[200:203], v[96:103], v244
    v_exp_f32 v115, v115
    v_exp_f32 v116, v116
    v_exp_f32 v117, v117
    v_mfma_f32_32x32x16_bf16 v[0:15], a[212:215], a[244:247], v[0:15]
    v_exp_f32 v118, v118
    v_exp_f32 v119, v119
    v_exp_f32 v120, v120
    v_smfmac_f32_16x16x64_bf16 v[192:195], v[240:243], v[96:103], v244
    ds_read_b128 a[216:219], v254 offset:34816
    v_exp_f32 v121, v121
    v_exp_f32 v122, v122
    v_smfmac_f32_32x32x32_bf16 v[64:79], a[204:207], v[104:111], v244
    v_exp_f32 v123, v123
    v_exp_f32 v124, v124
    v_exp_f32 v125, v125
    v_smfmac_f32_16x16x64_bf16 v[192:195], v[240:243], v[104:111], v244
    s_waitcnt lgkmcnt(1)
    ds_read_b128 a[220:223], v254 offset:35840
    v_exp_f32 v126, v126
    v_exp_f32 v127, v127
    v_mfma_f32_32x32x16_bf16 v[16:31], a[208:211], a[248:251], v[48:63]
    v_exp_f32 v0, v0
    v_exp_f32 v1, v1
    v_exp_f32 v2, v2
    v_smfmac_f32_32x32x32_bf16 v[80:95], a[200:203], v[112:119], v244
    v_exp_f32 v3, v3
    v_exp_f32 v4, v4
    v_exp_f32 v5, v5
    v_mfma_f32_32x32x16_bf16 v[16:31], a[212:215], a[252:255], v[16:31]
    v_exp_f32 v6, v6
    v_exp_f32 v7, v7
    v_exp_f32 v8, v8
    v_smfmac_f32_16x16x64_bf16 v[196:199], v[240:243], v[112:119], v244
    ds_read_b128 a[232:235], v254 offset:43008
    v_exp_f32 v9, v9
    v_exp_f32 v10, v10
    v_smfmac_f32_32x32x32_bf16 v[80:95], a[204:207], v[120:127], v244
    v_exp_f32 v11, v11
    v_exp_f32 v12, v12
    v_exp_f32 v13, v13
    v_smfmac_f32_16x16x64_bf16 v[196:199], v[240:243], v[120:127], v244
    s_waitcnt lgkmcnt(1)
    ds_read_b128 a[236:239], v254 offset:44032
    v_exp_f32 v14, v14
    v_exp_f32 v15, v15
    v_mfma_f32_32x32x16_bf16 v[96:111], a[216:219], a[240:243], v[32:47]
    v_add_u32 v142, s72, v254
    v_exp_f32 v16, v16
    v_exp_f32 v17, v17
    v_exp_f32 v18, v18
    v_smfmac_f32_32x32x32_bf16 v[64:79], a[224:227], v[0:7], v244
    v_add_u32 v143, s73, v254
    v_exp_f32 v19, v19
    v_exp_f32 v20, v20
    v_exp_f32 v21, v21
    v_mfma_f32_32x32x16_bf16 v[96:111], a[220:223], a[244:247], v[96:111]
    buffer_store_dwordx4 v[144:147], v142, s[16:19], 0 offen offset:0 sc1
    v_exp_f32 v22, v22
    v_exp_f32 v23, v23
    v_exp_f32 v24, v24
    v_smfmac_f32_16x16x64_bf16 v[192:195], v[240:243], v[0:7], v244
    ds_read_b128 a[208:211], v254 offset:36864
    v_exp_f32 v25, v25
    v_exp_f32 v26, v26
    v_smfmac_f32_32x32x32_bf16 v[64:79], a[228:231], v[8:15], v244
    v_exp_f32 v27, v27
    v_exp_f32 v28, v28
    v_exp_f32 v29, v29
    v_smfmac_f32_16x16x64_bf16 v[192:195], v[240:243], v[8:15], v244
    s_waitcnt lgkmcnt(1)
    ds_read_b128 a[212:215], v254 offset:37888
    v_exp_f32 v30, v30
    v_exp_f32 v31, v31
    v_mfma_f32_32x32x16_bf16 v[112:127], a[216:219], a[248:251], v[48:63]
    buffer_store_dwordx4 v[160:163], v142, s[16:19], 0 offen offset:1024 sc1
    v_exp_f32 v96, v96
    v_exp_f32 v97, v97
    v_exp_f32 v98, v98
    v_smfmac_f32_32x32x32_bf16 v[80:95], a[224:227], v[16:23], v244
    v_exp_f32 v99, v99
    v_exp_f32 v100, v100
    v_exp_f32 v101, v101
    v_mfma_f32_32x32x16_bf16 v[112:127], a[220:223], a[252:255], v[112:127]
    v_exp_f32 v102, v102
    v_exp_f32 v103, v103
    v_exp_f32 v104, v104
    v_smfmac_f32_16x16x64_bf16 v[196:199], v[240:243], v[16:23], v244
    ds_read_b128 a[192:195], v254 offset:45056
    v_exp_f32 v105, v105
    v_exp_f32 v106, v106
    v_smfmac_f32_32x32x32_bf16 v[80:95], a[228:231], v[24:31], v244
    buffer_store_dwordx4 v[176:179], v142, s[16:19], 0 offen offset:2048 sc1
    v_exp_f32 v107, v107
    v_exp_f32 v108, v108
    v_exp_f32 v109, v109
    v_smfmac_f32_16x16x64_bf16 v[196:199], v[240:243], v[24:31], v244
    s_waitcnt lgkmcnt(1)
    ds_read_b128 a[196:199], v254 offset:46080
    v_exp_f32 v110, v110
    v_exp_f32 v111, v111
    v_mfma_f32_32x32x16_bf16 v[0:15], a[208:211], a[240:243], v[32:47]
    v_exp_f32 v112, v112
    v_exp_f32 v113, v113
    v_exp_f32 v114, v114
    v_smfmac_f32_32x32x32_bf16 v[64:79], a[232:235], v[96:103], v244
    v_exp_f32 v115, v115
    v_exp_f32 v116, v116
    v_exp_f32 v117, v117
    v_mfma_f32_32x32x16_bf16 v[0:15], a[212:215], a[244:247], v[0:15]
    v_exp_f32 v118, v118
    v_exp_f32 v119, v119
    v_exp_f32 v120, v120
    v_smfmac_f32_16x16x64_bf16 v[192:195], v[240:243], v[96:103], v244
    ds_read_b128 a[216:219], v254 offset:38912
    v_exp_f32 v121, v121
    v_exp_f32 v122, v122
    v_smfmac_f32_32x32x32_bf16 v[64:79], a[236:239], v[104:111], v244
    v_exp_f32 v123, v123
    v_exp_f32 v124, v124
    v_exp_f32 v125, v125
    v_smfmac_f32_16x16x64_bf16 v[192:195], v[240:243], v[104:111], v244
    s_waitcnt lgkmcnt(1)
    ds_read_b128 a[220:223], v254 offset:39936
    v_exp_f32 v126, v126
    v_exp_f32 v127, v127
    v_mfma_f32_32x32x16_bf16 v[16:31], a[208:211], a[248:251], v[48:63]
    s_waitcnt vmcnt(4)
    v_exp_f32 v0, v0
    v_exp_f32 v1, v1
    v_exp_f32 v2, v2
    v_smfmac_f32_32x32x32_bf16 v[80:95], a[232:235], v[112:119], v244
    s_barrier
    v_exp_f32 v3, v3
    v_exp_f32 v4, v4
    v_exp_f32 v5, v5
    v_mfma_f32_32x32x16_bf16 v[16:31], a[212:215], a[252:255], v[16:31]
    v_exp_f32 v6, v6
    v_exp_f32 v7, v7
    v_exp_f32 v8, v8
    v_smfmac_f32_16x16x64_bf16 v[196:199], v[240:243], v[112:119], v244
    ds_read_b128 a[200:203], v254 offset:47104
    v_exp_f32 v9, v9
    v_exp_f32 v10, v10
    v_smfmac_f32_32x32x32_bf16 v[80:95], a[236:239], v[120:127], v244
    v_exp_f32 v11, v11
    v_exp_f32 v12, v12
    v_exp_f32 v13, v13
    v_smfmac_f32_16x16x64_bf16 v[196:199], v[240:243], v[120:127], v244
    s_waitcnt lgkmcnt(1)
    ds_read_b128 a[204:207], v254 offset:48128
    v_exp_f32 v14, v14
    v_exp_f32 v15, v15
    v_mfma_f32_32x32x16_bf16 v[96:111], a[216:219], a[240:243], v[32:47]
    v_exp_f32 v16, v16
    v_exp_f32 v17, v17
    v_exp_f32 v18, v18
    v_smfmac_f32_32x32x32_bf16 v[64:79], a[192:195], v[0:7], v244
    s_add_u32 s4, s42, s65
    s_addc_u32 s5, s43, 0
    v_exp_f32 v19, v19
    v_exp_f32 v20, v20
    v_exp_f32 v21, v21
    v_mfma_f32_32x32x16_bf16 v[96:111], a[220:223], a[244:247], v[96:111]
    s_add_u32 m0, s64, 98304
    v_exp_f32 v22, v22
    v_exp_f32 v23, v23
    v_exp_f32 v24, v24
    v_smfmac_f32_16x16x64_bf16 v[192:195], v[240:243], v[0:7], v244
    ds_read_b128 a[208:211], v254 offset:49152
    buffer_load_dwordx4 v246, s[4:7], 0 offen offset:0 sc1 lds
    v_exp_f32 v25, v25
    v_exp_f32 v26, v26
    v_smfmac_f32_32x32x32_bf16 v[64:79], a[196:199], v[8:15], v244
    buffer_load_dwordx4 v245, s[4:7], 0 offen offset:1024 sc1 lds
    s_add_u32 s8, s48, s65
    s_addc_u32 s9, s49, 0
    v_exp_f32 v27, v27
    v_exp_f32 v28, v28
    v_exp_f32 v29, v29
    v_smfmac_f32_16x16x64_bf16 v[192:195], v[240:243], v[8:15], v244
    s_waitcnt lgkmcnt(1)
    ds_read_b128 a[212:215], v254 offset:50176
    v_exp_f32 v30, v30
    v_exp_f32 v31, v31
    v_mfma_f32_32x32x16_bf16 v[112:127], a[216:219], a[248:251], v[48:63]
    s_add_u32 m0, s64, 106496
    v_exp_f32 v96, v96
    v_exp_f32 v97, v97
    v_exp_f32 v98, v98
    v_smfmac_f32_32x32x32_bf16 v[80:95], a[192:195], v[16:23], v244
    buffer_load_dwordx4 v254, s[8:11], 0 offen offset:0 sc1 lds
    v_exp_f32 v99, v99
    v_exp_f32 v100, v100
    v_exp_f32 v101, v101
    v_mfma_f32_32x32x16_bf16 v[112:127], a[220:223], a[252:255], v[112:127]
    buffer_load_dwordx4 v254, s[8:11], 0 offen offset:1024 sc1 lds
    s_add_u32 s65, s65, 8192
    v_exp_f32 v102, v102
    v_exp_f32 v103, v103
    v_exp_f32 v104, v104
    v_smfmac_f32_16x16x64_bf16 v[196:199], v[240:243], v[16:23], v244
    ds_read_b128 a[224:227], v254 offset:57344
    v_exp_f32 v105, v105
    v_exp_f32 v106, v106
    v_smfmac_f32_32x32x32_bf16 v[80:95], a[196:199], v[24:31], v244
    s_and_b32 s65, s65, 0x1ffff
    v_exp_f32 v107, v107
    v_exp_f32 v108, v108
    v_exp_f32 v109, v109
    v_smfmac_f32_16x16x64_bf16 v[196:199], v[240:243], v[24:31], v244
    s_waitcnt lgkmcnt(1)
    ds_read_b128 a[228:231], v254 offset:58368
    v_exp_f32 v110, v110
    v_exp_f32 v111, v111
    v_mfma_f32_32x32x16_bf16 v[0:15], a[208:211], a[240:243], v[32:47]
    v_exp_f32 v112, v112
    v_exp_f32 v113, v113
    v_exp_f32 v114, v114
    v_smfmac_f32_32x32x32_bf16 v[64:79], a[200:203], v[96:103], v244
    s_add_u32 s4, s42, s65
    s_addc_u32 s5, s43, 0
    v_exp_f32 v115, v115
    v_exp_f32 v116, v116
    v_exp_f32 v117, v117
    v_mfma_f32_32x32x16_bf16 v[0:15], a[212:215], a[244:247], v[0:15]
    s_add_u32 m0, s64, 114688
    v_exp_f32 v118, v118
    v_exp_f32 v119, v119
    v_exp_f32 v120, v120
    v_smfmac_f32_16x16x64_bf16 v[192:195], v[240:243], v[96:103], v244
    ds_read_b128 a[216:219], v254 offset:51200
    buffer_load_dwordx4 v246, s[4:7], 0 offen offset:0 sc1 lds
    v_exp_f32 v121, v121
    v_exp_f32 v122, v122
    v_smfmac_f32_32x32x32_bf16 v[64:79], a[204:207], v[104:111], v244
    buffer_load_dwordx4 v245, s[4:7], 0 offen offset:1024 sc1 lds
    s_add_u32 s8, s48, s65
    s_addc_u32 s9, s49, 0
    v_exp_f32 v123, v123
    v_exp_f32 v124, v124
    v_exp_f32 v125, v125
    v_smfmac_f32_16x16x64_bf16 v[192:195], v[240:243], v[104:111], v244
    s_waitcnt lgkmcnt(1)
    ds_read_b128 a[220:223], v254 offset:52224
    v_exp_f32 v126, v126
    v_exp_f32 v127, v127
    v_mfma_f32_32x32x16_bf16 v[16:31], a[208:211], a[248:251], v[48:63]
    s_add_u32 m0, s64, 122880
    v_exp_f32 v0, v0
    v_exp_f32 v1, v1
    v_exp_f32 v2, v2
    v_smfmac_f32_32x32x32_bf16 v[80:95], a[200:203], v[112:119], v244
    buffer_load_dwordx4 v254, s[8:11], 0 offen offset:0 sc1 lds
    v_exp_f32 v3, v3
    v_exp_f32 v4, v4
    v_exp_f32 v5, v5
    v_mfma_f32_32x32x16_bf16 v[16:31], a[212:215], a[252:255], v[16:31]
    buffer_load_dwordx4 v254, s[8:11], 0 offen offset:1024 sc1 lds
    s_add_u32 s65, s65, 8192
    v_exp_f32 v6, v6
    v_exp_f32 v7, v7
    v_exp_f32 v8, v8
    v_smfmac_f32_16x16x64_bf16 v[196:199], v[240:243], v[112:119], v244
    ds_read_b128 a[232:235], v254 offset:59392
    v_exp_f32 v9, v9
    v_exp_f32 v10, v10
    v_smfmac_f32_32x32x32_bf16 v[80:95], a[204:207], v[120:127], v244
    s_and_b32 s65, s65, 0x1ffff
    v_exp_f32 v11, v11
    v_exp_f32 v12, v12
    v_exp_f32 v13, v13
    v_smfmac_f32_16x16x64_bf16 v[196:199], v[240:243], v[120:127], v244
    s_waitcnt lgkmcnt(1)
    ds_read_b128 a[236:239], v254 offset:60416
    v_exp_f32 v14, v14
    v_exp_f32 v15, v15
    v_mfma_f32_32x32x16_bf16 v[96:111], a[216:219], a[240:243], v[32:47]
    v_exp_f32 v16, v16
    v_exp_f32 v17, v17
    v_exp_f32 v18, v18
    v_smfmac_f32_32x32x32_bf16 v[64:79], a[224:227], v[0:7], v244
    s_add_u32 s4, s42, s65
    s_addc_u32 s5, s43, 0
    v_exp_f32 v19, v19
    v_exp_f32 v20, v20
    v_exp_f32 v21, v21
    v_mfma_f32_32x32x16_bf16 v[96:111], a[220:223], a[244:247], v[96:111]
    s_add_u32 m0, s64, 0
    v_exp_f32 v22, v22
    v_exp_f32 v23, v23
    v_exp_f32 v24, v24
    v_smfmac_f32_16x16x64_bf16 v[192:195], v[240:243], v[0:7], v244
    ds_read_b128 a[208:211], v254 offset:53248
    buffer_load_dwordx4 v246, s[4:7], 0 offen offset:0 sc1 lds
    v_exp_f32 v25, v25
    v_exp_f32 v26, v26
    v_smfmac_f32_32x32x32_bf16 v[64:79], a[228:231], v[8:15], v244
    buffer_load_dwordx4 v245, s[4:7], 0 offen offset:1024 sc1 lds
    s_add_u32 s8, s48, s65
    s_addc_u32 s9, s49, 0
    v_exp_f32 v27, v27
    v_exp_f32 v28, v28
    v_exp_f32 v29, v29
    v_smfmac_f32_16x16x64_bf16 v[192:195], v[240:243], v[8:15], v244
    s_waitcnt lgkmcnt(1)
    ds_read_b128 a[212:215], v254 offset:54272
    v_exp_f32 v30, v30
    v_exp_f32 v31, v31
    v_mfma_f32_32x32x16_bf16 v[112:127], a[216:219], a[248:251], v[48:63]
    s_add_u32 m0, s64, 8192
    v_exp_f32 v96, v96
    v_exp_f32 v97, v97
    v_exp_f32 v98, v98
    v_smfmac_f32_32x32x32_bf16 v[80:95], a[224:227], v[16:23], v244
    buffer_load_dwordx4 v254, s[8:11], 0 offen offset:0 sc1 lds
    v_exp_f32 v99, v99
    v_exp_f32 v100, v100
    v_exp_f32 v101, v101
    v_mfma_f32_32x32x16_bf16 v[112:127], a[220:223], a[252:255], v[112:127]
    buffer_load_dwordx4 v254, s[8:11], 0 offen offset:1024 sc1 lds
    s_add_u32 s65, s65, 8192
    v_exp_f32 v102, v102
    v_exp_f32 v103, v103
    v_exp_f32 v104, v104
    v_smfmac_f32_16x16x64_bf16 v[196:199], v[240:243], v[16:23], v244
    ds_read_b128 a[192:195], v254 offset:61440
    v_exp_f32 v105, v105
    v_exp_f32 v106, v106
    v_smfmac_f32_32x32x32_bf16 v[80:95], a[228:231], v[24:31], v244
    s_and_b32 s65, s65, 0x1ffff
    v_exp_f32 v107, v107
    v_exp_f32 v108, v108
    v_exp_f32 v109, v109
    v_smfmac_f32_16x16x64_bf16 v[196:199], v[240:243], v[24:31], v244
    s_waitcnt lgkmcnt(1)
    ds_read_b128 a[196:199], v254 offset:62464
    v_exp_f32 v110, v110
    v_exp_f32 v111, v111
    v_mfma_f32_32x32x16_bf16 v[0:15], a[208:211], a[240:243], v[32:47]
    buffer_store_dwordx2 v[128:129], v143, s[16:19], 0 offen sc1
    v_exp_f32 v112, v112
    v_exp_f32 v113, v113
    v_exp_f32 v114, v114
    v_smfmac_f32_32x32x32_bf16 v[64:79], a[232:235], v[96:103], v244
    v_exp_f32 v115, v115
    v_exp_f32 v116, v116
    v_exp_f32 v117, v117
    v_mfma_f32_32x32x16_bf16 v[0:15], a[212:215], a[244:247], v[0:15]
    v_exp_f32 v118, v118
    v_exp_f32 v119, v119
    v_exp_f32 v120, v120
    v_smfmac_f32_16x16x64_bf16 v[192:195], v[240:243], v[96:103], v244
    ds_read_b128 a[216:219], v254 offset:55296
    v_exp_f32 v121, v121
    v_exp_f32 v122, v122
    v_smfmac_f32_32x32x32_bf16 v[64:79], a[236:239], v[104:111], v244
    v_add_u32 v142, 147456, v142
    v_exp_f32 v123, v123
    v_exp_f32 v124, v124
    v_exp_f32 v125, v125
    v_smfmac_f32_16x16x64_bf16 v[192:195], v[240:243], v[104:111], v244
    s_waitcnt lgkmcnt(1)
    ds_read_b128 a[220:223], v254 offset:56320
    v_add_u32 v143, 147456, v143
    v_exp_f32 v126, v126
    v_exp_f32 v127, v127
    v_mfma_f32_32x32x16_bf16 v[16:31], a[208:211], a[248:251], v[48:63]
    buffer_store_dwordx4 v[148:151], v142, s[16:19], 0 offen offset:0 sc1
    v_exp_f32 v0, v0
    v_exp_f32 v1, v1
    v_exp_f32 v2, v2
    v_smfmac_f32_32x32x32_bf16 v[80:95], a[232:235], v[112:119], v244
    v_exp_f32 v3, v3
    v_exp_f32 v4, v4
    v_exp_f32 v5, v5
    v_mfma_f32_32x32x16_bf16 v[16:31], a[212:215], a[252:255], v[16:31]
    v_exp_f32 v6, v6
    v_exp_f32 v7, v7
    v_exp_f32 v8, v8
    v_smfmac_f32_16x16x64_bf16 v[196:199], v[240:243], v[112:119], v244
    ds_read_b128 a[200:203], v254 offset:63488
    v_exp_f32 v9, v9
    v_exp_f32 v10, v10
    v_smfmac_f32_32x32x32_bf16 v[80:95], a[236:239], v[120:127], v244
    buffer_store_dwordx4 v[164:167], v142, s[16:19], 0 offen offset:1024 sc1
    v_exp_f32 v11, v11
    v_exp_f32 v12, v12
    v_exp_f32 v13, v13
    v_smfmac_f32_16x16x64_bf16 v[196:199], v[240:243], v[120:127], v244
    s_waitcnt lgkmcnt(1)
    ds_read_b128 a[204:207], v254 offset:64512
    v_exp_f32 v14, v14
    v_exp_f32 v15, v15
    v_mfma_f32_32x32x16_bf16 v[96:111], a[216:219], a[240:243], v[32:47]
    v_exp_f32 v16, v16
    v_exp_f32 v17, v17
    v_exp_f32 v18, v18
    v_smfmac_f32_32x32x32_bf16 v[64:79], a[192:195], v[0:7], v244
    v_exp_f32 v19, v19
    v_exp_f32 v20, v20
    v_exp_f32 v21, v21
    v_mfma_f32_32x32x16_bf16 v[96:111], a[220:223], a[244:247], v[96:111]
    v_exp_f32 v22, v22
    v_exp_f32 v23, v23
    v_exp_f32 v24, v24
    v_smfmac_f32_16x16x64_bf16 v[192:195], v[240:243], v[0:7], v244
    ds_read_b128 a[208:211], v137 offset:0
    v_exp_f32 v25, v25
    v_exp_f32 v26, v26
    v_smfmac_f32_32x32x32_bf16 v[64:79], a[196:199], v[8:15], v244
    v_exp_f32 v27, v27
    v_exp_f32 v28, v28
    v_exp_f32 v29, v29
    v_smfmac_f32_16x16x64_bf16 v[192:195], v[240:243], v[8:15], v244
    s_waitcnt lgkmcnt(1)
    ds_read_b128 a[212:215], v137 offset:1024
    v_exp_f32 v30, v30
    v_exp_f32 v31, v31
    v_mfma_f32_32x32x16_bf16 v[112:127], a[216:219], a[248:251], v[48:63]
    v_exp_f32 v96, v96
    v_exp_f32 v97, v97
    v_exp_f32 v98, v98
    v_smfmac_f32_32x32x32_bf16 v[80:95], a[192:195], v[16:23], v244
    v_exp_f32 v99, v99
    v_exp_f32 v100, v100
    v_exp_f32 v101, v101
    v_mfma_f32_32x32x16_bf16 v[112:127], a[220:223], a[252:255], v[112:127]
    v_exp_f32 v102, v102
    v_exp_f32 v103, v103
    v_exp_f32 v104, v104
    v_smfmac_f32_16x16x64_bf16 v[196:199], v[240:243], v[16:23], v244
    ds_read_b128 a[224:227], v137 offset:8192
    v_exp_f32 v105, v105
    v_exp_f32 v106, v106
    v_smfmac_f32_32x32x32_bf16 v[80:95], a[196:199], v[24:31], v244
    v_exp_f32 v107, v107
    v_exp_f32 v108, v108
    v_exp_f32 v109, v109
    v_smfmac_f32_16x16x64_bf16 v[196:199], v[240:243], v[24:31], v244
    s_waitcnt lgkmcnt(1)
    ds_read_b128 a[228:231], v137 offset:9216
    v_exp_f32 v110, v110
    v_exp_f32 v111, v111
    v_mfma_f32_32x32x16_bf16 v[0:15], a[208:211], a[240:243], v[32:47]
    v_exp_f32 v112, v112
    v_exp_f32 v113, v113
    v_exp_f32 v114, v114
    v_smfmac_f32_32x32x32_bf16 v[64:79], a[200:203], v[96:103], v244
    v_exp_f32 v115, v115
    v_exp_f32 v116, v116
    v_exp_f32 v117, v117
    v_mfma_f32_32x32x16_bf16 v[0:15], a[212:215], a[244:247], v[0:15]
    v_exp_f32 v118, v118
    v_exp_f32 v119, v119
    v_exp_f32 v120, v120
    v_smfmac_f32_16x16x64_bf16 v[192:195], v[240:243], v[96:103], v244
    ds_read_b128 a[216:219], v137 offset:2048
    v_exp_f32 v121, v121
    v_exp_f32 v122, v122
    v_smfmac_f32_32x32x32_bf16 v[64:79], a[204:207], v[104:111], v244
    v_exp_f32 v123, v123
    v_exp_f32 v124, v124
    v_exp_f32 v125, v125
    v_smfmac_f32_16x16x64_bf16 v[192:195], v[240:243], v[104:111], v244
    s_waitcnt lgkmcnt(1)
    ds_read_b128 a[220:223], v137 offset:3072
    v_exp_f32 v126, v126
    v_exp_f32 v127, v127
    v_mfma_f32_32x32x16_bf16 v[16:31], a[208:211], a[248:251], v[48:63]
    v_exp_f32 v0, v0
    v_exp_f32 v1, v1
    v_exp_f32 v2, v2
    v_smfmac_f32_32x32x32_bf16 v[80:95], a[200:203], v[112:119], v244
    v_exp_f32 v3, v3
    v_exp_f32 v4, v4
    v_exp_f32 v5, v5
    v_mfma_f32_32x32x16_bf16 v[16:31], a[212:215], a[252:255], v[16:31]
    v_exp_f32 v6, v6
    v_exp_f32 v7, v7
    v_exp_f32 v8, v8
    v_smfmac_f32_16x16x64_bf16 v[196:199], v[240:243], v[112:119], v244
    ds_read_b128 a[232:235], v137 offset:10240
    v_exp_f32 v9, v9
    v_exp_f32 v10, v10
    v_smfmac_f32_32x32x32_bf16 v[80:95], a[204:207], v[120:127], v244
    v_exp_f32 v11, v11
    v_exp_f32 v12, v12
    v_exp_f32 v13, v13
    v_smfmac_f32_16x16x64_bf16 v[196:199], v[240:243], v[120:127], v244
    s_waitcnt lgkmcnt(1)
    ds_read_b128 a[236:239], v137 offset:11264
    v_exp_f32 v14, v14
    v_exp_f32 v15, v15
    v_mfma_f32_32x32x16_bf16 v[96:111], a[216:219], a[240:243], v[32:47]
    buffer_store_dwordx4 v[180:183], v142, s[16:19], 0 offen offset:2048 sc1
    v_exp_f32 v16, v16
    v_exp_f32 v17, v17
    v_exp_f32 v18, v18
    v_smfmac_f32_32x32x32_bf16 v[64:79], a[224:227], v[0:7], v244
    v_exp_f32 v19, v19
    v_exp_f32 v20, v20
    v_exp_f32 v21, v21
    v_mfma_f32_32x32x16_bf16 v[96:111], a[220:223], a[244:247], v[96:111]
    v_exp_f32 v22, v22
    v_exp_f32 v23, v23
    v_exp_f32 v24, v24
    v_smfmac_f32_16x16x64_bf16 v[192:195], v[240:243], v[0:7], v244
    ds_read_b128 a[208:211], v137 offset:4096
    v_exp_f32 v25, v25
    v_exp_f32 v26, v26
    v_smfmac_f32_32x32x32_bf16 v[64:79], a[228:231], v[8:15], v244
    buffer_store_dwordx2 v[130:131], v143, s[16:19], 0 offen sc1
    v_exp_f32 v27, v27
    v_exp_f32 v28, v28
    v_exp_f32 v29, v29
    v_smfmac_f32_16x16x64_bf16 v[192:195], v[240:243], v[8:15], v244
    s_waitcnt lgkmcnt(1)
    ds_read_b128 a[212:215], v137 offset:5120
    v_exp_f32 v30, v30
    v_exp_f32 v31, v31
    v_mfma_f32_32x32x16_bf16 v[112:127], a[216:219], a[248:251], v[48:63]
    v_exp_f32 v96, v96
    v_exp_f32 v97, v97
    v_exp_f32 v98, v98
    v_smfmac_f32_32x32x32_bf16 v[80:95], a[224:227], v[16:23], v244
    v_exp_f32 v99, v99
    v_exp_f32 v100, v100
    v_exp_f32 v101, v101
    v_mfma_f32_32x32x16_bf16 v[112:127], a[220:223], a[252:255], v[112:127]
    v_add_u32 v142, 147456, v142
    v_exp_f32 v102, v102
    v_exp_f32 v103, v103
    v_exp_f32 v104, v104
    v_smfmac_f32_16x16x64_bf16 v[196:199], v[240:243], v[16:23], v244
    ds_read_b128 a[192:195], v137 offset:12288
    v_add_u32 v143, 147456, v143
    v_exp_f32 v105, v105
    v_exp_f32 v106, v106
    v_smfmac_f32_32x32x32_bf16 v[80:95], a[228:231], v[24:31], v244
    buffer_store_dwordx4 v[152:155], v142, s[16:19], 0 offen offset:0 sc1
    v_exp_f32 v107, v107
    v_exp_f32 v108, v108
    v_exp_f32 v109, v109
    v_smfmac_f32_16x16x64_bf16 v[196:199], v[240:243], v[24:31], v244
    s_waitcnt lgkmcnt(1)
    ds_read_b128 a[196:199], v137 offset:13312
    v_exp_f32 v110, v110
    v_exp_f32 v111, v111
    v_mfma_f32_32x32x16_bf16 v[0:15], a[208:211], a[240:243], v[32:47]
    v_exp_f32 v112, v112
    v_exp_f32 v113, v113
    v_exp_f32 v114, v114
    v_smfmac_f32_32x32x32_bf16 v[64:79], a[232:235], v[96:103], v244
    v_exp_f32 v115, v115
    v_exp_f32 v116, v116
    v_exp_f32 v117, v117
    v_mfma_f32_32x32x16_bf16 v[0:15], a[212:215], a[244:247], v[0:15]
    v_exp_f32 v118, v118
    v_exp_f32 v119, v119
    v_exp_f32 v120, v120
    v_smfmac_f32_16x16x64_bf16 v[192:195], v[240:243], v[96:103], v244
    ds_read_b128 a[216:219], v137 offset:6144
    v_exp_f32 v121, v121
    v_exp_f32 v122, v122
    v_smfmac_f32_32x32x32_bf16 v[64:79], a[236:239], v[104:111], v244
    v_exp_f32 v123, v123
    v_exp_f32 v124, v124
    v_exp_f32 v125, v125
    v_smfmac_f32_16x16x64_bf16 v[192:195], v[240:243], v[104:111], v244
    s_waitcnt lgkmcnt(1)
    ds_read_b128 a[220:223], v137 offset:7168
    v_exp_f32 v126, v126
    v_exp_f32 v127, v127
    v_mfma_f32_32x32x16_bf16 v[16:31], a[208:211], a[248:251], v[48:63]
    v_exp_f32 v0, v0
    v_exp_f32 v1, v1
    v_exp_f32 v2, v2
    v_smfmac_f32_32x32x32_bf16 v[80:95], a[232:235], v[112:119], v244
    v_exp_f32 v3, v3
    v_exp_f32 v4, v4
    v_exp_f32 v5, v5
    v_mfma_f32_32x32x16_bf16 v[16:31], a[212:215], a[252:255], v[16:31]
    v_exp_f32 v6, v6
    v_exp_f32 v7, v7
    v_exp_f32 v8, v8
    v_smfmac_f32_16x16x64_bf16 v[196:199], v[240:243], v[112:119], v244
    ds_read_b128 a[200:203], v137 offset:14336
    v_exp_f32 v9, v9
    v_exp_f32 v10, v10
    v_smfmac_f32_32x32x32_bf16 v[80:95], a[236:239], v[120:127], v244
    v_exp_f32 v11, v11
    v_exp_f32 v12, v12
    v_exp_f32 v13, v13
    v_smfmac_f32_16x16x64_bf16 v[196:199], v[240:243], v[120:127], v244
    s_waitcnt lgkmcnt(1)
    ds_read_b128 a[204:207], v137 offset:15360
    v_exp_f32 v14, v14
    v_exp_f32 v15, v15
    v_mfma_f32_32x32x16_bf16 v[96:111], a[216:219], a[240:243], v[32:47]
    v_exp_f32 v16, v16
    v_exp_f32 v17, v17
    v_exp_f32 v18, v18
    v_smfmac_f32_32x32x32_bf16 v[64:79], a[192:195], v[0:7], v244
    v_exp_f32 v19, v19
    v_exp_f32 v20, v20
    v_exp_f32 v21, v21
    v_mfma_f32_32x32x16_bf16 v[96:111], a[220:223], a[244:247], v[96:111]
    v_exp_f32 v22, v22
    v_exp_f32 v23, v23
    v_exp_f32 v24, v24
    v_smfmac_f32_16x16x64_bf16 v[192:195], v[240:243], v[0:7], v244
    ds_read_b128 a[208:211], v137 offset:16384
    v_exp_f32 v25, v25
    v_exp_f32 v26, v26
    v_smfmac_f32_32x32x32_bf16 v[64:79], a[196:199], v[8:15], v244
    v_exp_f32 v27, v27
    v_exp_f32 v28, v28
    v_exp_f32 v29, v29
    v_smfmac_f32_16x16x64_bf16 v[192:195], v[240:243], v[8:15], v244
    s_waitcnt lgkmcnt(1)
    ds_read_b128 a[212:215], v137 offset:17408
    v_exp_f32 v30, v30
    v_exp_f32 v31, v31
    v_mfma_f32_32x32x16_bf16 v[112:127], a[216:219], a[248:251], v[48:63]
    v_exp_f32 v96, v96
    v_exp_f32 v97, v97
    v_exp_f32 v98, v98
    v_smfmac_f32_32x32x32_bf16 v[80:95], a[192:195], v[16:23], v244
    v_exp_f32 v99, v99
    v_exp_f32 v100, v100
    v_exp_f32 v101, v101
    v_mfma_f32_32x32x16_bf16 v[112:127], a[220:223], a[252:255], v[112:127]
    v_exp_f32 v102, v102
    v_exp_f32 v103, v103
    v_exp_f32 v104, v104
    v_smfmac_f32_16x16x64_bf16 v[196:199], v[240:243], v[16:23], v244
    ds_read_b128 a[224:227], v137 offset:24576
    v_exp_f32 v105, v105
    v_exp_f32 v106, v106
    v_smfmac_f32_32x32x32_bf16 v[80:95], a[196:199], v[24:31], v244
    v_exp_f32 v107, v107
    v_exp_f32 v108, v108
    v_exp_f32 v109, v109
    v_smfmac_f32_16x16x64_bf16 v[196:199], v[240:243], v[24:31], v244
    s_waitcnt lgkmcnt(1)
    ds_read_b128 a[228:231], v137 offset:25600
    v_exp_f32 v110, v110
    v_exp_f32 v111, v111
    v_mfma_f32_32x32x16_bf16 v[0:15], a[208:211], a[240:243], v[32:47]
    v_exp_f32 v112, v112
    v_exp_f32 v113, v113
    v_exp_f32 v114, v114
    v_smfmac_f32_32x32x32_bf16 v[64:79], a[200:203], v[96:103], v244
    v_exp_f32 v115, v115
    v_exp_f32 v116, v116
    v_exp_f32 v117, v117
    v_mfma_f32_32x32x16_bf16 v[0:15], a[212:215], a[244:247], v[0:15]
    v_exp_f32 v118, v118
    v_exp_f32 v119, v119
    v_exp_f32 v120, v120
    v_smfmac_f32_16x16x64_bf16 v[192:195], v[240:243], v[96:103], v244
    ds_read_b128 a[216:219], v137 offset:18432
    v_exp_f32 v121, v121
    v_exp_f32 v122, v122
    v_smfmac_f32_32x32x32_bf16 v[64:79], a[204:207], v[104:111], v244
    v_exp_f32 v123, v123
    v_exp_f32 v124, v124
    v_exp_f32 v125, v125
    v_smfmac_f32_16x16x64_bf16 v[192:195], v[240:243], v[104:111], v244
    s_waitcnt lgkmcnt(1)
    ds_read_b128 a[220:223], v137 offset:19456
    v_exp_f32 v126, v126
    v_exp_f32 v127, v127
    v_mfma_f32_32x32x16_bf16 v[16:31], a[208:211], a[248:251], v[48:63]
    v_exp_f32 v0, v0
    v_exp_f32 v1, v1
    v_exp_f32 v2, v2
    v_smfmac_f32_32x32x32_bf16 v[80:95], a[200:203], v[112:119], v244
    v_exp_f32 v3, v3
    v_exp_f32 v4, v4
    v_exp_f32 v5, v5
    v_mfma_f32_32x32x16_bf16 v[16:31], a[212:215], a[252:255], v[16:31]
    v_exp_f32 v6, v6
    v_exp_f32 v7, v7
    v_exp_f32 v8, v8
    v_smfmac_f32_16x16x64_bf16 v[196:199], v[240:243], v[112:119], v244
    ds_read_b128 a[232:235], v137 offset:26624
    v_exp_f32 v9, v9
    v_exp_f32 v10, v10
    v_smfmac_f32_32x32x32_bf16 v[80:95], a[204:207], v[120:127], v244
    v_exp_f32 v11, v11
    v_exp_f32 v12, v12
    v_exp_f32 v13, v13
    v_smfmac_f32_16x16x64_bf16 v[196:199], v[240:243], v[120:127], v244
    s_waitcnt lgkmcnt(1)
    ds_read_b128 a[236:239], v137 offset:27648
    v_exp_f32 v14, v14
    v_exp_f32 v15, v15
    v_mfma_f32_32x32x16_bf16 v[96:111], a[216:219], a[240:243], v[32:47]
    buffer_store_dwordx4 v[168:171], v142, s[16:19], 0 offen offset:1024 sc1
    v_exp_f32 v16, v16
    v_exp_f32 v17, v17
    v_exp_f32 v18, v18
    v_smfmac_f32_32x32x32_bf16 v[64:79], a[224:227], v[0:7], v244
    v_exp_f32 v19, v19
    v_exp_f32 v20, v20
    v_exp_f32 v21, v21
    v_mfma_f32_32x32x16_bf16 v[96:111], a[220:223], a[244:247], v[96:111]
    v_exp_f32 v22, v22
    v_exp_f32 v23, v23
    v_exp_f32 v24, v24
    v_smfmac_f32_16x16x64_bf16 v[192:195], v[240:243], v[0:7], v244
    ds_read_b128 a[208:211], v137 offset:20480
    v_exp_f32 v25, v25
    v_exp_f32 v26, v26
    v_smfmac_f32_32x32x32_bf16 v[64:79], a[228:231], v[8:15], v244
    buffer_store_dwordx4 v[184:187], v142, s[16:19], 0 offen offset:2048 sc1
    v_exp_f32 v27, v27
    v_exp_f32 v28, v28
    v_exp_f32 v29, v29
    v_smfmac_f32_16x16x64_bf16 v[192:195], v[240:243], v[8:15], v244
    s_waitcnt lgkmcnt(1)
    ds_read_b128 a[212:215], v137 offset:21504
    v_exp_f32 v30, v30
    v_exp_f32 v31, v31
    v_mfma_f32_32x32x16_bf16 v[112:127], a[216:219], a[248:251], v[48:63]
    v_exp_f32 v96, v96
    v_exp_f32 v97, v97
    v_exp_f32 v98, v98
    v_smfmac_f32_32x32x32_bf16 v[80:95], a[224:227], v[16:23], v244
    v_exp_f32 v99, v99
    v_exp_f32 v100, v100
    v_exp_f32 v101, v101
    v_mfma_f32_32x32x16_bf16 v[112:127], a[220:223], a[252:255], v[112:127]
    buffer_store_dwordx2 v[132:133], v143, s[16:19], 0 offen sc1
    v_exp_f32 v102, v102
    v_exp_f32 v103, v103
    v_exp_f32 v104, v104
    v_smfmac_f32_16x16x64_bf16 v[196:199], v[240:243], v[16:23], v244
    ds_read_b128 a[192:195], v137 offset:28672
    v_exp_f32 v105, v105
    v_exp_f32 v106, v106
    v_smfmac_f32_32x32x32_bf16 v[80:95], a[228:231], v[24:31], v244
    v_exp_f32 v107, v107
    v_exp_f32 v108, v108
    v_exp_f32 v109, v109
    v_smfmac_f32_16x16x64_bf16 v[196:199], v[240:243], v[24:31], v244
    s_waitcnt lgkmcnt(1)
    ds_read_b128 a[196:199], v137 offset:29696
    v_exp_f32 v110, v110
    v_exp_f32 v111, v111
    v_mfma_f32_32x32x16_bf16 v[0:15], a[208:211], a[240:243], v[32:47]
    v_exp_f32 v112, v112
    v_exp_f32 v113, v113
    v_exp_f32 v114, v114
    v_smfmac_f32_32x32x32_bf16 v[64:79], a[232:235], v[96:103], v244
    v_exp_f32 v115, v115
    v_exp_f32 v116, v116
    v_exp_f32 v117, v117
    v_mfma_f32_32x32x16_bf16 v[0:15], a[212:215], a[244:247], v[0:15]
    v_exp_f32 v118, v118
    v_exp_f32 v119, v119
    v_exp_f32 v120, v120
    v_smfmac_f32_16x16x64_bf16 v[192:195], v[240:243], v[96:103], v244
    ds_read_b128 a[216:219], v137 offset:22528
    v_exp_f32 v121, v121
    v_exp_f32 v122, v122
    v_smfmac_f32_32x32x32_bf16 v[64:79], a[236:239], v[104:111], v244
    v_exp_f32 v123, v123
    v_exp_f32 v124, v124
    v_exp_f32 v125, v125
    v_smfmac_f32_16x16x64_bf16 v[192:195], v[240:243], v[104:111], v244
    s_waitcnt lgkmcnt(1)
    ds_read_b128 a[220:223], v137 offset:23552
    v_exp_f32 v126, v126
    v_exp_f32 v127, v127
    v_mfma_f32_32x32x16_bf16 v[16:31], a[208:211], a[248:251], v[48:63]
    s_waitcnt vmcnt(9)
    v_exp_f32 v0, v0
    v_exp_f32 v1, v1
    v_exp_f32 v2, v2
    v_smfmac_f32_32x32x32_bf16 v[80:95], a[232:235], v[112:119], v244
    s_barrier
    v_exp_f32 v3, v3
    v_exp_f32 v4, v4
    v_exp_f32 v5, v5
    v_mfma_f32_32x32x16_bf16 v[16:31], a[212:215], a[252:255], v[16:31]
    v_exp_f32 v6, v6
    v_exp_f32 v7, v7
    v_exp_f32 v8, v8
    v_smfmac_f32_16x16x64_bf16 v[196:199], v[240:243], v[112:119], v244
    ds_read_b128 a[200:203], v137 offset:30720
    v_exp_f32 v9, v9
    v_exp_f32 v10, v10
    v_smfmac_f32_32x32x32_bf16 v[80:95], a[236:239], v[120:127], v244
    v_exp_f32 v11, v11
    v_exp_f32 v12, v12
    v_exp_f32 v13, v13
    v_smfmac_f32_16x16x64_bf16 v[196:199], v[240:243], v[120:127], v244
    s_waitcnt lgkmcnt(1)
    ds_read_b128 a[204:207], v137 offset:31744
    v_exp_f32 v14, v14
    v_exp_f32 v15, v15
    v_mfma_f32_32x32x16_bf16 v[96:111], a[216:219], a[240:243], v[32:47]
    v_exp_f32 v16, v16
    v_exp_f32 v17, v17
    v_exp_f32 v18, v18
    v_smfmac_f32_32x32x32_bf16 v[64:79], a[192:195], v[0:7], v244
    s_add_u32 s4, s42, s65
    s_addc_u32 s5, s43, 0
    v_exp_f32 v19, v19
    v_exp_f32 v20, v20
    v_exp_f32 v21, v21
    v_mfma_f32_32x32x16_bf16 v[96:111], a[220:223], a[244:247], v[96:111]
    s_add_u32 m0, s64, 16384
    v_exp_f32 v22, v22
    v_exp_f32 v23, v23
    v_exp_f32 v24, v24
    v_smfmac_f32_16x16x64_bf16 v[192:195], v[240:243], v[0:7], v244
    ds_read_b128 a[208:211], v137 offset:32768
    buffer_load_dwordx4 v246, s[4:7], 0 offen offset:0 sc1 lds
    v_exp_f32 v25, v25
    v_exp_f32 v26, v26
    v_smfmac_f32_32x32x32_bf16 v[64:79], a[196:199], v[8:15], v244
    buffer_load_dwordx4 v245, s[4:7], 0 offen offset:1024 sc1 lds
    s_add_u32 s8, s48, s65
    s_addc_u32 s9, s49, 0
    v_exp_f32 v27, v27
    v_exp_f32 v28, v28
    v_exp_f32 v29, v29
    v_smfmac_f32_16x16x64_bf16 v[192:195], v[240:243], v[8:15], v244
    s_waitcnt lgkmcnt(1)
    ds_read_b128 a[212:215], v137 offset:33792
    v_exp_f32 v30, v30
    v_exp_f32 v31, v31
    v_mfma_f32_32x32x16_bf16 v[112:127], a[216:219], a[248:251], v[48:63]
    s_add_u32 m0, s64, 24576
    v_exp_f32 v96, v96
    v_exp_f32 v97, v97
    v_exp_f32 v98, v98
    v_smfmac_f32_32x32x32_bf16 v[80:95], a[192:195], v[16:23], v244
    buffer_load_dwordx4 v254, s[8:11], 0 offen offset:0 sc1 lds
    v_exp_f32 v99, v99
    v_exp_f32 v100, v100
    v_exp_f32 v101, v101
    v_mfma_f32_32x32x16_bf16 v[112:127], a[220:223], a[252:255], v[112:127]
    buffer_load_dwordx4 v254, s[8:11], 0 offen offset:1024 sc1 lds
    s_add_u32 s65, s65, 8192
    v_exp_f32 v102, v102
    v_exp_f32 v103, v103
    v_exp_f32 v104, v104
    v_smfmac_f32_16x16x64_bf16 v[196:199], v[240:243], v[16:23], v244
    ds_read_b128 a[224:227], v137 offset:40960
    v_exp_f32 v105, v105
    v_exp_f32 v106, v106
    v_smfmac_f32_32x32x32_bf16 v[80:95], a[196:199], v[24:31], v244
    s_and_b32 s65, s65, 0x1ffff
    v_exp_f32 v107, v107
    v_exp_f32 v108, v108
    v_exp_f32 v109, v109
    v_smfmac_f32_16x16x64_bf16 v[196:199], v[240:243], v[24:31], v244
    s_waitcnt lgkmcnt(1)
    ds_read_b128 a[228:231], v137 offset:41984
    v_exp_f32 v110, v110
    v_exp_f32 v111, v111
    v_mfma_f32_32x32x16_bf16 v[0:15], a[208:211], a[240:243], v[32:47]
    v_exp_f32 v112, v112
    v_exp_f32 v113, v113
    v_exp_f32 v114, v114
    v_smfmac_f32_32x32x32_bf16 v[64:79], a[200:203], v[96:103], v244
    s_add_u32 s4, s42, s65
    s_addc_u32 s5, s43, 0
    v_exp_f32 v115, v115
    v_exp_f32 v116, v116
    v_exp_f32 v117, v117
    v_mfma_f32_32x32x16_bf16 v[0:15], a[212:215], a[244:247], v[0:15]
    s_add_u32 m0, s64, 32768
    v_exp_f32 v118, v118
    v_exp_f32 v119, v119
    v_exp_f32 v120, v120
    v_smfmac_f32_16x16x64_bf16 v[192:195], v[240:243], v[96:103], v244
    ds_read_b128 a[216:219], v137 offset:34816
    buffer_load_dwordx4 v246, s[4:7], 0 offen offset:0 sc1 lds
    v_exp_f32 v121, v121
    v_exp_f32 v122, v122
    v_smfmac_f32_32x32x32_bf16 v[64:79], a[204:207], v[104:111], v244
    buffer_load_dwordx4 v245, s[4:7], 0 offen offset:1024 sc1 lds
    s_add_u32 s8, s48, s65
    s_addc_u32 s9, s49, 0
    v_exp_f32 v123, v123
    v_exp_f32 v124, v124
    v_exp_f32 v125, v125
    v_smfmac_f32_16x16x64_bf16 v[192:195], v[240:243], v[104:111], v244
    s_waitcnt lgkmcnt(1)
    ds_read_b128 a[220:223], v137 offset:35840
    v_exp_f32 v126, v126
    v_exp_f32 v127, v127
    v_mfma_f32_32x32x16_bf16 v[16:31], a[208:211], a[248:251], v[48:63]
    s_add_u32 m0, s64, 40960
    v_exp_f32 v0, v0
    v_exp_f32 v1, v1
    v_exp_f32 v2, v2
    v_smfmac_f32_32x32x32_bf16 v[80:95], a[200:203], v[112:119], v244
    buffer_load_dwordx4 v254, s[8:11], 0 offen offset:0 sc1 lds
    v_exp_f32 v3, v3
    v_exp_f32 v4, v4
    v_exp_f32 v5, v5
    v_mfma_f32_32x32x16_bf16 v[16:31], a[212:215], a[252:255], v[16:31]
    buffer_load_dwordx4 v254, s[8:11], 0 offen offset:1024 sc1 lds
    s_add_u32 s65, s65, 8192
    v_exp_f32 v6, v6
    v_exp_f32 v7, v7
    v_exp_f32 v8, v8
    v_smfmac_f32_16x16x64_bf16 v[196:199], v[240:243], v[112:119], v244
    ds_read_b128 a[232:235], v137 offset:43008
    v_exp_f32 v9, v9
    v_exp_f32 v10, v10
    v_smfmac_f32_32x32x32_bf16 v[80:95], a[204:207], v[120:127], v244
    s_and_b32 s65, s65, 0x1ffff
    v_exp_f32 v11, v11
    v_exp_f32 v12, v12
    v_exp_f32 v13, v13
    v_smfmac_f32_16x16x64_bf16 v[196:199], v[240:243], v[120:127], v244
    s_waitcnt lgkmcnt(1)
    ds_read_b128 a[236:239], v137 offset:44032
    v_exp_f32 v14, v14
    v_exp_f32 v15, v15
    v_mfma_f32_32x32x16_bf16 v[96:111], a[216:219], a[240:243], v[32:47]
    v_add_u32 v142, 147456, v142
    v_exp_f32 v16, v16
    v_exp_f32 v17, v17
    v_exp_f32 v18, v18
    v_smfmac_f32_32x32x32_bf16 v[64:79], a[224:227], v[0:7], v244
    s_add_u32 s4, s42, s65
    s_addc_u32 s5, s43, 0
    v_exp_f32 v19, v19
    v_exp_f32 v20, v20
    v_exp_f32 v21, v21
    v_mfma_f32_32x32x16_bf16 v[96:111], a[220:223], a[244:247], v[96:111]
    s_add_u32 m0, s64, 49152
    v_add_u32 v143, 147456, v143
    v_exp_f32 v22, v22
    v_exp_f32 v23, v23
    v_exp_f32 v24, v24
    v_smfmac_f32_16x16x64_bf16 v[192:195], v[240:243], v[0:7], v244
    ds_read_b128 a[208:211], v137 offset:36864
    buffer_load_dwordx4 v246, s[4:7], 0 offen offset:0 sc1 lds
    v_exp_f32 v25, v25
    v_exp_f32 v26, v26
    v_smfmac_f32_32x32x32_bf16 v[64:79], a[228:231], v[8:15], v244
    buffer_load_dwordx4 v245, s[4:7], 0 offen offset:1024 sc1 lds
    s_add_u32 s8, s48, s65
    s_addc_u32 s9, s49, 0
    v_exp_f32 v27, v27
    v_exp_f32 v28, v28
    v_exp_f32 v29, v29
    v_smfmac_f32_16x16x64_bf16 v[192:195], v[240:243], v[8:15], v244
    s_waitcnt lgkmcnt(1)
    ds_read_b128 a[212:215], v137 offset:37888
    v_exp_f32 v30, v30
    v_exp_f32 v31, v31
    v_mfma_f32_32x32x16_bf16 v[112:127], a[216:219], a[248:251], v[48:63]
    s_add_u32 m0, s64, 57344
    v_exp_f32 v96, v96
    v_exp_f32 v97, v97
    v_exp_f32 v98, v98
    v_smfmac_f32_32x32x32_bf16 v[80:95], a[224:227], v[16:23], v244
    buffer_load_dwordx4 v254, s[8:11], 0 offen offset:0 sc1 lds
    v_exp_f32 v99, v99
    v_exp_f32 v100, v100
    v_exp_f32 v101, v101
    v_mfma_f32_32x32x16_bf16 v[112:127], a[220:223], a[252:255], v[112:127]
    buffer_load_dwordx4 v254, s[8:11], 0 offen offset:1024 sc1 lds
    s_add_u32 s65, s65, 8192
    v_exp_f32 v102, v102
    v_exp_f32 v103, v103
    v_exp_f32 v104, v104
    v_smfmac_f32_16x16x64_bf16 v[196:199], v[240:243], v[16:23], v244
    ds_read_b128 a[192:195], v137 offset:45056
    v_exp_f32 v105, v105
    v_exp_f32 v106, v106
    v_smfmac_f32_32x32x32_bf16 v[80:95], a[228:231], v[24:31], v244
    s_and_b32 s65, s65, 0x1ffff
    v_exp_f32 v107, v107
    v_exp_f32 v108, v108
    v_exp_f32 v109, v109
    v_smfmac_f32_16x16x64_bf16 v[196:199], v[240:243], v[24:31], v244
    s_waitcnt lgkmcnt(1)
    ds_read_b128 a[196:199], v137 offset:46080
    v_exp_f32 v110, v110
    v_exp_f32 v111, v111
    v_mfma_f32_32x32x16_bf16 v[0:15], a[208:211], a[240:243], v[32:47]
    buffer_store_dwordx4 v[156:159], v142, s[16:19], 0 offen offset:0 sc1
    v_exp_f32 v112, v112
    v_exp_f32 v113, v113
    v_exp_f32 v114, v114
    v_smfmac_f32_32x32x32_bf16 v[64:79], a[232:235], v[96:103], v244
    v_exp_f32 v115, v115
    v_exp_f32 v116, v116
    v_exp_f32 v117, v117
    v_mfma_f32_32x32x16_bf16 v[0:15], a[212:215], a[244:247], v[0:15]
    v_exp_f32 v118, v118
    v_exp_f32 v119, v119
    v_exp_f32 v120, v120
    v_smfmac_f32_16x16x64_bf16 v[192:195], v[240:243], v[96:103], v244
    ds_read_b128 a[216:219], v137 offset:38912
    v_exp_f32 v121, v121
    v_exp_f32 v122, v122
    v_smfmac_f32_32x32x32_bf16 v[64:79], a[236:239], v[104:111], v244
    buffer_store_dwordx4 v[172:175], v142, s[16:19], 0 offen offset:1024 sc1
    v_exp_f32 v123, v123
    v_exp_f32 v124, v124
    v_exp_f32 v125, v125
    v_smfmac_f32_16x16x64_bf16 v[192:195], v[240:243], v[104:111], v244
    s_waitcnt lgkmcnt(1)
    ds_read_b128 a[220:223], v137 offset:39936
    v_exp_f32 v126, v126
    v_exp_f32 v127, v127
    v_mfma_f32_32x32x16_bf16 v[16:31], a[208:211], a[248:251], v[48:63]
    v_exp_f32 v0, v0
    v_exp_f32 v1, v1
    v_exp_f32 v2, v2
    v_smfmac_f32_32x32x32_bf16 v[80:95], a[232:235], v[112:119], v244
    v_exp_f32 v3, v3
    v_exp_f32 v4, v4
    v_exp_f32 v5, v5
    v_mfma_f32_32x32x16_bf16 v[16:31], a[212:215], a[252:255], v[16:31]
    v_exp_f32 v6, v6
    v_exp_f32 v7, v7
    v_exp_f32 v8, v8
    v_smfmac_f32_16x16x64_bf16 v[196:199], v[240:243], v[112:119], v244
    ds_read_b128 a[200:203], v137 offset:47104
    v_exp_f32 v9, v9
    v_exp_f32 v10, v10
    v_smfmac_f32_32x32x32_bf16 v[80:95], a[236:239], v[120:127], v244
    v_exp_f32 v11, v11
    v_exp_f32 v12, v12
    v_exp_f32 v13, v13
    v_smfmac_f32_16x16x64_bf16 v[196:199], v[240:243], v[120:127], v244
    s_waitcnt lgkmcnt(1)
    ds_read_b128 a[204:207], v137 offset:48128
    v_exp_f32 v14, v14
    v_exp_f32 v15, v15
    v_mfma_f32_32x32x16_bf16 v[96:111], a[216:219], a[240:243], v[32:47]
    v_exp_f32 v16, v16
    v_exp_f32 v17, v17
    v_exp_f32 v18, v18
    v_smfmac_f32_32x32x32_bf16 v[64:79], a[192:195], v[0:7], v244
    v_exp_f32 v19, v19
    v_exp_f32 v20, v20
    v_exp_f32 v21, v21
    v_mfma_f32_32x32x16_bf16 v[96:111], a[220:223], a[244:247], v[96:111]
    v_exp_f32 v22, v22
    v_exp_f32 v23, v23
    v_exp_f32 v24, v24
    v_smfmac_f32_16x16x64_bf16 v[192:195], v[240:243], v[0:7], v244
    ds_read_b128 a[208:211], v137 offset:49152
    v_exp_f32 v25, v25
    v_exp_f32 v26, v26
    v_smfmac_f32_32x32x32_bf16 v[64:79], a[196:199], v[8:15], v244
    v_exp_f32 v27, v27
    v_exp_f32 v28, v28
    v_exp_f32 v29, v29
    v_smfmac_f32_16x16x64_bf16 v[192:195], v[240:243], v[8:15], v244
    s_waitcnt lgkmcnt(1)
    ds_read_b128 a[212:215], v137 offset:50176
    v_exp_f32 v30, v30
    v_exp_f32 v31, v31
    v_mfma_f32_32x32x16_bf16 v[112:127], a[216:219], a[248:251], v[48:63]
    v_exp_f32 v96, v96
    v_exp_f32 v97, v97
    v_exp_f32 v98, v98
    v_smfmac_f32_32x32x32_bf16 v[80:95], a[192:195], v[16:23], v244
    v_exp_f32 v99, v99
    v_exp_f32 v100, v100
    v_exp_f32 v101, v101
    v_mfma_f32_32x32x16_bf16 v[112:127], a[220:223], a[252:255], v[112:127]
    v_exp_f32 v102, v102
    v_exp_f32 v103, v103
    v_exp_f32 v104, v104
    v_smfmac_f32_16x16x64_bf16 v[196:199], v[240:243], v[16:23], v244
    ds_read_b128 a[224:227], v137 offset:57344
    v_exp_f32 v105, v105
    v_exp_f32 v106, v106
    v_smfmac_f32_32x32x32_bf16 v[80:95], a[196:199], v[24:31], v244
    v_exp_f32 v107, v107
    v_exp_f32 v108, v108
    v_exp_f32 v109, v109
    v_smfmac_f32_16x16x64_bf16 v[196:199], v[240:243], v[24:31], v244
    s_waitcnt lgkmcnt(1)
    ds_read_b128 a[228:231], v137 offset:58368
    v_exp_f32 v110, v110
    v_exp_f32 v111, v111
    v_mfma_f32_32x32x16_bf16 v[0:15], a[208:211], a[240:243], v[32:47]
    v_exp_f32 v112, v112
    v_exp_f32 v113, v113
    v_exp_f32 v114, v114
    v_smfmac_f32_32x32x32_bf16 v[64:79], a[200:203], v[96:103], v244
    v_exp_f32 v115, v115
    v_exp_f32 v116, v116
    v_exp_f32 v117, v117
    v_mfma_f32_32x32x16_bf16 v[0:15], a[212:215], a[244:247], v[0:15]
    v_exp_f32 v118, v118
    v_exp_f32 v119, v119
    v_exp_f32 v120, v120
    v_smfmac_f32_16x16x64_bf16 v[192:195], v[240:243], v[96:103], v244
    ds_read_b128 a[216:219], v137 offset:51200
    v_exp_f32 v121, v121
    v_exp_f32 v122, v122
    v_smfmac_f32_32x32x32_bf16 v[64:79], a[204:207], v[104:111], v244
    v_exp_f32 v123, v123
    v_exp_f32 v124, v124
    v_exp_f32 v125, v125
    v_smfmac_f32_16x16x64_bf16 v[192:195], v[240:243], v[104:111], v244
    s_waitcnt lgkmcnt(1)
    ds_read_b128 a[220:223], v137 offset:52224
    v_exp_f32 v126, v126
    v_exp_f32 v127, v127
    v_mfma_f32_32x32x16_bf16 v[16:31], a[208:211], a[248:251], v[48:63]
    v_exp_f32 v0, v0
    v_exp_f32 v1, v1
    v_exp_f32 v2, v2
    v_smfmac_f32_32x32x32_bf16 v[80:95], a[200:203], v[112:119], v244
    v_exp_f32 v3, v3
    v_exp_f32 v4, v4
    v_exp_f32 v5, v5
    v_mfma_f32_32x32x16_bf16 v[16:31], a[212:215], a[252:255], v[16:31]
    v_exp_f32 v6, v6
    v_exp_f32 v7, v7
    v_exp_f32 v8, v8
    v_smfmac_f32_16x16x64_bf16 v[196:199], v[240:243], v[112:119], v244
    ds_read_b128 a[232:235], v137 offset:59392
    v_exp_f32 v9, v9
    v_exp_f32 v10, v10
    v_smfmac_f32_32x32x32_bf16 v[80:95], a[204:207], v[120:127], v244
    v_exp_f32 v11, v11
    v_exp_f32 v12, v12
    v_exp_f32 v13, v13
    v_smfmac_f32_16x16x64_bf16 v[196:199], v[240:243], v[120:127], v244
    s_waitcnt lgkmcnt(1)
    ds_read_b128 a[236:239], v137 offset:60416
    v_exp_f32 v14, v14
    v_exp_f32 v15, v15
    v_mfma_f32_32x32x16_bf16 v[96:111], a[216:219], a[240:243], v[32:47]
    buffer_store_dwordx4 v[188:191], v142, s[16:19], 0 offen offset:2048 sc1
    v_exp_f32 v16, v16
    v_exp_f32 v17, v17
    v_exp_f32 v18, v18
    v_smfmac_f32_32x32x32_bf16 v[64:79], a[224:227], v[0:7], v244
    v_exp_f32 v19, v19
    v_exp_f32 v20, v20
    v_exp_f32 v21, v21
    v_mfma_f32_32x32x16_bf16 v[96:111], a[220:223], a[244:247], v[96:111]
    v_exp_f32 v22, v22
    v_exp_f32 v23, v23
    v_exp_f32 v24, v24
    v_smfmac_f32_16x16x64_bf16 v[192:195], v[240:243], v[0:7], v244
    ds_read_b128 a[208:211], v137 offset:53248
    v_exp_f32 v25, v25
    v_exp_f32 v26, v26
    v_smfmac_f32_32x32x32_bf16 v[64:79], a[228:231], v[8:15], v244
    buffer_store_dwordx2 v[134:135], v143, s[16:19], 0 offen sc1
    v_exp_f32 v27, v27
    v_exp_f32 v28, v28
    v_exp_f32 v29, v29
    v_smfmac_f32_16x16x64_bf16 v[192:195], v[240:243], v[8:15], v244
    s_waitcnt lgkmcnt(1)
    ds_read_b128 a[212:215], v137 offset:54272
    v_exp_f32 v30, v30
    v_exp_f32 v31, v31
    v_mfma_f32_32x32x16_bf16 v[112:127], a[216:219], a[248:251], v[48:63]
    v_exp_f32 v96, v96
    v_exp_f32 v97, v97
    v_exp_f32 v98, v98
    v_smfmac_f32_32x32x32_bf16 v[80:95], a[224:227], v[16:23], v244
    v_exp_f32 v99, v99
    v_exp_f32 v100, v100
    v_exp_f32 v101, v101
    v_mfma_f32_32x32x16_bf16 v[112:127], a[220:223], a[252:255], v[112:127]
    v_exp_f32 v102, v102
    v_exp_f32 v103, v103
    v_exp_f32 v104, v104
    v_smfmac_f32_16x16x64_bf16 v[196:199], v[240:243], v[16:23], v244
    ds_read_b128 a[192:195], v137 offset:61440
    v_exp_f32 v105, v105
    v_exp_f32 v106, v106
    v_smfmac_f32_32x32x32_bf16 v[80:95], a[228:231], v[24:31], v244
    v_exp_f32 v107, v107
    v_exp_f32 v108, v108
    v_exp_f32 v109, v109
    v_smfmac_f32_16x16x64_bf16 v[196:199], v[240:243], v[24:31], v244
    s_waitcnt lgkmcnt(1)
    ds_read_b128 a[196:199], v137 offset:62464
    v_exp_f32 v110, v110
    v_exp_f32 v111, v111
    v_mfma_f32_32x32x16_bf16 v[0:15], a[208:211], a[240:243], v[32:47]
    v_exp_f32 v112, v112
    v_exp_f32 v113, v113
    v_exp_f32 v114, v114
    v_smfmac_f32_32x32x32_bf16 v[64:79], a[232:235], v[96:103], v244
    v_exp_f32 v115, v115
    v_exp_f32 v116, v116
    v_exp_f32 v117, v117
    v_mfma_f32_32x32x16_bf16 v[0:15], a[212:215], a[244:247], v[0:15]
    v_exp_f32 v118, v118
    v_exp_f32 v119, v119
    v_exp_f32 v120, v120
    v_smfmac_f32_16x16x64_bf16 v[192:195], v[240:243], v[96:103], v244
    ds_read_b128 a[216:219], v137 offset:55296
    v_exp_f32 v121, v121
    v_exp_f32 v122, v122
    v_smfmac_f32_32x32x32_bf16 v[64:79], a[236:239], v[104:111], v244
    v_exp_f32 v123, v123
    v_exp_f32 v124, v124
    v_exp_f32 v125, v125
    v_smfmac_f32_16x16x64_bf16 v[192:195], v[240:243], v[104:111], v244
    s_waitcnt lgkmcnt(1)
    ds_read_b128 a[220:223], v137 offset:56320
    v_exp_f32 v126, v126
    v_exp_f32 v127, v127
    v_mfma_f32_32x32x16_bf16 v[16:31], a[208:211], a[248:251], v[48:63]
    s_and_b32 s57, s2, 3
    v_exp_f32 v0, v0
    v_exp_f32 v1, v1
    v_exp_f32 v2, v2
    v_smfmac_f32_32x32x32_bf16 v[80:95], a[232:235], v[112:119], v244
    s_bfe_u32 s39, s2, 0x10002
    s_lshl_b32 s39, s39, 2
    v_exp_f32 v3, v3
    v_exp_f32 v4, v4
    v_exp_f32 v5, v5
    v_mfma_f32_32x32x16_bf16 v[16:31], a[212:215], a[252:255], v[16:31]
    s_and_b32 s71, s37, 3
    v_exp_f32 v6, v6
    v_exp_f32 v7, v7
    v_exp_f32 v8, v8
    v_smfmac_f32_16x16x64_bf16 v[196:199], v[240:243], v[112:119], v244
    ds_read_b128 a[200:203], v137 offset:63488
    v_exp_f32 v9, v9
    v_exp_f32 v10, v10
    v_smfmac_f32_32x32x32_bf16 v[80:95], a[236:239], v[120:127], v244
    s_add_u32 s71, s71, s39
    s_lshl_b32 s56, s36, 3
    v_exp_f32 v11, v11
    v_exp_f32 v12, v12
    v_exp_f32 v13, v13
    v_smfmac_f32_16x16x64_bf16 v[196:199], v[240:243], v[120:127], v244
    s_waitcnt lgkmcnt(1)
    ds_read_b128 a[204:207], v137 offset:64512
    v_exp_f32 v14, v14
    v_exp_f32 v15, v15
    v_mfma_f32_32x32x16_bf16 v[96:111], a[216:219], a[240:243], v[32:47]
    s_add_u32 s56, s56, s71
    v_exp_f32 v16, v16
    v_exp_f32 v17, v17
    v_exp_f32 v18, v18
    v_smfmac_f32_32x32x32_bf16 v[64:79], a[192:195], v[0:7], v244
    s_lshl_b32 s54, s3, 11
    s_lshl_b32 s39, s36, 2
    v_exp_f32 v19, v19
    v_exp_f32 v20, v20
    v_exp_f32 v21, v21
    v_mfma_f32_32x32x16_bf16 v[96:111], a[220:223], a[244:247], v[96:111]
    s_add_u32 s39, s39, s3
    v_exp_f32 v22, v22
    v_exp_f32 v23, v23
    v_exp_f32 v24, v24
    v_smfmac_f32_16x16x64_bf16 v[192:195], v[240:243], v[0:7], v244
    ds_read_b128 a[208:211], v254 offset:0
    v_exp_f32 v25, v25
    v_exp_f32 v26, v26
    v_smfmac_f32_32x32x32_bf16 v[64:79], a[196:199], v[8:15], v244
    s_mul_i32 s50, s39, 589824
    s_add_u32 s50, s50, 0xc00000
    v_exp_f32 v27, v27
    v_exp_f32 v28, v28
    v_exp_f32 v29, v29
    v_smfmac_f32_16x16x64_bf16 v[192:195], v[240:243], v[8:15], v244
    s_waitcnt lgkmcnt(1)
    ds_read_b128 a[212:215], v254 offset:1024
    v_exp_f32 v30, v30
    v_exp_f32 v31, v31
    v_mfma_f32_32x32x16_bf16 v[112:127], a[216:219], a[248:251], v[48:63]
    s_mul_i32 s66, s57, 20480
    v_exp_f32 v96, v96
    v_exp_f32 v97, v97
    v_exp_f32 v98, v98
    v_smfmac_f32_32x32x32_bf16 v[80:95], a[192:195], v[16:23], v244
    s_sub_u32 s66, 106496, s66
    s_mul_i32 s78, s57, 28672
    v_exp_f32 v99, v99
    v_exp_f32 v100, v100
    v_exp_f32 v101, v101
    v_mfma_f32_32x32x16_bf16 v[112:127], a[220:223], a[252:255], v[112:127]
    s_add_u32 s50, s50, s78
    v_exp_f32 v102, v102
    v_exp_f32 v103, v103
    v_exp_f32 v104, v104
    v_smfmac_f32_16x16x64_bf16 v[196:199], v[240:243], v[16:23], v244
    ds_read_b128 a[224:227], v254 offset:8192
    v_exp_f32 v105, v105
    v_exp_f32 v106, v106
    v_smfmac_f32_32x32x32_bf16 v[80:95], a[196:199], v[24:31], v244
    s_mul_i32 s63, s57, 1835008
    v_exp_f32 v107, v107
    v_exp_f32 v108, v108
    v_exp_f32 v109, v109
    v_smfmac_f32_16x16x64_bf16 v[196:199], v[240:243], v[24:31], v244
    s_waitcnt lgkmcnt(1)
    ds_read_b128 a[228:231], v254 offset:9216
    v_exp_f32 v110, v110
    v_exp_f32 v111, v111
    v_mfma_f32_32x32x16_bf16 v[0:15], a[208:211], a[240:243], v[32:47]
    v_exp_f32 v112, v112
    v_exp_f32 v113, v113
    v_exp_f32 v114, v114
    v_smfmac_f32_32x32x32_bf16 v[64:79], a[200:203], v[96:103], v244
    s_add_u32 s12, s60, s50
    s_addc_u32 s13, s61, 0
    v_exp_f32 v115, v115
    v_exp_f32 v116, v116
    v_exp_f32 v117, v117
    v_mfma_f32_32x32x16_bf16 v[0:15], a[212:215], a[244:247], v[0:15]
    s_mov_b32 s14, 0x90000
    v_exp_f32 v118, v118
    v_exp_f32 v119, v119
    v_exp_f32 v120, v120
    v_smfmac_f32_16x16x64_bf16 v[192:195], v[240:243], v[96:103], v244
    ds_read_b128 a[216:219], v254 offset:2048
    v_exp_f32 v121, v121
    v_exp_f32 v122, v122
    v_smfmac_f32_32x32x32_bf16 v[64:79], a[204:207], v[104:111], v244
    s_mov_b32 s15, 0x20000
    v_exp_f32 v123, v123
    v_exp_f32 v124, v124
    v_exp_f32 v125, v125
    v_smfmac_f32_16x16x64_bf16 v[192:195], v[240:243], v[104:111], v244
    s_waitcnt lgkmcnt(1)
    ds_read_b128 a[220:223], v254 offset:3072
    v_exp_f32 v126, v126
    v_exp_f32 v127, v127
    v_mfma_f32_32x32x16_bf16 v[16:31], a[208:211], a[248:251], v[48:63]
    v_exp_f32 v0, v0
    v_exp_f32 v1, v1
    v_exp_f32 v2, v2
    v_smfmac_f32_32x32x32_bf16 v[80:95], a[200:203], v[112:119], v244
    s_add_u32 s20, s52, s63
    s_addc_u32 s21, s53, 0
    v_exp_f32 v3, v3
    v_exp_f32 v4, v4
    v_exp_f32 v5, v5
    v_mfma_f32_32x32x16_bf16 v[16:31], a[212:215], a[252:255], v[16:31]
    s_sub_u32 s22, 0x680000, s63
    v_exp_f32 v6, v6
    v_exp_f32 v7, v7
    v_exp_f32 v8, v8
    v_smfmac_f32_16x16x64_bf16 v[196:199], v[240:243], v[112:119], v244
    ds_read_b128 a[232:235], v254 offset:10240
    v_exp_f32 v9, v9
    v_exp_f32 v10, v10
    v_smfmac_f32_32x32x32_bf16 v[80:95], a[204:207], v[120:127], v244
    s_lshl_b32 s72, s36, 7
    s_add_u32 s72, s72, 0x1e03400
    v_exp_f32 v11, v11
    v_exp_f32 v12, v12
    v_exp_f32 v13, v13
    v_smfmac_f32_16x16x64_bf16 v[196:199], v[240:243], v[120:127], v244
    s_waitcnt lgkmcnt(1)
    ds_read_b128 a[236:239], v254 offset:11264
    v_exp_f32 v14, v14
    v_exp_f32 v15, v15
    v_mfma_f32_32x32x16_bf16 v[96:111], a[216:219], a[240:243], v[32:47]
    s_lshl_b32 s78, s3, 3
    v_exp_f32 v16, v16
    v_exp_f32 v17, v17
    v_exp_f32 v18, v18
    v_smfmac_f32_32x32x32_bf16 v[64:79], a[224:227], v[0:7], v244
    s_lshl_b32 s79, s71, 8
    v_lshrrev_b32 v224, 4, v255
    v_exp_f32 v19, v19
    v_exp_f32 v20, v20
    v_exp_f32 v21, v21
    v_mfma_f32_32x32x16_bf16 v[96:111], a[220:223], a[244:247], v[96:111]
    v_add_u32 v224, s78, v224
    v_exp_f32 v22, v22
    v_exp_f32 v23, v23
    v_exp_f32 v24, v24
    v_smfmac_f32_16x16x64_bf16 v[192:195], v[240:243], v[0:7], v244
    ds_read_b128 a[208:211], v254 offset:4096
    v_lshlrev_b32 v225, 1, v224
    v_exp_f32 v25, v25
    v_exp_f32 v26, v26
    v_smfmac_f32_32x32x32_bf16 v[64:79], a[228:231], v[8:15], v244
    v_xor_b32 v225, v225, v255
    v_exp_f32 v27, v27
    v_exp_f32 v28, v28
    v_exp_f32 v29, v29
    v_smfmac_f32_16x16x64_bf16 v[192:195], v[240:243], v[8:15], v244
    s_waitcnt lgkmcnt(1)
    ds_read_b128 a[212:215], v254 offset:5120
    v_and_b32 v225, 15, v225
    v_exp_f32 v30, v30
    v_exp_f32 v31, v31
    v_mfma_f32_32x32x16_bf16 v[112:127], a[216:219], a[248:251], v[48:63]
    v_lshlrev_b32 v225, 4, v225
    v_exp_f32 v96, v96
    v_exp_f32 v97, v97
    v_exp_f32 v98, v98
    v_smfmac_f32_32x32x32_bf16 v[80:95], a[224:227], v[16:23], v244
    v_lshl_add_u32 v225, v224, 11, v225
    v_exp_f32 v99, v99
    v_exp_f32 v100, v100
    v_exp_f32 v101, v101
    v_mfma_f32_32x32x16_bf16 v[112:127], a[220:223], a[252:255], v[112:127]
    v_add_u32 v232, s79, v225
    v_exp_f32 v102, v102
    v_exp_f32 v103, v103
    v_exp_f32 v104, v104
    v_smfmac_f32_16x16x64_bf16 v[196:199], v[240:243], v[16:23], v244
    ds_read_b128 a[192:195], v254 offset:12288
    v_xor_b32 v225, 128, v232
    v_exp_f32 v105, v105
    v_exp_f32 v106, v106
    v_smfmac_f32_32x32x32_bf16 v[80:95], a[228:231], v[24:31], v244
    v_add_u32 v233, 7168, v225
    v_exp_f32 v107, v107
    v_exp_f32 v108, v108
    v_exp_f32 v109, v109
    v_smfmac_f32_16x16x64_bf16 v[196:199], v[240:243], v[24:31], v244
    s_waitcnt lgkmcnt(1)
    ds_read_b128 a[196:199], v254 offset:13312
    v_and_b32 v224, 15, v255
    v_exp_f32 v110, v110
    v_exp_f32 v111, v111
    v_mfma_f32_32x32x16_bf16 v[0:15], a[208:211], a[240:243], v[32:47]
    v_lshlrev_b32 v226, 2, v224
    v_exp_f32 v112, v112
    v_exp_f32 v113, v113
    v_exp_f32 v114, v114
    v_smfmac_f32_32x32x32_bf16 v[64:79], a[232:235], v[96:103], v244
    v_mov_b32 v234, v254
    v_exp_f32 v115, v115
    v_exp_f32 v116, v116
    v_exp_f32 v117, v117
    v_mfma_f32_32x32x16_bf16 v[0:15], a[212:215], a[244:247], v[0:15]
    v_add_u32 v235, 147456, v254
    v_exp_f32 v118, v118
    v_exp_f32 v119, v119
    v_exp_f32 v120, v120
    v_smfmac_f32_16x16x64_bf16 v[192:195], v[240:243], v[96:103], v244
    ds_read_b128 a[216:219], v254 offset:6144
    v_add_u32 v236, 294912, v254
    v_exp_f32 v121, v121
    v_exp_f32 v122, v122
    v_smfmac_f32_32x32x32_bf16 v[64:79], a[236:239], v[104:111], v244
    v_add_u32 v237, 442368, v254
    v_exp_f32 v123, v123
    v_exp_f32 v124, v124
    v_exp_f32 v125, v125
    v_smfmac_f32_16x16x64_bf16 v[192:195], v[240:243], v[104:111], v244
    s_waitcnt lgkmcnt(1)
    ds_read_b128 a[220:223], v254 offset:7168
    v_exp_f32 v126, v126
    v_exp_f32 v127, v127
    v_mfma_f32_32x32x16_bf16 v[16:31], a[208:211], a[248:251], v[48:63]
    s_waitcnt vmcnt(4)
    v_exp_f32 v0, v0
    v_exp_f32 v1, v1
    v_exp_f32 v2, v2
    v_smfmac_f32_32x32x32_bf16 v[80:95], a[232:235], v[112:119], v244
    s_barrier
    v_exp_f32 v3, v3
    v_exp_f32 v4, v4
    v_exp_f32 v5, v5
    v_mfma_f32_32x32x16_bf16 v[16:31], a[212:215], a[252:255], v[16:31]
    v_exp_f32 v6, v6
    v_exp_f32 v7, v7
    v_exp_f32 v8, v8
    v_smfmac_f32_16x16x64_bf16 v[196:199], v[240:243], v[112:119], v244
    ds_read_b128 a[200:203], v254 offset:14336
    v_exp_f32 v9, v9
    v_exp_f32 v10, v10
    v_smfmac_f32_32x32x32_bf16 v[80:95], a[236:239], v[120:127], v244
    v_exp_f32 v11, v11
    v_exp_f32 v12, v12
    v_exp_f32 v13, v13
    v_smfmac_f32_16x16x64_bf16 v[196:199], v[240:243], v[120:127], v244
    s_waitcnt lgkmcnt(1)
    ds_read_b128 a[204:207], v254 offset:15360
    v_exp_f32 v14, v14
    v_exp_f32 v15, v15
    v_mfma_f32_32x32x16_bf16 v[96:111], a[216:219], a[240:243], v[32:47]
    v_exp_f32 v16, v16
    v_exp_f32 v17, v17
    v_exp_f32 v18, v18
    v_smfmac_f32_32x32x32_bf16 v[64:79], a[192:195], v[0:7], v244
    s_add_u32 s4, s42, s65
    s_addc_u32 s5, s43, 0
    v_exp_f32 v19, v19
    v_exp_f32 v20, v20
    v_exp_f32 v21, v21
    v_mfma_f32_32x32x16_bf16 v[96:111], a[220:223], a[244:247], v[96:111]
    s_add_u32 m0, s64, 65536
    v_exp_f32 v22, v22
    v_exp_f32 v23, v23
    v_exp_f32 v24, v24
    v_smfmac_f32_16x16x64_bf16 v[192:195], v[240:243], v[0:7], v244
    ds_read_b128 a[208:211], v254 offset:16384
    buffer_load_dwordx4 v246, s[4:7], 0 offen offset:0 sc1 lds
    v_exp_f32 v25, v25
    v_exp_f32 v26, v26
    v_smfmac_f32_32x32x32_bf16 v[64:79], a[196:199], v[8:15], v244
    buffer_load_dwordx4 v245, s[4:7], 0 offen offset:1024 sc1 lds
    s_add_u32 s8, s48, s65
    s_addc_u32 s9, s49, 0
    v_exp_f32 v27, v27
    v_exp_f32 v28, v28
    v_exp_f32 v29, v29
    v_smfmac_f32_16x16x64_bf16 v[192:195], v[240:243], v[8:15], v244
    s_waitcnt lgkmcnt(1)
    ds_read_b128 a[212:215], v254 offset:17408
    v_exp_f32 v30, v30
    v_exp_f32 v31, v31
    v_mfma_f32_32x32x16_bf16 v[112:127], a[216:219], a[248:251], v[48:63]
    s_add_u32 m0, s64, 73728
    v_exp_f32 v96, v96
    v_exp_f32 v97, v97
    v_exp_f32 v98, v98
    v_smfmac_f32_32x32x32_bf16 v[80:95], a[192:195], v[16:23], v244
    buffer_load_dwordx4 v254, s[8:11], 0 offen offset:0 sc1 lds
    s_lshl_b32 s74, s56, 2
    s_add_u32 s74, s74, s57
    v_exp_f32 v99, v99
    v_exp_f32 v100, v100
    v_exp_f32 v101, v101
    v_mfma_f32_32x32x16_bf16 v[112:127], a[220:223], a[252:255], v[112:127]
    buffer_load_dwordx4 v254, s[8:11], 0 offen offset:1024 sc1 lds
    s_add_u32 s65, s65, 8192
    v_exp_f32 v102, v102
    v_exp_f32 v103, v103
    v_exp_f32 v104, v104
    v_smfmac_f32_16x16x64_bf16 v[196:199], v[240:243], v[16:23], v244
    ds_read_b128 a[224:227], v254 offset:24576
    v_exp_f32 v105, v105
    v_exp_f32 v106, v106
    v_smfmac_f32_32x32x32_bf16 v[80:95], a[196:199], v[24:31], v244
    s_and_b32 s65, s65, 0x1ffff
    s_lshl_b32 s74, s74, 2
    v_exp_f32 v107, v107
    v_exp_f32 v108, v108
    v_exp_f32 v109, v109
    v_smfmac_f32_16x16x64_bf16 v[196:199], v[240:243], v[24:31], v244
    s_waitcnt lgkmcnt(1)
    ds_read_b128 a[228:231], v254 offset:25600
    v_exp_f32 v110, v110
    v_exp_f32 v111, v111
    v_mfma_f32_32x32x16_bf16 v[0:15], a[208:211], a[240:243], v[32:47]
    s_add_u32 s74, s74, s3
    v_exp_f32 v112, v112
    v_exp_f32 v113, v113
    v_exp_f32 v114, v114
    v_smfmac_f32_32x32x32_bf16 v[64:79], a[200:203], v[96:103], v244
    s_add_u32 s4, s42, s65
    s_addc_u32 s5, s43, 0
    v_exp_f32 v115, v115
    v_exp_f32 v116, v116
    v_exp_f32 v117, v117
    v_mfma_f32_32x32x16_bf16 v[0:15], a[212:215], a[244:247], v[0:15]
    s_add_u32 m0, s64, 81920
    v_exp_f32 v118, v118
    v_exp_f32 v119, v119
    v_exp_f32 v120, v120
    v_smfmac_f32_16x16x64_bf16 v[192:195], v[240:243], v[96:103], v244
    ds_read_b128 a[216:219], v254 offset:18432
    buffer_load_dwordx4 v246, s[4:7], 0 offen offset:0 sc1 lds
    v_exp_f32 v121, v121
    v_exp_f32 v122, v122
    v_smfmac_f32_32x32x32_bf16 v[64:79], a[204:207], v[104:111], v244
    buffer_load_dwordx4 v245, s[4:7], 0 offen offset:1024 sc1 lds
    s_add_u32 s8, s48, s65
    s_addc_u32 s9, s49, 0
    v_exp_f32 v123, v123
    v_exp_f32 v124, v124
    v_exp_f32 v125, v125
    v_smfmac_f32_16x16x64_bf16 v[192:195], v[240:243], v[104:111], v244
    s_waitcnt lgkmcnt(1)
    ds_read_b128 a[220:223], v254 offset:19456
    v_exp_f32 v126, v126
    v_exp_f32 v127, v127
    v_mfma_f32_32x32x16_bf16 v[16:31], a[208:211], a[248:251], v[48:63]
    s_add_u32 m0, s64, 90112
    v_exp_f32 v0, v0
    v_exp_f32 v1, v1
    v_exp_f32 v2, v2
    v_smfmac_f32_32x32x32_bf16 v[80:95], a[200:203], v[112:119], v244
    buffer_load_dwordx4 v254, s[8:11], 0 offen offset:0 sc1 lds
    s_mul_i32 s74, s74, 12288
    s_add_u32 s74, s74, 0x2400000
    v_exp_f32 v3, v3
    v_exp_f32 v4, v4
    v_exp_f32 v5, v5
    v_mfma_f32_32x32x16_bf16 v[16:31], a[212:215], a[252:255], v[16:31]
    buffer_load_dwordx4 v254, s[8:11], 0 offen offset:1024 sc1 lds
    s_add_u32 s65, s65, 8192
    v_mov_b32 v228, -1
    v_exp_f32 v6, v6
    v_exp_f32 v7, v7
    v_exp_f32 v8, v8
    v_smfmac_f32_16x16x64_bf16 v[196:199], v[240:243], v[112:119], v244
    ds_read_b128 a[232:235], v254 offset:26624
    v_mov_b32 v229, -1
    v_exp_f32 v9, v9
    v_exp_f32 v10, v10
    v_smfmac_f32_32x32x32_bf16 v[80:95], a[204:207], v[120:127], v244
    s_and_b32 s65, s65, 0x1ffff
    v_mov_b32 v230, -1
    v_exp_f32 v11, v11
    v_exp_f32 v12, v12
    v_exp_f32 v13, v13
    v_smfmac_f32_16x16x64_bf16 v[196:199], v[240:243], v[120:127], v244
    s_waitcnt lgkmcnt(1)
    ds_read_b128 a[236:239], v254 offset:27648
    v_mov_b32 v231, -1
    v_exp_f32 v14, v14
    v_exp_f32 v15, v15
    v_mfma_f32_32x32x16_bf16 v[96:111], a[216:219], a[240:243], v[32:47]
    v_add_u32 v227, s74, v254
    v_exp_f32 v16, v16
    v_exp_f32 v17, v17
    v_exp_f32 v18, v18
    v_smfmac_f32_32x32x32_bf16 v[64:79], a[224:227], v[0:7], v244
    s_add_u32 s4, s42, s65
    s_addc_u32 s5, s43, 0
    v_exp_f32 v19, v19
    v_exp_f32 v20, v20
    v_exp_f32 v21, v21
    v_mfma_f32_32x32x16_bf16 v[96:111], a[220:223], a[244:247], v[96:111]
    s_add_u32 m0, s64, 98304
    v_exp_f32 v22, v22
    v_exp_f32 v23, v23
    v_exp_f32 v24, v24
    v_smfmac_f32_16x16x64_bf16 v[192:195], v[240:243], v[0:7], v244
    ds_read_b128 a[208:211], v254 offset:20480
    buffer_load_dwordx4 v246, s[4:7], 0 offen offset:0 sc1 lds
    v_exp_f32 v25, v25
    v_exp_f32 v26, v26
    v_smfmac_f32_32x32x32_bf16 v[64:79], a[228:231], v[8:15], v244
    buffer_load_dwordx4 v245, s[4:7], 0 offen offset:1024 sc1 lds
    s_add_u32 s8, s48, s65
    s_addc_u32 s9, s49, 0
    v_exp_f32 v27, v27
    v_exp_f32 v28, v28
    v_exp_f32 v29, v29
    v_smfmac_f32_16x16x64_bf16 v[192:195], v[240:243], v[8:15], v244
    s_waitcnt lgkmcnt(1)
    ds_read_b128 a[212:215], v254 offset:21504
    v_exp_f32 v30, v30
    v_exp_f32 v31, v31
    v_mfma_f32_32x32x16_bf16 v[112:127], a[216:219], a[248:251], v[48:63]
    s_add_u32 m0, s64, 106496
    v_exp_f32 v96, v96
    v_exp_f32 v97, v97
    v_exp_f32 v98, v98
    v_smfmac_f32_32x32x32_bf16 v[80:95], a[224:227], v[16:23], v244
    buffer_load_dwordx4 v254, s[8:11], 0 offen offset:0 sc1 lds
    v_exp_f32 v99, v99
    v_exp_f32 v100, v100
    v_exp_f32 v101, v101
    v_mfma_f32_32x32x16_bf16 v[112:127], a[220:223], a[252:255], v[112:127]
    buffer_load_dwordx4 v254, s[8:11], 0 offen offset:1024 sc1 lds
    s_add_u32 s65, s65, 8192
    v_exp_f32 v102, v102
    v_exp_f32 v103, v103
    v_exp_f32 v104, v104
    v_smfmac_f32_16x16x64_bf16 v[196:199], v[240:243], v[16:23], v244
    ds_read_b128 a[192:195], v254 offset:28672
    v_exp_f32 v105, v105
    v_exp_f32 v106, v106
    v_smfmac_f32_32x32x32_bf16 v[80:95], a[228:231], v[24:31], v244
    s_and_b32 s65, s65, 0x1ffff
    s_waitcnt vmcnt(12)
    buffer_atomic_add v253, v252, s[16:19], s75 offen sc1
    v_exp_f32 v107, v107
    v_exp_f32 v108, v108
    v_exp_f32 v109, v109
    v_smfmac_f32_16x16x64_bf16 v[196:199], v[240:243], v[24:31], v244
    s_waitcnt lgkmcnt(1)
    ds_read_b128 a[196:199], v254 offset:29696
    v_exp_f32 v110, v110
    v_exp_f32 v111, v111
    v_mfma_f32_32x32x16_bf16 v[0:15], a[208:211], a[240:243], v[32:47]
    buffer_load_dword v220, v249, s[32:35], s68 offen
    s_add_u32 s68, s68, s69
    v_exp_f32 v112, v112
    v_exp_f32 v113, v113
    v_exp_f32 v114, v114
    v_smfmac_f32_32x32x32_bf16 v[64:79], a[232:235], v[96:103], v244
    buffer_store_dwordx4 v[228:231], v227, s[16:19], 0 offen offset:0 sc1
    v_exp_f32 v115, v115
    v_exp_f32 v116, v116
    v_exp_f32 v117, v117
    v_mfma_f32_32x32x16_bf16 v[0:15], a[212:215], a[244:247], v[0:15]
    v_exp_f32 v118, v118
    v_exp_f32 v119, v119
    v_exp_f32 v120, v120
    v_smfmac_f32_16x16x64_bf16 v[192:195], v[240:243], v[96:103], v244
    ds_read_b128 a[216:219], v254 offset:22528
    v_exp_f32 v121, v121
    v_exp_f32 v122, v122
    v_smfmac_f32_32x32x32_bf16 v[64:79], a[236:239], v[104:111], v244
    v_exp_f32 v123, v123
    v_exp_f32 v124, v124
    v_exp_f32 v125, v125
    v_smfmac_f32_16x16x64_bf16 v[192:195], v[240:243], v[104:111], v244
    s_waitcnt lgkmcnt(1)
    ds_read_b128 a[220:223], v254 offset:23552
    v_exp_f32 v126, v126
    v_exp_f32 v127, v127
    v_mfma_f32_32x32x16_bf16 v[16:31], a[208:211], a[248:251], v[48:63]
    v_exp_f32 v0, v0
    v_exp_f32 v1, v1
    v_exp_f32 v2, v2
    v_smfmac_f32_32x32x32_bf16 v[80:95], a[232:235], v[112:119], v244
    v_exp_f32 v3, v3
    v_exp_f32 v4, v4
    v_exp_f32 v5, v5
    v_mfma_f32_32x32x16_bf16 v[16:31], a[212:215], a[252:255], v[16:31]
    v_exp_f32 v6, v6
    v_exp_f32 v7, v7
    v_exp_f32 v8, v8
    v_smfmac_f32_16x16x64_bf16 v[196:199], v[240:243], v[112:119], v244
    ds_read_b128 a[200:203], v254 offset:30720
    v_exp_f32 v9, v9
    v_exp_f32 v10, v10
    v_smfmac_f32_32x32x32_bf16 v[80:95], a[236:239], v[120:127], v244
    v_exp_f32 v11, v11
    v_exp_f32 v12, v12
    v_exp_f32 v13, v13
    v_smfmac_f32_16x16x64_bf16 v[196:199], v[240:243], v[120:127], v244
    s_waitcnt lgkmcnt(1)
    ds_read_b128 a[204:207], v254 offset:31744
    buffer_store_dwordx4 v[228:231], v227, s[16:19], 0 offen offset:1024 sc1
    v_exp_f32 v14, v14
    v_exp_f32 v15, v15
    v_mfma_f32_32x32x16_bf16 v[96:111], a[216:219], a[240:243], v[32:47]
    v_exp_f32 v16, v16
    v_exp_f32 v17, v17
    v_exp_f32 v18, v18
    v_smfmac_f32_32x32x32_bf16 v[64:79], a[192:195], v[0:7], v244
    v_exp_f32 v19, v19
    v_exp_f32 v20, v20
    v_exp_f32 v21, v21
    v_mfma_f32_32x32x16_bf16 v[96:111], a[220:223], a[244:247], v[96:111]
    v_exp_f32 v22, v22
    v_exp_f32 v23, v23
    v_exp_f32 v24, v24
    v_smfmac_f32_16x16x64_bf16 v[192:195], v[240:243], v[0:7], v244
    ds_read_b128 a[208:211], v254 offset:32768
    v_exp_f32 v25, v25
    v_exp_f32 v26, v26
    v_smfmac_f32_32x32x32_bf16 v[64:79], a[196:199], v[8:15], v244
    v_exp_f32 v27, v27
    v_exp_f32 v28, v28
    v_exp_f32 v29, v29
    v_smfmac_f32_16x16x64_bf16 v[192:195], v[240:243], v[8:15], v244
    s_waitcnt lgkmcnt(1)
    ds_read_b128 a[212:215], v254 offset:33792
    v_exp_f32 v30, v30
    v_exp_f32 v31, v31
    v_mfma_f32_32x32x16_bf16 v[112:127], a[216:219], a[248:251], v[48:63]
    v_exp_f32 v96, v96
    v_exp_f32 v97, v97
    v_exp_f32 v98, v98
    v_smfmac_f32_32x32x32_bf16 v[80:95], a[192:195], v[16:23], v244
    v_exp_f32 v99, v99
    v_exp_f32 v100, v100
    v_exp_f32 v101, v101
    v_mfma_f32_32x32x16_bf16 v[112:127], a[220:223], a[252:255], v[112:127]
    v_exp_f32 v102, v102
    v_exp_f32 v103, v103
    v_exp_f32 v104, v104
    v_smfmac_f32_16x16x64_bf16 v[196:199], v[240:243], v[16:23], v244
    ds_read_b128 a[224:227], v254 offset:40960
    buffer_store_dwordx4 v[228:231], v227, s[16:19], 0 offen offset:2048 sc1
    v_exp_f32 v105, v105
    v_exp_f32 v106, v106
    v_smfmac_f32_32x32x32_bf16 v[80:95], a[196:199], v[24:31], v244
    v_exp_f32 v107, v107
    v_exp_f32 v108, v108
    v_exp_f32 v109, v109
    v_smfmac_f32_16x16x64_bf16 v[196:199], v[240:243], v[24:31], v244
    s_waitcnt lgkmcnt(1)
    ds_read_b128 a[228:231], v254 offset:41984
    v_exp_f32 v110, v110
    v_exp_f32 v111, v111
    v_mfma_f32_32x32x16_bf16 v[0:15], a[208:211], a[240:243], v[32:47]
    v_exp_f32 v112, v112
    v_exp_f32 v113, v113
    v_exp_f32 v114, v114
    v_smfmac_f32_32x32x32_bf16 v[64:79], a[200:203], v[96:103], v244
    v_exp_f32 v115, v115
    v_exp_f32 v116, v116
    v_exp_f32 v117, v117
    v_mfma_f32_32x32x16_bf16 v[0:15], a[212:215], a[244:247], v[0:15]
    v_exp_f32 v118, v118
    v_exp_f32 v119, v119
    v_exp_f32 v120, v120
    v_smfmac_f32_16x16x64_bf16 v[192:195], v[240:243], v[96:103], v244
    ds_read_b128 a[216:219], v254 offset:34816
    v_exp_f32 v121, v121
    v_exp_f32 v122, v122
    v_smfmac_f32_32x32x32_bf16 v[64:79], a[204:207], v[104:111], v244
    v_exp_f32 v123, v123
    v_exp_f32 v124, v124
    v_exp_f32 v125, v125
    v_smfmac_f32_16x16x64_bf16 v[192:195], v[240:243], v[104:111], v244
    s_waitcnt lgkmcnt(1)
    ds_read_b128 a[220:223], v254 offset:35840
    v_exp_f32 v126, v126
    v_exp_f32 v127, v127
    v_mfma_f32_32x32x16_bf16 v[16:31], a[208:211], a[248:251], v[48:63]
    v_exp_f32 v0, v0
    v_exp_f32 v1, v1
    v_exp_f32 v2, v2
    v_smfmac_f32_32x32x32_bf16 v[80:95], a[200:203], v[112:119], v244
    buffer_store_dwordx4 v[228:231], v227, s[16:19], 0 offen offset:3072 sc1
    v_exp_f32 v3, v3
    v_exp_f32 v4, v4
    v_exp_f32 v5, v5
    v_mfma_f32_32x32x16_bf16 v[16:31], a[212:215], a[252:255], v[16:31]
    v_exp_f32 v6, v6
    v_exp_f32 v7, v7
    v_exp_f32 v8, v8
    v_smfmac_f32_16x16x64_bf16 v[196:199], v[240:243], v[112:119], v244
    ds_read_b128 a[232:235], v254 offset:43008
    v_exp_f32 v9, v9
    v_exp_f32 v10, v10
    v_smfmac_f32_32x32x32_bf16 v[80:95], a[204:207], v[120:127], v244
    v_exp_f32 v11, v11
    v_exp_f32 v12, v12
    v_exp_f32 v13, v13
    v_smfmac_f32_16x16x64_bf16 v[196:199], v[240:243], v[120:127], v244
    s_waitcnt lgkmcnt(1)
    ds_read_b128 a[236:239], v254 offset:44032
    v_exp_f32 v14, v14
    v_exp_f32 v15, v15
    v_mfma_f32_32x32x16_bf16 v[96:111], a[216:219], a[240:243], v[32:47]
    v_exp_f32 v16, v16
    v_exp_f32 v17, v17
    v_exp_f32 v18, v18
    v_smfmac_f32_32x32x32_bf16 v[64:79], a[224:227], v[0:7], v244
    v_exp_f32 v19, v19
    v_exp_f32 v20, v20
    v_exp_f32 v21, v21
    v_mfma_f32_32x32x16_bf16 v[96:111], a[220:223], a[244:247], v[96:111]
    v_exp_f32 v22, v22
    v_exp_f32 v23, v23
    v_exp_f32 v24, v24
    v_smfmac_f32_16x16x64_bf16 v[192:195], v[240:243], v[0:7], v244
    ds_read_b128 a[208:211], v254 offset:36864
    v_exp_f32 v25, v25
    v_exp_f32 v26, v26
    v_smfmac_f32_32x32x32_bf16 v[64:79], a[228:231], v[8:15], v244
    v_exp_f32 v27, v27
    v_exp_f32 v28, v28
    v_exp_f32 v29, v29
    v_smfmac_f32_16x16x64_bf16 v[192:195], v[240:243], v[8:15], v244
    s_waitcnt lgkmcnt(1)
    ds_read_b128 a[212:215], v254 offset:37888
    v_add_u32 v227, 4096, v227
    v_exp_f32 v30, v30
    v_exp_f32 v31, v31
    v_mfma_f32_32x32x16_bf16 v[112:127], a[216:219], a[248:251], v[48:63]
    buffer_store_dwordx4 v[228:231], v227, s[16:19], 0 offen offset:0 sc1
    v_exp_f32 v96, v96
    v_exp_f32 v97, v97
    v_exp_f32 v98, v98
    v_smfmac_f32_32x32x32_bf16 v[80:95], a[224:227], v[16:23], v244
    v_exp_f32 v99, v99
    v_exp_f32 v100, v100
    v_exp_f32 v101, v101
    v_mfma_f32_32x32x16_bf16 v[112:127], a[220:223], a[252:255], v[112:127]
    v_exp_f32 v102, v102
    v_exp_f32 v103, v103
    v_exp_f32 v104, v104
    v_smfmac_f32_16x16x64_bf16 v[196:199], v[240:243], v[16:23], v244
    ds_read_b128 a[192:195], v254 offset:45056
    v_exp_f32 v105, v105
    v_exp_f32 v106, v106
    v_smfmac_f32_32x32x32_bf16 v[80:95], a[228:231], v[24:31], v244
    v_exp_f32 v107, v107
    v_exp_f32 v108, v108
    v_exp_f32 v109, v109
    v_smfmac_f32_16x16x64_bf16 v[196:199], v[240:243], v[24:31], v244
    s_waitcnt lgkmcnt(1)
    ds_read_b128 a[196:199], v254 offset:46080
    v_exp_f32 v110, v110
    v_exp_f32 v111, v111
    v_mfma_f32_32x32x16_bf16 v[0:15], a[208:211], a[240:243], v[32:47]
    v_exp_f32 v112, v112
    v_exp_f32 v113, v113
    v_exp_f32 v114, v114
    v_smfmac_f32_32x32x32_bf16 v[64:79], a[232:235], v[96:103], v244
    v_exp_f32 v115, v115
    v_exp_f32 v116, v116
    v_exp_f32 v117, v117
    v_mfma_f32_32x32x16_bf16 v[0:15], a[212:215], a[244:247], v[0:15]
    v_exp_f32 v118, v118
    v_exp_f32 v119, v119
    v_exp_f32 v120, v120
    v_smfmac_f32_16x16x64_bf16 v[192:195], v[240:243], v[96:103], v244
    ds_read_b128 a[216:219], v254 offset:38912
    v_exp_f32 v121, v121
    v_exp_f32 v122, v122
    v_smfmac_f32_32x32x32_bf16 v[64:79], a[236:239], v[104:111], v244
    buffer_store_dwordx4 v[228:231], v227, s[16:19], 0 offen offset:1024 sc1
    v_exp_f32 v123, v123
    v_exp_f32 v124, v124
    v_exp_f32 v125, v125
    v_smfmac_f32_16x16x64_bf16 v[192:195], v[240:243], v[104:111], v244
    s_waitcnt lgkmcnt(1)
    ds_read_b128 a[220:223], v254 offset:39936
    v_exp_f32 v126, v126
    v_exp_f32 v127, v127
    v_mfma_f32_32x32x16_bf16 v[16:31], a[208:211], a[248:251], v[48:63]
    v_exp_f32 v0, v0
    v_exp_f32 v1, v1
    v_exp_f32 v2, v2
    v_smfmac_f32_32x32x32_bf16 v[80:95], a[232:235], v[112:119], v244
    v_exp_f32 v3, v3
    v_exp_f32 v4, v4
    v_exp_f32 v5, v5
    v_mfma_f32_32x32x16_bf16 v[16:31], a[212:215], a[252:255], v[16:31]
    v_exp_f32 v6, v6
    v_exp_f32 v7, v7
    v_exp_f32 v8, v8
    v_smfmac_f32_16x16x64_bf16 v[196:199], v[240:243], v[112:119], v244
    ds_read_b128 a[200:203], v254 offset:47104
    v_exp_f32 v9, v9
    v_exp_f32 v10, v10
    v_smfmac_f32_32x32x32_bf16 v[80:95], a[236:239], v[120:127], v244
    v_exp_f32 v11, v11
    v_exp_f32 v12, v12
    v_exp_f32 v13, v13
    v_smfmac_f32_16x16x64_bf16 v[196:199], v[240:243], v[120:127], v244
    s_waitcnt lgkmcnt(1)
    ds_read_b128 a[204:207], v254 offset:48128
    v_exp_f32 v14, v14
    v_exp_f32 v15, v15
    v_mfma_f32_32x32x16_bf16 v[96:111], a[216:219], a[240:243], v[32:47]
    buffer_load_dword v220, v249, s[32:35], s68 offen
    s_add_u32 s68, s68, s69
    v_exp_f32 v16, v16
    v_exp_f32 v17, v17
    v_exp_f32 v18, v18
    v_smfmac_f32_32x32x32_bf16 v[64:79], a[192:195], v[0:7], v244
    v_exp_f32 v19, v19
    v_exp_f32 v20, v20
    v_exp_f32 v21, v21
    v_mfma_f32_32x32x16_bf16 v[96:111], a[220:223], a[244:247], v[96:111]
    buffer_store_dwordx4 v[228:231], v227, s[16:19], 0 offen offset:2048 sc1
    v_exp_f32 v22, v22
    v_exp_f32 v23, v23
    v_exp_f32 v24, v24
    v_smfmac_f32_16x16x64_bf16 v[192:195], v[240:243], v[0:7], v244
    ds_read_b128 a[208:211], v254 offset:49152
    v_exp_f32 v25, v25
    v_exp_f32 v26, v26
    v_smfmac_f32_32x32x32_bf16 v[64:79], a[196:199], v[8:15], v244
    v_exp_f32 v27, v27
    v_exp_f32 v28, v28
    v_exp_f32 v29, v29
    v_smfmac_f32_16x16x64_bf16 v[192:195], v[240:243], v[8:15], v244
    s_waitcnt lgkmcnt(1)
    ds_read_b128 a[212:215], v254 offset:50176
    v_exp_f32 v30, v30
    v_exp_f32 v31, v31
    v_mfma_f32_32x32x16_bf16 v[112:127], a[216:219], a[248:251], v[48:63]
    v_exp_f32 v96, v96
    v_exp_f32 v97, v97
    v_exp_f32 v98, v98
    v_smfmac_f32_32x32x32_bf16 v[80:95], a[192:195], v[16:23], v244
    v_exp_f32 v99, v99
    v_exp_f32 v100, v100
    v_exp_f32 v101, v101
    v_mfma_f32_32x32x16_bf16 v[112:127], a[220:223], a[252:255], v[112:127]
    v_exp_f32 v102, v102
    v_exp_f32 v103, v103
    v_exp_f32 v104, v104
    v_smfmac_f32_16x16x64_bf16 v[196:199], v[240:243], v[16:23], v244
    ds_read_b128 a[224:227], v254 offset:57344
    v_exp_f32 v105, v105
    v_exp_f32 v106, v106
    v_smfmac_f32_32x32x32_bf16 v[80:95], a[196:199], v[24:31], v244
    v_exp_f32 v107, v107
    v_exp_f32 v108, v108
    v_exp_f32 v109, v109
    v_smfmac_f32_16x16x64_bf16 v[196:199], v[240:243], v[24:31], v244
    s_waitcnt lgkmcnt(1)
    ds_read_b128 a[228:231], v254 offset:58368
    v_exp_f32 v110, v110
    v_exp_f32 v111, v111
    v_mfma_f32_32x32x16_bf16 v[0:15], a[208:211], a[240:243], v[32:47]
    buffer_store_dwordx4 v[228:231], v227, s[16:19], 0 offen offset:3072 sc1
    v_exp_f32 v112, v112
    v_exp_f32 v113, v113
    v_exp_f32 v114, v114
    v_smfmac_f32_32x32x32_bf16 v[64:79], a[200:203], v[96:103], v244
    v_exp_f32 v115, v115
    v_exp_f32 v116, v116
    v_exp_f32 v117, v117
    v_mfma_f32_32x32x16_bf16 v[0:15], a[212:215], a[244:247], v[0:15]
    v_exp_f32 v118, v118
    v_exp_f32 v119, v119
    v_exp_f32 v120, v120
    v_smfmac_f32_16x16x64_bf16 v[192:195], v[240:243], v[96:103], v244
    ds_read_b128 a[216:219], v254 offset:51200
    v_exp_f32 v121, v121
    v_exp_f32 v122, v122
    v_smfmac_f32_32x32x32_bf16 v[64:79], a[204:207], v[104:111], v244
    v_exp_f32 v123, v123
    v_exp_f32 v124, v124
    v_exp_f32 v125, v125
    v_smfmac_f32_16x16x64_bf16 v[192:195], v[240:243], v[104:111], v244
    s_waitcnt lgkmcnt(1)
    ds_read_b128 a[220:223], v254 offset:52224
    v_exp_f32 v126, v126
    v_exp_f32 v127, v127
    v_mfma_f32_32x32x16_bf16 v[16:31], a[208:211], a[248:251], v[48:63]
    s_getpc_b64 s[46:47]
ct2:
    v_exp_f32 v0, v0
    v_exp_f32 v1, v1
    v_exp_f32 v2, v2
    v_smfmac_f32_32x32x32_bf16 v[80:95], a[200:203], v[112:119], v244
    s_add_u32 s46, s46, p3_code - ct2
    s_addc_u32 s47, s47, 0
    v_exp_f32 v3, v3
    v_exp_f32 v4, v4
    v_exp_f32 v5, v5
    v_mfma_f32_32x32x16_bf16 v[16:31], a[212:215], a[252:255], v[16:31]
    s_lshr_b32 s62, s2, 3
    v_exp_f32 v6, v6
    v_exp_f32 v7, v7
    v_exp_f32 v8, v8
    v_smfmac_f32_16x16x64_bf16 v[196:199], v[240:243], v[112:119], v244
    ds_read_b128 a[232:235], v254 offset:59392
    v_exp_f32 v9, v9
    v_exp_f32 v10, v10
    v_smfmac_f32_32x32x32_bf16 v[80:95], a[204:207], v[120:127], v244
    s_lshl_b32 s62, s62, 2
    s_add_u32 s62, s62, s3
    v_exp_f32 v11, v11
    v_exp_f32 v12, v12
    v_exp_f32 v13, v13
    v_smfmac_f32_16x16x64_bf16 v[196:199], v[240:243], v[120:127], v244
    s_waitcnt lgkmcnt(1)
    ds_read_b128 a[236:239], v254 offset:60416
    v_add_u32 v227, 4096, v227
    v_exp_f32 v14, v14
    v_exp_f32 v15, v15
    v_mfma_f32_32x32x16_bf16 v[96:111], a[216:219], a[240:243], v[32:47]
    s_mul_i32 s62, s62, 2
    v_min_u32 v249, 1, v255
    buffer_store_dwordx4 v[228:231], v227, s[16:19], 0 offen offset:0 sc1
    v_exp_f32 v16, v16
    v_exp_f32 v17, v17
    v_exp_f32 v18, v18
    v_smfmac_f32_32x32x32_bf16 v[64:79], a[224:227], v[0:7], v244
    v_add_lshl_u32 v249, s62, v249, 7
    v_exp_f32 v19, v19
    v_exp_f32 v20, v20
    v_exp_f32 v21, v21
    v_mfma_f32_32x32x16_bf16 v[96:111], a[220:223], a[244:247], v[96:111]
    v_min_u32 v249, k_end - p3_code - 64, v249
    v_exp_f32 v22, v22
    v_exp_f32 v23, v23
    v_exp_f32 v24, v24
    v_smfmac_f32_16x16x64_bf16 v[192:195], v[240:243], v[0:7], v244
    ds_read_b128 a[208:211], v254 offset:53248
    global_load_dword v220, v249, s[46:47]
    v_exp_f32 v25, v25
    v_exp_f32 v26, v26
    v_smfmac_f32_32x32x32_bf16 v[64:79], a[228:231], v[8:15], v244
    v_exp_f32 v27, v27
    v_exp_f32 v28, v28
    v_exp_f32 v29, v29
    v_smfmac_f32_16x16x64_bf16 v[192:195], v[240:243], v[8:15], v244
    s_waitcnt lgkmcnt(1)
    ds_read_b128 a[212:215], v254 offset:54272
    v_exp_f32 v30, v30
    v_exp_f32 v31, v31
    v_mfma_f32_32x32x16_bf16 v[112:127], a[216:219], a[248:251], v[48:63]
    v_exp_f32 v96, v96
    v_exp_f32 v97, v97
    v_exp_f32 v98, v98
    v_smfmac_f32_32x32x32_bf16 v[80:95], a[224:227], v[16:23], v244
    v_exp_f32 v99, v99
    v_exp_f32 v100, v100
    v_exp_f32 v101, v101
    v_mfma_f32_32x32x16_bf16 v[112:127], a[220:223], a[252:255], v[112:127]
    v_exp_f32 v102, v102
    v_exp_f32 v103, v103
    v_exp_f32 v104, v104
    v_smfmac_f32_16x16x64_bf16 v[196:199], v[240:243], v[16:23], v244
    ds_read_b128 a[192:195], v254 offset:61440
    v_exp_f32 v105, v105
    v_exp_f32 v106, v106
    v_smfmac_f32_32x32x32_bf16 v[80:95], a[228:231], v[24:31], v244
    buffer_store_dwordx4 v[228:231], v227, s[16:19], 0 offen offset:1024 sc1
    v_exp_f32 v107, v107
    v_exp_f32 v108, v108
    v_exp_f32 v109, v109
    v_smfmac_f32_16x16x64_bf16 v[196:199], v[240:243], v[24:31], v244
    s_waitcnt lgkmcnt(1)
    ds_read_b128 a[196:199], v254 offset:62464
    v_exp_f32 v110, v110
    v_exp_f32 v111, v111
    v_mfma_f32_32x32x16_bf16 v[0:15], a[208:211], a[240:243], v[32:47]
    v_exp_f32 v112, v112
    v_exp_f32 v113, v113
    v_exp_f32 v114, v114
    v_smfmac_f32_32x32x32_bf16 v[64:79], a[232:235], v[96:103], v244
    v_exp_f32 v115, v115
    v_exp_f32 v116, v116
    v_exp_f32 v117, v117
    v_mfma_f32_32x32x16_bf16 v[0:15], a[212:215], a[244:247], v[0:15]
    v_exp_f32 v118, v118
    v_exp_f32 v119, v119
    v_exp_f32 v120, v120
    v_smfmac_f32_16x16x64_bf16 v[192:195], v[240:243], v[96:103], v244
    ds_read_b128 a[216:219], v254 offset:55296
    v_exp_f32 v121, v121
    v_exp_f32 v122, v122
    v_smfmac_f32_32x32x32_bf16 v[64:79], a[236:239], v[104:111], v244
    buffer_load_dword v251, v252, s[16:19], s75 offen sc1
    v_exp_f32 v123, v123
    v_exp_f32 v124, v124
    v_exp_f32 v125, v125
    v_smfmac_f32_16x16x64_bf16 v[192:195], v[240:243], v[104:111], v244
    s_waitcnt lgkmcnt(1)
    ds_read_b128 a[220:223], v254 offset:56320
    v_exp_f32 v126, v126
    v_exp_f32 v127, v127
    v_mfma_f32_32x32x16_bf16 v[16:31], a[208:211], a[248:251], v[48:63]
    s_waitcnt vmcnt(15)
    v_exp_f32 v0, v0
    v_exp_f32 v1, v1
    v_exp_f32 v2, v2
    v_smfmac_f32_32x32x32_bf16 v[80:95], a[232:235], v[112:119], v244
    s_barrier
    v_exp_f32 v3, v3
    v_exp_f32 v4, v4
    v_exp_f32 v5, v5
    v_mfma_f32_32x32x16_bf16 v[16:31], a[212:215], a[252:255], v[16:31]
    buffer_store_dwordx4 v[228:231], v227, s[16:19], 0 offen offset:2048 sc1
    v_exp_f32 v6, v6
    v_exp_f32 v7, v7
    v_exp_f32 v8, v8
    v_smfmac_f32_16x16x64_bf16 v[196:199], v[240:243], v[112:119], v244
    ds_read_b128 a[200:203], v254 offset:63488
    v_exp_f32 v9, v9
    v_exp_f32 v10, v10
    v_smfmac_f32_32x32x32_bf16 v[80:95], a[236:239], v[120:127], v244
    v_exp_f32 v11, v11
    v_exp_f32 v12, v12
    v_exp_f32 v13, v13
    v_smfmac_f32_16x16x64_bf16 v[196:199], v[240:243], v[120:127], v244
    s_waitcnt lgkmcnt(1)
    ds_read_b128 a[204:207], v254 offset:64512
    v_exp_f32 v14, v14
    v_exp_f32 v15, v15
    v_mfma_f32_32x32x16_bf16 v[96:111], a[216:219], a[240:243], v[32:47]
    v_exp_f32 v16, v16
    v_exp_f32 v17, v17
    v_exp_f32 v18, v18
    v_smfmac_f32_32x32x32_bf16 v[64:79], a[192:195], v[0:7], v244
    s_add_u32 s4, s42, s65
    s_addc_u32 s5, s43, 0
    v_exp_f32 v19, v19
    v_exp_f32 v20, v20
    v_exp_f32 v21, v21
    v_mfma_f32_32x32x16_bf16 v[96:111], a[220:223], a[244:247], v[96:111]
    s_add_u32 m0, s64, 114688
    v_exp_f32 v22, v22
    v_exp_f32 v23, v23
    v_exp_f32 v24, v24
    v_smfmac_f32_16x16x64_bf16 v[192:195], v[240:243], v[0:7], v244
    ds_read_b128 a[208:211], v137 offset:0
    buffer_load_dwordx4 v246, s[4:7], 0 offen offset:0 sc1 lds
    v_exp_f32 v25, v25
    v_exp_f32 v26, v26
    v_smfmac_f32_32x32x32_bf16 v[64:79], a[196:199], v[8:15], v244
    buffer_load_dwordx4 v245, s[4:7], 0 offen offset:1024 sc1 lds
    s_add_u32 s8, s48, s65
    s_addc_u32 s9, s49, 0
    v_exp_f32 v27, v27
    v_exp_f32 v28, v28
    v_exp_f32 v29, v29
    v_smfmac_f32_16x16x64_bf16 v[192:195], v[240:243], v[8:15], v244
    s_waitcnt lgkmcnt(1)
    ds_read_b128 a[212:215], v137 offset:1024
    v_exp_f32 v30, v30
    v_exp_f32 v31, v31
    v_mfma_f32_32x32x16_bf16 v[112:127], a[216:219], a[248:251], v[48:63]
    s_add_u32 m0, s64, 122880
    v_exp_f32 v96, v96
    v_exp_f32 v97, v97
    v_exp_f32 v98, v98
    v_smfmac_f32_32x32x32_bf16 v[80:95], a[192:195], v[16:23], v244
    buffer_load_dwordx4 v254, s[8:11], 0 offen offset:0 sc1 lds
    v_exp_f32 v99, v99
    v_exp_f32 v100, v100
    v_exp_f32 v101, v101
    v_mfma_f32_32x32x16_bf16 v[112:127], a[220:223], a[252:255], v[112:127]
    buffer_load_dwordx4 v254, s[8:11], 0 offen offset:1024 sc1 lds
    s_add_u32 s65, s65, 8192
    v_exp_f32 v102, v102
    v_exp_f32 v103, v103
    v_exp_f32 v104, v104
    v_smfmac_f32_16x16x64_bf16 v[196:199], v[240:243], v[16:23], v244
    ds_read_b128 a[224:227], v137 offset:8192
    v_exp_f32 v105, v105
    v_exp_f32 v106, v106
    v_smfmac_f32_32x32x32_bf16 v[80:95], a[196:199], v[24:31], v244
    s_and_b32 s65, s65, 0x1ffff
    v_exp_f32 v107, v107
    v_exp_f32 v108, v108
    v_exp_f32 v109, v109
    v_smfmac_f32_16x16x64_bf16 v[196:199], v[240:243], v[24:31], v244
    s_waitcnt lgkmcnt(1)
    ds_read_b128 a[228:231], v137 offset:9216
    v_exp_f32 v110, v110
    v_exp_f32 v111, v111
    v_mfma_f32_32x32x16_bf16 v[0:15], a[208:211], a[240:243], v[32:47]
    buffer_store_dwordx4 v[228:231], v227, s[16:19], 0 offen offset:3072 sc1
    v_exp_f32 v112, v112
    v_exp_f32 v113, v113
    v_exp_f32 v114, v114
    v_smfmac_f32_32x32x32_bf16 v[64:79], a[200:203], v[96:103], v244
    v_exp_f32 v115, v115
    v_exp_f32 v116, v116
    v_exp_f32 v117, v117
    v_mfma_f32_32x32x16_bf16 v[0:15], a[212:215], a[244:247], v[0:15]
    v_exp_f32 v118, v118
    v_exp_f32 v119, v119
    v_exp_f32 v120, v120
    v_smfmac_f32_16x16x64_bf16 v[192:195], v[240:243], v[96:103], v244
    ds_read_b128 a[216:219], v137 offset:2048
    v_exp_f32 v121, v121
    v_exp_f32 v122, v122
    v_smfmac_f32_32x32x32_bf16 v[64:79], a[204:207], v[104:111], v244
    v_exp_f32 v123, v123
    v_exp_f32 v124, v124
    v_exp_f32 v125, v125
    v_smfmac_f32_16x16x64_bf16 v[192:195], v[240:243], v[104:111], v244
    s_waitcnt lgkmcnt(1)
    ds_read_b128 a[220:223], v137 offset:3072
    v_exp_f32 v126, v126
    v_exp_f32 v127, v127
    v_mfma_f32_32x32x16_bf16 v[16:31], a[208:211], a[248:251], v[48:63]
    v_exp_f32 v0, v0
    v_exp_f32 v1, v1
    v_exp_f32 v2, v2
    v_smfmac_f32_32x32x32_bf16 v[80:95], a[200:203], v[112:119], v244
    v_exp_f32 v3, v3
    v_exp_f32 v4, v4
    v_exp_f32 v5, v5
    v_mfma_f32_32x32x16_bf16 v[16:31], a[212:215], a[252:255], v[16:31]
    v_exp_f32 v6, v6
    v_exp_f32 v7, v7
    v_exp_f32 v8, v8
    v_smfmac_f32_16x16x64_bf16 v[196:199], v[240:243], v[112:119], v244
    ds_read_b128 a[232:235], v137 offset:10240
    v_exp_f32 v9, v9
    v_exp_f32 v10, v10
    v_smfmac_f32_32x32x32_bf16 v[80:95], a[204:207], v[120:127], v244
    v_exp_f32 v11, v11
    v_exp_f32 v12, v12
    v_exp_f32 v13, v13
    v_smfmac_f32_16x16x64_bf16 v[196:199], v[240:243], v[120:127], v244
    s_waitcnt lgkmcnt(1)
    ds_read_b128 a[236:239], v137 offset:11264
    v_exp_f32 v14, v14
    v_exp_f32 v15, v15
    v_mfma_f32_32x32x16_bf16 v[96:111], a[216:219], a[240:243], v[32:47]
    s_waitcnt vmcnt(6)
    s_lshl_b32 s39, s36, 2
    v_exp_f32 v16, v16
    v_exp_f32 v17, v17
    v_exp_f32 v18, v18
    v_smfmac_f32_32x32x32_bf16 v[64:79], a[224:227], v[0:7], v244
    v_readfirstlane_b32 s62, v251
    s_nop 0
    s_cmp_ge_u32 s62, 128
    s_cbranch_scc0 hready_spin
hready_ok:
    v_exp_f32 v19, v19
    v_exp_f32 v20, v20
    v_exp_f32 v21, v21
    v_mfma_f32_32x32x16_bf16 v[96:111], a[220:223], a[244:247], v[96:111]
    s_add_u32 s39, s39, s3
    v_exp_f32 v22, v22
    v_exp_f32 v23, v23
    v_exp_f32 v24, v24
    v_smfmac_f32_16x16x64_bf16 v[192:195], v[240:243], v[0:7], v244
    ds_read_b128 a[208:211], v137 offset:4096
    v_exp_f32 v25, v25
    v_exp_f32 v26, v26
    v_smfmac_f32_32x32x32_bf16 v[64:79], a[228:231], v[8:15], v244
    s_lshl_b32 s39, s39, 8
    s_add_u32 s39, s39, 0x1e00000
    v_exp_f32 v27, v27
    v_exp_f32 v28, v28
    v_exp_f32 v29, v29
    v_smfmac_f32_16x16x64_bf16 v[192:195], v[240:243], v[8:15], v244
    s_waitcnt lgkmcnt(1)
    ds_read_b128 a[212:215], v137 offset:5120
    v_bfe_u32 v207, v255, 2, 1
    v_exp_f32 v30, v30
    v_exp_f32 v31, v31
    v_mfma_f32_32x32x16_bf16 v[112:127], a[216:219], a[248:251], v[48:63]
    v_bfe_u32 v210, v255, 3, 2
    v_exp_f32 v96, v96
    v_exp_f32 v97, v97
    v_exp_f32 v98, v98
    v_smfmac_f32_32x32x32_bf16 v[80:95], a[224:227], v[16:23], v244
    v_lshlrev_b32 v210, 2, v210
    v_exp_f32 v99, v99
    v_exp_f32 v100, v100
    v_exp_f32 v101, v101
    v_mfma_f32_32x32x16_bf16 v[112:127], a[220:223], a[252:255], v[112:127]
    v_lshl_add_u32 v207, v207, 4, v210
    v_exp_f32 v102, v102
    v_exp_f32 v103, v103
    v_exp_f32 v104, v104
    v_smfmac_f32_16x16x64_bf16 v[196:199], v[240:243], v[16:23], v244
    ds_read_b128 a[192:195], v137 offset:12288
    v_and_b32 v210, 3, v255
    v_exp_f32 v105, v105
    v_exp_f32 v106, v106
    v_smfmac_f32_32x32x32_bf16 v[80:95], a[228:231], v[24:31], v244
    v_add_lshl_u32 v207, v207, v210, 2
    v_exp_f32 v107, v107
    v_exp_f32 v108, v108
    v_exp_f32 v109, v109
    v_smfmac_f32_16x16x64_bf16 v[196:199], v[240:243], v[24:31], v244
    s_waitcnt lgkmcnt(1)
    ds_read_b128 a[196:199], v137 offset:13312
    v_exp_f32 v110, v110
    v_exp_f32 v111, v111
    v_mfma_f32_32x32x16_bf16 v[0:15], a[208:211], a[240:243], v[32:47]
    s_lshl_b32 s77, s36, 2
    buffer_load_dword v200, v226, s[16:19], s39 offen offset:0 sc1
    v_exp_f32 v112, v112
    v_exp_f32 v113, v113
    v_exp_f32 v114, v114
    v_smfmac_f32_32x32x32_bf16 v[64:79], a[232:235], v[96:103], v244
    s_add_u32 s77, s77, s3
    s_lshl_b32 s77, s77, 8
    buffer_load_dword v201, v226, s[16:19], s39 offen offset:64 sc1
    v_exp_f32 v115, v115
    v_exp_f32 v116, v116
    v_exp_f32 v117, v117
    v_mfma_f32_32x32x16_bf16 v[0:15], a[212:215], a[244:247], v[0:15]
    s_add_u32 s77, s77, 0x1e00000
    v_exp_f32 v118, v118
    v_exp_f32 v119, v119
    v_exp_f32 v120, v120
    v_smfmac_f32_16x16x64_bf16 v[192:195], v[240:243], v[96:103], v244
    ds_read_b128 a[216:219], v137 offset:6144
    v_exp_f32 v121, v121
    v_exp_f32 v122, v122
    v_smfmac_f32_32x32x32_bf16 v[64:79], a[236:239], v[104:111], v244
    v_exp_f32 v123, v123
    v_exp_f32 v124, v124
    v_exp_f32 v125, v125
    v_smfmac_f32_16x16x64_bf16 v[192:195], v[240:243], v[104:111], v244
    s_waitcnt lgkmcnt(1)
    ds_read_b128 a[220:223], v137 offset:7168
    v_exp_f32 v126, v126
    v_exp_f32 v127, v127
    v_mfma_f32_32x32x16_bf16 v[16:31], a[208:211], a[248:251], v[48:63]
    buffer_load_dword v202, v226, s[16:19], s39 offen offset:128 sc1
    v_exp_f32 v0, v0
    v_exp_f32 v1, v1
    v_exp_f32 v2, v2
    v_smfmac_f32_32x32x32_bf16 v[80:95], a[232:235], v[112:119], v244
    buffer_load_dword v203, v226, s[16:19], s39 offen offset:192 sc1
    v_exp_f32 v3, v3
    v_exp_f32 v4, v4
    v_exp_f32 v5, v5
    v_mfma_f32_32x32x16_bf16 v[16:31], a[212:215], a[252:255], v[16:31]
    v_exp_f32 v6, v6
    v_exp_f32 v7, v7
    v_exp_f32 v8, v8
    v_smfmac_f32_16x16x64_bf16 v[196:199], v[240:243], v[112:119], v244
    ds_read_b128 a[200:203], v137 offset:14336
    v_exp_f32 v9, v9
    v_exp_f32 v10, v10
    v_smfmac_f32_32x32x32_bf16 v[80:95], a[236:239], v[120:127], v244
    v_exp_f32 v11, v11
    v_exp_f32 v12, v12
    v_exp_f32 v13, v13
    v_smfmac_f32_16x16x64_bf16 v[196:199], v[240:243], v[120:127], v244
    s_waitcnt lgkmcnt(1)
    ds_read_b128 a[204:207], v137 offset:15360
    v_exp_f32 v14, v14
    v_exp_f32 v15, v15
    v_mfma_f32_32x32x16_bf16 v[96:111], a[216:219], a[240:243], v[32:47]
    buffer_load_dword v208, v207, s[16:19], s77 offen offset:0 sc1
    v_exp_f32 v16, v16
    v_exp_f32 v17, v17
    v_exp_f32 v18, v18
    v_smfmac_f32_32x32x32_bf16 v[64:79], a[192:195], v[0:7], v244
    buffer_load_dword v209, v207, s[16:19], s77 offen offset:128 sc1
    s_add_u32 m0, s54, 0
    v_exp_f32 v19, v19
    v_exp_f32 v20, v20
    v_exp_f32 v21, v21
    v_mfma_f32_32x32x16_bf16 v[96:111], a[220:223], a[244:247], v[96:111]
    v_exp_f32 v22, v22
    v_exp_f32 v23, v23
    v_exp_f32 v24, v24
    v_smfmac_f32_16x16x64_bf16 v[192:195], v[240:243], v[0:7], v244
    ds_read_b128 a[208:211], v137 offset:16384
    v_exp_f32 v25, v25
    v_exp_f32 v26, v26
    v_smfmac_f32_32x32x32_bf16 v[64:79], a[196:199], v[8:15], v244
    v_exp_f32 v27, v27
    v_exp_f32 v28, v28
    v_exp_f32 v29, v29
    v_smfmac_f32_16x16x64_bf16 v[192:195], v[240:243], v[8:15], v244
    s_waitcnt lgkmcnt(1)
    ds_read_b128 a[212:215], v137 offset:17408
    v_exp_f32 v30, v30
    v_exp_f32 v31, v31
    v_mfma_f32_32x32x16_bf16 v[112:127], a[216:219], a[248:251], v[48:63]
    buffer_load_dwordx4 v232, s[20:23], 0 offen offset:0 lds
    v_exp_f32 v96, v96
    v_exp_f32 v97, v97
    v_exp_f32 v98, v98
    v_smfmac_f32_32x32x32_bf16 v[80:95], a[192:195], v[16:23], v244
    buffer_load_dwordx4 a[0:3], v234, s[12:15], 0 offen offset:0 sc1
    v_exp_f32 v99, v99
    v_exp_f32 v100, v100
    v_exp_f32 v101, v101
    v_mfma_f32_32x32x16_bf16 v[112:127], a[220:223], a[252:255], v[112:127]
    v_exp_f32 v102, v102
    v_exp_f32 v103, v103
    v_exp_f32 v104, v104
    v_smfmac_f32_16x16x64_bf16 v[196:199], v[240:243], v[16:23], v244
    ds_read_b128 a[224:227], v137 offset:24576
    v_exp_f32 v105, v105
    v_exp_f32 v106, v106
    v_smfmac_f32_32x32x32_bf16 v[80:95], a[196:199], v[24:31], v244
    v_exp_f32 v107, v107
    v_exp_f32 v108, v108
    v_exp_f32 v109, v109
    v_smfmac_f32_16x16x64_bf16 v[196:199], v[240:243], v[24:31], v244
    s_waitcnt lgkmcnt(1)
    ds_read_b128 a[228:231], v137 offset:25600
    v_exp_f32 v110, v110
    v_exp_f32 v111, v111
    v_mfma_f32_32x32x16_bf16 v[0:15], a[208:211], a[240:243], v[32:47]
    buffer_load_dwordx4 a[4:7], v235, s[12:15], 0 offen offset:0 sc1
    v_exp_f32 v112, v112
    v_exp_f32 v113, v113
    v_exp_f32 v114, v114
    v_smfmac_f32_32x32x32_bf16 v[64:79], a[200:203], v[96:103], v244
    buffer_load_dwordx4 v233, s[20:23], 0 offen offset:1024 lds
    s_add_u32 s20, s20, 65536
    s_addc_u32 s21, s21, 0
    v_exp_f32 v115, v115
    v_exp_f32 v116, v116
    v_exp_f32 v117, v117
    v_mfma_f32_32x32x16_bf16 v[0:15], a[212:215], a[244:247], v[0:15]
    v_exp_f32 v118, v118
    v_exp_f32 v119, v119
    v_exp_f32 v120, v120
    v_smfmac_f32_16x16x64_bf16 v[192:195], v[240:243], v[96:103], v244
    ds_read_b128 a[216:219], v137 offset:18432
    v_exp_f32 v121, v121
    v_exp_f32 v122, v122
    v_smfmac_f32_32x32x32_bf16 v[64:79], a[204:207], v[104:111], v244
    v_exp_f32 v123, v123
    v_exp_f32 v124, v124
    v_exp_f32 v125, v125
    v_smfmac_f32_16x16x64_bf16 v[192:195], v[240:243], v[104:111], v244
    s_waitcnt lgkmcnt(1)
    ds_read_b128 a[220:223], v137 offset:19456
    v_exp_f32 v126, v126
    v_exp_f32 v127, v127
    v_mfma_f32_32x32x16_bf16 v[16:31], a[208:211], a[248:251], v[48:63]
    buffer_load_dwordx4 a[8:11], v236, s[12:15], 0 offen offset:0 sc1
    v_exp_f32 v0, v0
    v_exp_f32 v1, v1
    v_exp_f32 v2, v2
    v_smfmac_f32_32x32x32_bf16 v[80:95], a[200:203], v[112:119], v244
    buffer_load_dwordx4 a[12:15], v237, s[12:15], 0 offen offset:0 sc1
    s_add_u32 m0, s54, 8192
    v_exp_f32 v3, v3
    v_exp_f32 v4, v4
    v_exp_f32 v5, v5
    v_mfma_f32_32x32x16_bf16 v[16:31], a[212:215], a[252:255], v[16:31]
    v_exp_f32 v6, v6
    v_exp_f32 v7, v7
    v_exp_f32 v8, v8
    v_smfmac_f32_16x16x64_bf16 v[196:199], v[240:243], v[112:119], v244
    ds_read_b128 a[232:235], v137 offset:26624
    v_exp_f32 v9, v9
    v_exp_f32 v10, v10
    v_smfmac_f32_32x32x32_bf16 v[80:95], a[204:207], v[120:127], v244
    v_exp_f32 v11, v11
    v_exp_f32 v12, v12
    v_exp_f32 v13, v13
    v_smfmac_f32_16x16x64_bf16 v[196:199], v[240:243], v[120:127], v244
    s_waitcnt lgkmcnt(1)
    ds_read_b128 a[236:239], v137 offset:27648
    v_exp_f32 v14, v14
    v_exp_f32 v15, v15
    v_mfma_f32_32x32x16_bf16 v[96:111], a[216:219], a[240:243], v[32:47]
    buffer_load_dwordx4 v232, s[20:23], 0 offen offset:0 lds
    v_exp_f32 v16, v16
    v_exp_f32 v17, v17
    v_exp_f32 v18, v18
    v_smfmac_f32_32x32x32_bf16 v[64:79], a[224:227], v[0:7], v244
    buffer_load_dwordx4 a[16:19], v234, s[12:15], 0 offen offset:1024 sc1
    v_exp_f32 v19, v19
    v_exp_f32 v20, v20
    v_exp_f32 v21, v21
    v_mfma_f32_32x32x16_bf16 v[96:111], a[220:223], a[244:247], v[96:111]
    v_exp_f32 v22, v22
    v_exp_f32 v23, v23
    v_exp_f32 v24, v24
    v_smfmac_f32_16x16x64_bf16 v[192:195], v[240:243], v[0:7], v244
    ds_read_b128 a[208:211], v137 offset:20480
    v_exp_f32 v25, v25
    v_exp_f32 v26, v26
    v_smfmac_f32_32x32x32_bf16 v[64:79], a[228:231], v[8:15], v244
    v_exp_f32 v27, v27
    v_exp_f32 v28, v28
    v_exp_f32 v29, v29
    v_smfmac_f32_16x16x64_bf16 v[192:195], v[240:243], v[8:15], v244
    s_waitcnt lgkmcnt(1)
    ds_read_b128 a[212:215], v137 offset:21504
    v_exp_f32 v30, v30
    v_exp_f32 v31, v31
    v_mfma_f32_32x32x16_bf16 v[112:127], a[216:219], a[248:251], v[48:63]
    buffer_load_dwordx4 a[20:23], v235, s[12:15], 0 offen offset:1024 sc1
    v_exp_f32 v96, v96
    v_exp_f32 v97, v97
    v_exp_f32 v98, v98
    v_smfmac_f32_32x32x32_bf16 v[80:95], a[224:227], v[16:23], v244
    buffer_load_dwordx4 v233, s[20:23], 0 offen offset:1024 lds
    s_add_u32 s20, s20, 65536
    s_addc_u32 s21, s21, 0
    v_exp_f32 v99, v99
    v_exp_f32 v100, v100
    v_exp_f32 v101, v101
    v_mfma_f32_32x32x16_bf16 v[112:127], a[220:223], a[252:255], v[112:127]
    v_exp_f32 v102, v102
    v_exp_f32 v103, v103
    v_exp_f32 v104, v104
    v_smfmac_f32_16x16x64_bf16 v[196:199], v[240:243], v[16:23], v244
    ds_read_b128 a[192:195], v137 offset:28672
    v_exp_f32 v105, v105
    v_exp_f32 v106, v106
    v_smfmac_f32_32x32x32_bf16 v[80:95], a[228:231], v[24:31], v244
    v_exp_f32 v107, v107
    v_exp_f32 v108, v108
    v_exp_f32 v109, v109
    v_smfmac_f32_16x16x64_bf16 v[196:199], v[240:243], v[24:31], v244
    s_waitcnt lgkmcnt(1)
    ds_read_b128 a[196:199], v137 offset:29696
    v_exp_f32 v110, v110
    v_exp_f32 v111, v111
    v_mfma_f32_32x32x16_bf16 v[0:15], a[208:211], a[240:243], v[32:47]
    buffer_load_dwordx4 a[24:27], v236, s[12:15], 0 offen offset:1024 sc1
    v_exp_f32 v112, v112
    v_exp_f32 v113, v113
    v_exp_f32 v114, v114
    v_smfmac_f32_32x32x32_bf16 v[64:79], a[232:235], v[96:103], v244
    buffer_load_dwordx4 a[28:31], v237, s[12:15], 0 offen offset:1024 sc1
    s_add_u32 m0, s54, 16384
    v_exp_f32 v115, v115
    v_exp_f32 v116, v116
    v_exp_f32 v117, v117
    v_mfma_f32_32x32x16_bf16 v[0:15], a[212:215], a[244:247], v[0:15]
    v_exp_f32 v118, v118
    v_exp_f32 v119, v119
    v_exp_f32 v120, v120
    v_smfmac_f32_16x16x64_bf16 v[192:195], v[240:243], v[96:103], v244
    ds_read_b128 a[216:219], v137 offset:22528
    v_exp_f32 v121, v121
    v_exp_f32 v122, v122
    v_smfmac_f32_32x32x32_bf16 v[64:79], a[236:239], v[104:111], v244
    v_exp_f32 v123, v123
    v_exp_f32 v124, v124
    v_exp_f32 v125, v125
    v_smfmac_f32_16x16x64_bf16 v[192:195], v[240:243], v[104:111], v244
    s_waitcnt lgkmcnt(1)
    ds_read_b128 a[220:223], v137 offset:23552
    v_exp_f32 v126, v126
    v_exp_f32 v127, v127
    v_mfma_f32_32x32x16_bf16 v[16:31], a[208:211], a[248:251], v[48:63]
    buffer_load_dwordx4 v232, s[20:23], 0 offen offset:0 lds
    v_exp_f32 v0, v0
    v_exp_f32 v1, v1
    v_exp_f32 v2, v2
    v_smfmac_f32_32x32x32_bf16 v[80:95], a[232:235], v[112:119], v244
    buffer_load_dwordx4 a[32:35], v234, s[12:15], 0 offen offset:2048 sc1
    v_exp_f32 v3, v3
    v_exp_f32 v4, v4
    v_exp_f32 v5, v5
    v_mfma_f32_32x32x16_bf16 v[16:31], a[212:215], a[252:255], v[16:31]
    v_exp_f32 v6, v6
    v_exp_f32 v7, v7
    v_exp_f32 v8, v8
    v_smfmac_f32_16x16x64_bf16 v[196:199], v[240:243], v[112:119], v244
    ds_read_b128 a[200:203], v137 offset:30720
    v_exp_f32 v9, v9
    v_exp_f32 v10, v10
    v_smfmac_f32_32x32x32_bf16 v[80:95], a[236:239], v[120:127], v244
    v_exp_f32 v11, v11
    v_exp_f32 v12, v12
    v_exp_f32 v13, v13
    v_smfmac_f32_16x16x64_bf16 v[196:199], v[240:243], v[120:127], v244
    s_waitcnt lgkmcnt(1)
    ds_read_b128 a[204:207], v137 offset:31744
    v_exp_f32 v14, v14
    v_exp_f32 v15, v15
    v_mfma_f32_32x32x16_bf16 v[96:111], a[216:219], a[240:243], v[32:47]
    buffer_load_dwordx4 a[36:39], v235, s[12:15], 0 offen offset:2048 sc1
    v_exp_f32 v16, v16
    v_exp_f32 v17, v17
    v_exp_f32 v18, v18
    v_smfmac_f32_32x32x32_bf16 v[64:79], a[192:195], v[0:7], v244
    buffer_load_dwordx4 v233, s[20:23], 0 offen offset:1024 lds
    s_add_u32 s20, s20, 65536
    s_addc_u32 s21, s21, 0
    v_exp_f32 v19, v19
    v_exp_f32 v20, v20
    v_exp_f32 v21, v21
    v_mfma_f32_32x32x16_bf16 v[96:111], a[220:223], a[244:247], v[96:111]
    v_exp_f32 v22, v22
    v_exp_f32 v23, v23
    v_exp_f32 v24, v24
    v_smfmac_f32_16x16x64_bf16 v[192:195], v[240:243], v[0:7], v244
    ds_read_b128 a[208:211], v137 offset:32768
    v_exp_f32 v25, v25
    v_exp_f32 v26, v26
    v_smfmac_f32_32x32x32_bf16 v[64:79], a[196:199], v[8:15], v244
    v_exp_f32 v27, v27
    v_exp_f32 v28, v28
    v_exp_f32 v29, v29
    v_smfmac_f32_16x16x64_bf16 v[192:195], v[240:243], v[8:15], v244
    s_waitcnt lgkmcnt(1)
    ds_read_b128 a[212:215], v137 offset:33792
    v_exp_f32 v30, v30
    v_exp_f32 v31, v31
    v_mfma_f32_32x32x16_bf16 v[112:127], a[216:219], a[248:251], v[48:63]
    buffer_load_dwordx4 a[40:43], v236, s[12:15], 0 offen offset:2048 sc1
    v_exp_f32 v96, v96
    v_exp_f32 v97, v97
    v_exp_f32 v98, v98
    v_smfmac_f32_32x32x32_bf16 v[80:95], a[192:195], v[16:23], v244
    buffer_load_dwordx4 a[44:47], v237, s[12:15], 0 offen offset:2048 sc1
    s_add_u32 m0, s54, 24576
    v_exp_f32 v99, v99
    v_exp_f32 v100, v100
    v_exp_f32 v101, v101
    v_mfma_f32_32x32x16_bf16 v[112:127], a[220:223], a[252:255], v[112:127]
    v_exp_f32 v102, v102
    v_exp_f32 v103, v103
    v_exp_f32 v104, v104
    v_smfmac_f32_16x16x64_bf16 v[196:199], v[240:243], v[16:23], v244
    ds_read_b128 a[224:227], v137 offset:40960
    v_exp_f32 v105, v105
    v_exp_f32 v106, v106
    v_smfmac_f32_32x32x32_bf16 v[80:95], a[196:199], v[24:31], v244
    v_exp_f32 v107, v107
    v_exp_f32 v108, v108
    v_exp_f32 v109, v109
    v_smfmac_f32_16x16x64_bf16 v[196:199], v[240:243], v[24:31], v244
    s_waitcnt lgkmcnt(1)
    ds_read_b128 a[228:231], v137 offset:41984
    v_exp_f32 v110, v110
    v_exp_f32 v111, v111
    v_mfma_f32_32x32x16_bf16 v[0:15], a[208:211], a[240:243], v[32:47]
    buffer_load_dwordx4 v232, s[20:23], 0 offen offset:0 lds
    v_exp_f32 v112, v112
    v_exp_f32 v113, v113
    v_exp_f32 v114, v114
    v_smfmac_f32_32x32x32_bf16 v[64:79], a[200:203], v[96:103], v244
    buffer_load_dwordx4 a[48:51], v234, s[12:15], 0 offen offset:3072 sc1
    v_exp_f32 v115, v115
    v_exp_f32 v116, v116
    v_exp_f32 v117, v117
    v_mfma_f32_32x32x16_bf16 v[0:15], a[212:215], a[244:247], v[0:15]
    v_exp_f32 v118, v118
    v_exp_f32 v119, v119
    v_exp_f32 v120, v120
    v_smfmac_f32_16x16x64_bf16 v[192:195], v[240:243], v[96:103], v244
    ds_read_b128 a[216:219], v137 offset:34816
    v_exp_f32 v121, v121
    v_exp_f32 v122, v122
    v_smfmac_f32_32x32x32_bf16 v[64:79], a[204:207], v[104:111], v244
    v_exp_f32 v123, v123
    v_exp_f32 v124, v124
    v_exp_f32 v125, v125
    v_smfmac_f32_16x16x64_bf16 v[192:195], v[240:243], v[104:111], v244
    s_waitcnt lgkmcnt(1)
    ds_read_b128 a[220:223], v137 offset:35840
    v_exp_f32 v126, v126
    v_exp_f32 v127, v127
    v_mfma_f32_32x32x16_bf16 v[16:31], a[208:211], a[248:251], v[48:63]
    buffer_load_dwordx4 a[52:55], v235, s[12:15], 0 offen offset:3072 sc1
    v_exp_f32 v0, v0
    v_exp_f32 v1, v1
    v_exp_f32 v2, v2
    v_smfmac_f32_32x32x32_bf16 v[80:95], a[200:203], v[112:119], v244
    buffer_load_dwordx4 v233, s[20:23], 0 offen offset:1024 lds
    s_add_u32 s20, s20, 65536
    s_addc_u32 s21, s21, 0
    v_exp_f32 v3, v3
    v_exp_f32 v4, v4
    v_exp_f32 v5, v5
    v_mfma_f32_32x32x16_bf16 v[16:31], a[212:215], a[252:255], v[16:31]
    v_exp_f32 v6, v6
    v_exp_f32 v7, v7
    v_exp_f32 v8, v8
    v_smfmac_f32_16x16x64_bf16 v[196:199], v[240:243], v[112:119], v244
    ds_read_b128 a[232:235], v137 offset:43008
    v_exp_f32 v9, v9
    v_exp_f32 v10, v10
    v_smfmac_f32_32x32x32_bf16 v[80:95], a[204:207], v[120:127], v244
    v_exp_f32 v11, v11
    v_exp_f32 v12, v12
    v_exp_f32 v13, v13
    v_smfmac_f32_16x16x64_bf16 v[196:199], v[240:243], v[120:127], v244
    s_waitcnt lgkmcnt(1)
    ds_read_b128 a[236:239], v137 offset:44032
    v_exp_f32 v14, v14
    v_exp_f32 v15, v15
    v_mfma_f32_32x32x16_bf16 v[96:111], a[216:219], a[240:243], v[32:47]
    buffer_load_dwordx4 a[56:59], v236, s[12:15], 0 offen offset:3072 sc1
    v_exp_f32 v16, v16
    v_exp_f32 v17, v17
    v_exp_f32 v18, v18
    v_smfmac_f32_32x32x32_bf16 v[64:79], a[224:227], v[0:7], v244
    buffer_load_dwordx4 a[60:63], v237, s[12:15], 0 offen offset:3072 sc1
    s_add_u32 s12, s12, 4096
    s_addc_u32 s13, s13, 0
    v_exp_f32 v19, v19
    v_exp_f32 v20, v20
    v_exp_f32 v21, v21
    v_mfma_f32_32x32x16_bf16 v[96:111], a[220:223], a[244:247], v[96:111]
    s_add_u32 m0, s54, 131072
    v_exp_f32 v22, v22
    v_exp_f32 v23, v23
    v_exp_f32 v24, v24
    v_smfmac_f32_16x16x64_bf16 v[192:195], v[240:243], v[0:7], v244
    ds_read_b128 a[208:211], v137 offset:36864
    v_exp_f32 v25, v25
    v_exp_f32 v26, v26
    v_smfmac_f32_32x32x32_bf16 v[64:79], a[228:231], v[8:15], v244
    v_exp_f32 v27, v27
    v_exp_f32 v28, v28
    v_exp_f32 v29, v29
    v_smfmac_f32_16x16x64_bf16 v[192:195], v[240:243], v[8:15], v244
    s_waitcnt lgkmcnt(1)
    ds_read_b128 a[212:215], v137 offset:37888
    v_exp_f32 v30, v30
    v_exp_f32 v31, v31
    v_mfma_f32_32x32x16_bf16 v[112:127], a[216:219], a[248:251], v[48:63]
    buffer_load_dwordx4 v232, s[20:23], 0 offen offset:0 lds
    v_exp_f32 v96, v96
    v_exp_f32 v97, v97
    v_exp_f32 v98, v98
    v_smfmac_f32_32x32x32_bf16 v[80:95], a[224:227], v[16:23], v244
    buffer_load_dwordx4 a[64:67], v234, s[12:15], 0 offen offset:0 sc1
    v_exp_f32 v99, v99
    v_exp_f32 v100, v100
    v_exp_f32 v101, v101
    v_mfma_f32_32x32x16_bf16 v[112:127], a[220:223], a[252:255], v[112:127]
    v_exp_f32 v102, v102
    v_exp_f32 v103, v103
    v_exp_f32 v104, v104
    v_smfmac_f32_16x16x64_bf16 v[196:199], v[240:243], v[16:23], v244
    ds_read_b128 a[192:195], v137 offset:45056
    v_exp_f32 v105, v105
    v_exp_f32 v106, v106
    v_smfmac_f32_32x32x32_bf16 v[80:95], a[228:231], v[24:31], v244
    v_exp_f32 v107, v107
    v_exp_f32 v108, v108
    v_exp_f32 v109, v109
    v_smfmac_f32_16x16x64_bf16 v[196:199], v[240:243], v[24:31], v244
    s_waitcnt lgkmcnt(1)
    ds_read_b128 a[196:199], v137 offset:46080
    v_exp_f32 v110, v110
    v_exp_f32 v111, v111
    v_mfma_f32_32x32x16_bf16 v[0:15], a[208:211], a[240:243], v[32:47]
    buffer_load_dwordx4 a[68:71], v235, s[12:15], 0 offen offset:0 sc1
    v_exp_f32 v112, v112
    v_exp_f32 v113, v113
    v_exp_f32 v114, v114
    v_smfmac_f32_32x32x32_bf16 v[64:79], a[232:235], v[96:103], v244
    buffer_load_dwordx4 v233, s[20:23], 0 offen offset:1024 lds
    s_add_u32 s20, s20, 65536
    s_addc_u32 s21, s21, 0
    v_exp_f32 v115, v115
    v_exp_f32 v116, v116
    v_exp_f32 v117, v117
    v_mfma_f32_32x32x16_bf16 v[0:15], a[212:215], a[244:247], v[0:15]
    v_exp_f32 v118, v118
    v_exp_f32 v119, v119
    v_exp_f32 v120, v120
    v_smfmac_f32_16x16x64_bf16 v[192:195], v[240:243], v[96:103], v244
    ds_read_b128 a[216:219], v137 offset:38912
    v_exp_f32 v121, v121
    v_exp_f32 v122, v122
    v_smfmac_f32_32x32x32_bf16 v[64:79], a[236:239], v[104:111], v244
    v_exp_f32 v123, v123
    v_exp_f32 v124, v124
    v_exp_f32 v125, v125
    v_smfmac_f32_16x16x64_bf16 v[192:195], v[240:243], v[104:111], v244
    s_waitcnt lgkmcnt(1)
    ds_read_b128 a[220:223], v137 offset:39936
    v_exp_f32 v126, v126
    v_exp_f32 v127, v127
    v_mfma_f32_32x32x16_bf16 v[16:31], a[208:211], a[248:251], v[48:63]
    s_waitcnt vmcnt(35)
    buffer_load_dwordx4 a[72:75], v236, s[12:15], 0 offen offset:0 sc1
    v_exp_f32 v0, v0
    v_exp_f32 v1, v1
    v_exp_f32 v2, v2
    v_smfmac_f32_32x32x32_bf16 v[80:95], a[232:235], v[112:119], v244
    s_barrier
    buffer_load_dwordx4 a[76:79], v237, s[12:15], 0 offen offset:0 sc1
    s_add_u32 m0, s54, 139264
    v_exp_f32 v3, v3
    v_exp_f32 v4, v4
    v_exp_f32 v5, v5
    v_mfma_f32_32x32x16_bf16 v[16:31], a[212:215], a[252:255], v[16:31]
    v_exp_f32 v6, v6
    v_exp_f32 v7, v7
    v_exp_f32 v8, v8
    v_smfmac_f32_16x16x64_bf16 v[196:199], v[240:243], v[112:119], v244
    ds_read_b128 a[200:203], v137 offset:47104
    v_exp_f32 v9, v9
    v_exp_f32 v10, v10
    v_smfmac_f32_32x32x32_bf16 v[80:95], a[236:239], v[120:127], v244
    v_exp_f32 v11, v11
    v_exp_f32 v12, v12
    v_exp_f32 v13, v13
    v_smfmac_f32_16x16x64_bf16 v[196:199], v[240:243], v[120:127], v244
    s_waitcnt lgkmcnt(1)
    ds_read_b128 a[204:207], v137 offset:48128
    v_exp_f32 v14, v14
    v_exp_f32 v15, v15
    v_mfma_f32_32x32x16_bf16 v[96:111], a[216:219], a[240:243], v[32:47]
    buffer_load_dwordx4 v232, s[20:23], 0 offen offset:0 lds
    v_exp_f32 v16, v16
    v_exp_f32 v17, v17
    v_exp_f32 v18, v18
    v_smfmac_f32_32x32x32_bf16 v[64:79], a[192:195], v[0:7], v244
    buffer_load_dwordx4 a[80:83], v234, s[12:15], 0 offen offset:1024 sc1
    v_exp_f32 v19, v19
    v_exp_f32 v20, v20
    v_exp_f32 v21, v21
    v_mfma_f32_32x32x16_bf16 v[96:111], a[220:223], a[244:247], v[96:111]
    v_exp_f32 v22, v22
    v_exp_f32 v23, v23
    v_exp_f32 v24, v24
    v_smfmac_f32_16x16x64_bf16 v[192:195], v[240:243], v[0:7], v244
    ds_read_b128 a[208:211], v137 offset:49152
    v_exp_f32 v25, v25
    v_exp_f32 v26, v26
    v_smfmac_f32_32x32x32_bf16 v[64:79], a[196:199], v[8:15], v244
    v_exp_f32 v27, v27
    v_exp_f32 v28, v28
    v_exp_f32 v29, v29
    v_smfmac_f32_16x16x64_bf16 v[192:195], v[240:243], v[8:15], v244
    s_waitcnt lgkmcnt(1)
    ds_read_b128 a[212:215], v137 offset:50176
    v_exp_f32 v30, v30
    v_exp_f32 v31, v31
    v_mfma_f32_32x32x16_bf16 v[112:127], a[216:219], a[248:251], v[48:63]
    buffer_load_dwordx4 a[84:87], v235, s[12:15], 0 offen offset:1024 sc1
    v_exp_f32 v96, v96
    v_exp_f32 v97, v97
    v_exp_f32 v98, v98
    v_smfmac_f32_32x32x32_bf16 v[80:95], a[192:195], v[16:23], v244
    buffer_load_dwordx4 v233, s[20:23], 0 offen offset:1024 lds
    s_add_u32 s20, s20, 65536
    s_addc_u32 s21, s21, 0
    v_exp_f32 v99, v99
    v_exp_f32 v100, v100
    v_exp_f32 v101, v101
    v_mfma_f32_32x32x16_bf16 v[112:127], a[220:223], a[252:255], v[112:127]
    v_exp_f32 v102, v102
    v_exp_f32 v103, v103
    v_exp_f32 v104, v104
    v_smfmac_f32_16x16x64_bf16 v[196:199], v[240:243], v[16:23], v244
    ds_read_b128 a[224:227], v137 offset:57344
    v_exp_f32 v105, v105
    v_exp_f32 v106, v106
    v_smfmac_f32_32x32x32_bf16 v[80:95], a[196:199], v[24:31], v244
    v_exp_f32 v107, v107
    v_exp_f32 v108, v108
    v_exp_f32 v109, v109
    v_smfmac_f32_16x16x64_bf16 v[196:199], v[240:243], v[24:31], v244
    s_waitcnt lgkmcnt(1)
    ds_read_b128 a[228:231], v137 offset:58368
    v_exp_f32 v110, v110
    v_exp_f32 v111, v111
    v_mfma_f32_32x32x16_bf16 v[0:15], a[208:211], a[240:243], v[32:47]
    buffer_load_dwordx4 a[88:91], v236, s[12:15], 0 offen offset:1024 sc1
    v_exp_f32 v112, v112
    v_exp_f32 v113, v113
    v_exp_f32 v114, v114
    v_smfmac_f32_32x32x32_bf16 v[64:79], a[200:203], v[96:103], v244
    buffer_load_dwordx4 a[92:95], v237, s[12:15], 0 offen offset:1024 sc1
    s_add_u32 m0, s54, 147456
    v_exp_f32 v115, v115
    v_exp_f32 v116, v116
    v_exp_f32 v117, v117
    v_mfma_f32_32x32x16_bf16 v[0:15], a[212:215], a[244:247], v[0:15]
    v_exp_f32 v118, v118
    v_exp_f32 v119, v119
    v_exp_f32 v120, v120
    v_smfmac_f32_16x16x64_bf16 v[192:195], v[240:243], v[96:103], v244
    ds_read_b128 a[216:219], v137 offset:51200
    v_exp_f32 v121, v121
    v_exp_f32 v122, v122
    v_smfmac_f32_32x32x32_bf16 v[64:79], a[204:207], v[104:111], v244
    v_exp_f32 v123, v123
    v_exp_f32 v124, v124
    v_exp_f32 v125, v125
    v_smfmac_f32_16x16x64_bf16 v[192:195], v[240:243], v[104:111], v244
    s_waitcnt lgkmcnt(1)
    ds_read_b128 a[220:223], v137 offset:52224
    v_exp_f32 v126, v126
    v_exp_f32 v127, v127
    v_mfma_f32_32x32x16_bf16 v[16:31], a[208:211], a[248:251], v[48:63]
    buffer_load_dwordx4 v232, s[20:23], 0 offen offset:0 lds
    v_exp_f32 v0, v0
    v_exp_f32 v1, v1
    v_exp_f32 v2, v2
    v_smfmac_f32_32x32x32_bf16 v[80:95], a[200:203], v[112:119], v244
    buffer_load_dwordx4 a[96:99], v234, s[12:15], 0 offen offset:2048 sc1
    v_exp_f32 v3, v3
    v_exp_f32 v4, v4
    v_exp_f32 v5, v5
    v_mfma_f32_32x32x16_bf16 v[16:31], a[212:215], a[252:255], v[16:31]
    v_exp_f32 v6, v6
    v_exp_f32 v7, v7
    v_exp_f32 v8, v8
    v_smfmac_f32_16x16x64_bf16 v[196:199], v[240:243], v[112:119], v244
    ds_read_b128 a[232:235], v137 offset:59392
    v_exp_f32 v9, v9
    v_exp_f32 v10, v10
    v_smfmac_f32_32x32x32_bf16 v[80:95], a[204:207], v[120:127], v244
    v_exp_f32 v11, v11
    v_exp_f32 v12, v12
    v_exp_f32 v13, v13
    v_smfmac_f32_16x16x64_bf16 v[196:199], v[240:243], v[120:127], v244
    s_waitcnt lgkmcnt(1)
    ds_read_b128 a[236:239], v137 offset:60416
    v_exp_f32 v14, v14
    v_exp_f32 v15, v15
    v_mfma_f32_32x32x16_bf16 v[96:111], a[216:219], a[240:243], v[32:47]
    buffer_load_dwordx4 a[100:103], v235, s[12:15], 0 offen offset:2048 sc1
    v_exp_f32 v16, v16
    v_exp_f32 v17, v17
    v_exp_f32 v18, v18
    v_smfmac_f32_32x32x32_bf16 v[64:79], a[224:227], v[0:7], v244
    buffer_load_dwordx4 v233, s[20:23], 0 offen offset:1024 lds
    s_add_u32 s20, s20, 65536
    s_addc_u32 s21, s21, 0
    v_exp_f32 v19, v19
    v_exp_f32 v20, v20
    v_exp_f32 v21, v21
    v_mfma_f32_32x32x16_bf16 v[96:111], a[220:223], a[244:247], v[96:111]
    v_exp_f32 v22, v22
    v_exp_f32 v23, v23
    v_exp_f32 v24, v24
    v_smfmac_f32_16x16x64_bf16 v[192:195], v[240:243], v[0:7], v244
    ds_read_b128 a[208:211], v137 offset:53248
    v_exp_f32 v25, v25
    v_exp_f32 v26, v26
    v_smfmac_f32_32x32x32_bf16 v[64:79], a[228:231], v[8:15], v244
    v_exp_f32 v27, v27
    v_exp_f32 v28, v28
    v_exp_f32 v29, v29
    v_smfmac_f32_16x16x64_bf16 v[192:195], v[240:243], v[8:15], v244
    s_waitcnt lgkmcnt(1)
    ds_read_b128 a[212:215], v137 offset:54272
    v_exp_f32 v30, v30
    v_exp_f32 v31, v31
    v_mfma_f32_32x32x16_bf16 v[112:127], a[216:219], a[248:251], v[48:63]
    buffer_load_dwordx4 a[104:107], v236, s[12:15], 0 offen offset:2048 sc1
    v_exp_f32 v96, v96
    v_exp_f32 v97, v97
    v_exp_f32 v98, v98
    v_smfmac_f32_32x32x32_bf16 v[80:95], a[224:227], v[16:23], v244
    buffer_load_dwordx4 a[108:111], v237, s[12:15], 0 offen offset:2048 sc1
    s_add_u32 m0, s54, 155648
    v_exp_f32 v99, v99
    v_exp_f32 v100, v100
    v_exp_f32 v101, v101
    v_mfma_f32_32x32x16_bf16 v[112:127], a[220:223], a[252:255], v[112:127]
    v_exp_f32 v102, v102
    v_exp_f32 v103, v103
    v_exp_f32 v104, v104
    v_smfmac_f32_16x16x64_bf16 v[196:199], v[240:243], v[16:23], v244
    ds_read_b128 a[192:195], v137 offset:61440
    v_exp_f32 v105, v105
    v_exp_f32 v106, v106
    v_smfmac_f32_32x32x32_bf16 v[80:95], a[228:231], v[24:31], v244
    v_exp_f32 v107, v107
    v_exp_f32 v108, v108
    v_exp_f32 v109, v109
    v_smfmac_f32_16x16x64_bf16 v[196:199], v[240:243], v[24:31], v244
    s_waitcnt lgkmcnt(1)
    ds_read_b128 a[196:199], v137 offset:62464
    v_exp_f32 v110, v110
    v_exp_f32 v111, v111
    v_mfma_f32_32x32x16_bf16 v[0:15], a[208:211], a[240:243], v[32:47]
    buffer_load_dwordx4 v232, s[20:23], 0 offen offset:0 lds
    v_exp_f32 v112, v112
    v_exp_f32 v113, v113
    v_exp_f32 v114, v114
    v_smfmac_f32_32x32x32_bf16 v[64:79], a[232:235], v[96:103], v244
    buffer_load_dwordx4 a[112:115], v234, s[12:15], 0 offen offset:3072 sc1
    v_exp_f32 v115, v115
    v_exp_f32 v116, v116
    v_exp_f32 v117, v117
    v_mfma_f32_32x32x16_bf16 v[0:15], a[212:215], a[244:247], v[0:15]
    v_exp_f32 v118, v118
    v_exp_f32 v119, v119
    v_exp_f32 v120, v120
    v_smfmac_f32_16x16x64_bf16 v[192:195], v[240:243], v[96:103], v244
    ds_read_b128 a[216:219], v137 offset:55296
    v_exp_f32 v121, v121
    v_exp_f32 v122, v122
    v_smfmac_f32_32x32x32_bf16 v[64:79], a[236:239], v[104:111], v244
    v_exp_f32 v123, v123
    v_exp_f32 v124, v124
    v_exp_f32 v125, v125
    v_smfmac_f32_16x16x64_bf16 v[192:195], v[240:243], v[104:111], v244
    s_waitcnt lgkmcnt(1)
    ds_read_b128 a[220:223], v137 offset:56320
    v_exp_f32 v126, v126
    v_exp_f32 v127, v127
    v_mfma_f32_32x32x16_bf16 v[16:31], a[208:211], a[248:251], v[48:63]
    buffer_load_dwordx4 a[116:119], v235, s[12:15], 0 offen offset:3072 sc1
    v_exp_f32 v0, v0
    v_exp_f32 v1, v1
    v_exp_f32 v2, v2
    v_smfmac_f32_32x32x32_bf16 v[80:95], a[232:235], v[112:119], v244
    buffer_load_dwordx4 v233, s[20:23], 0 offen offset:1024 lds
    s_add_u32 s20, s20, 65536
    s_addc_u32 s21, s21, 0
    v_exp_f32 v3, v3
    v_exp_f32 v4, v4
    v_exp_f32 v5, v5
    v_mfma_f32_32x32x16_bf16 v[16:31], a[212:215], a[252:255], v[16:31]
    v_exp_f32 v6, v6
    v_exp_f32 v7, v7
    v_exp_f32 v8, v8
    v_smfmac_f32_16x16x64_bf16 v[196:199], v[240:243], v[112:119], v244
    ds_read_b128 a[200:203], v137 offset:63488
    v_exp_f32 v9, v9
    v_exp_f32 v10, v10
    v_smfmac_f32_32x32x32_bf16 v[80:95], a[236:239], v[120:127], v244
    v_exp_f32 v11, v11
    v_exp_f32 v12, v12
    v_exp_f32 v13, v13
    v_smfmac_f32_16x16x64_bf16 v[196:199], v[240:243], v[120:127], v244
    s_waitcnt lgkmcnt(1)
    ds_read_b128 a[204:207], v137 offset:64512
    v_exp_f32 v14, v14
    v_exp_f32 v15, v15
    v_mfma_f32_32x32x16_bf16 v[96:111], a[216:219], a[240:243], v[32:47]
    buffer_load_dwordx4 a[120:123], v236, s[12:15], 0 offen offset:3072 sc1
    v_exp_f32 v16, v16
    v_exp_f32 v17, v17
    v_exp_f32 v18, v18
    v_smfmac_f32_32x32x32_bf16 v[64:79], a[192:195], v[0:7], v244
    buffer_load_dwordx4 a[124:127], v237, s[12:15], 0 offen offset:3072 sc1
    s_add_u32 s12, s12, 4096
    s_addc_u32 s13, s13, 0
    v_exp_f32 v19, v19
    v_exp_f32 v20, v20
    v_exp_f32 v21, v21
    v_mfma_f32_32x32x16_bf16 v[96:111], a[220:223], a[244:247], v[96:111]
    v_exp_f32 v22, v22
    v_exp_f32 v23, v23
    v_exp_f32 v24, v24
    v_smfmac_f32_16x16x64_bf16 v[192:195], v[240:243], v[0:7], v244
    v_exp_f32 v25, v25
    v_exp_f32 v26, v26
    v_smfmac_f32_32x32x32_bf16 v[64:79], a[196:199], v[8:15], v244
    v_exp_f32 v27, v27
    v_exp_f32 v28, v28
    v_exp_f32 v29, v29
    v_smfmac_f32_16x16x64_bf16 v[192:195], v[240:243], v[8:15], v244
    s_waitcnt lgkmcnt(0)
    v_exp_f32 v30, v30
    v_exp_f32 v31, v31
    v_mfma_f32_32x32x16_bf16 v[112:127], a[216:219], a[248:251], v[48:63]
    v_exp_f32 v96, v96
    v_exp_f32 v97, v97
    v_exp_f32 v98, v98
    v_smfmac_f32_32x32x32_bf16 v[80:95], a[192:195], v[16:23], v244
    v_exp_f32 v99, v99
    v_exp_f32 v100, v100
    v_exp_f32 v101, v101
    v_mfma_f32_32x32x16_bf16 v[112:127], a[220:223], a[252:255], v[112:127]
    v_exp_f32 v102, v102
    v_exp_f32 v103, v103
    v_exp_f32 v104, v104
    v_smfmac_f32_16x16x64_bf16 v[196:199], v[240:243], v[16:23], v244
    v_exp_f32 v105, v105
    v_exp_f32 v106, v106
    v_smfmac_f32_32x32x32_bf16 v[80:95], a[196:199], v[24:31], v244
    v_exp_f32 v107, v107
    v_exp_f32 v108, v108
    v_exp_f32 v109, v109
    v_smfmac_f32_16x16x64_bf16 v[196:199], v[240:243], v[24:31], v244
    s_waitcnt lgkmcnt(0)
    v_exp_f32 v110, v110
    v_exp_f32 v111, v111
    v_exp_f32 v112, v112
    v_exp_f32 v113, v113
    v_exp_f32 v114, v114
    v_smfmac_f32_32x32x32_bf16 v[64:79], a[200:203], v[96:103], v244
    v_exp_f32 v115, v115
    v_exp_f32 v116, v116
    v_exp_f32 v117, v117
    v_exp_f32 v118, v118
    v_exp_f32 v119, v119
    v_exp_f32 v120, v120
    v_smfmac_f32_16x16x64_bf16 v[192:195], v[240:243], v[96:103], v244
    v_exp_f32 v121, v121
    v_exp_f32 v122, v122
    v_smfmac_f32_32x32x32_bf16 v[64:79], a[204:207], v[104:111], v244
    v_exp_f32 v123, v123
    v_exp_f32 v124, v124
    v_exp_f32 v125, v125
    v_smfmac_f32_16x16x64_bf16 v[192:195], v[240:243], v[104:111], v244
    s_waitcnt lgkmcnt(0)
    v_exp_f32 v126, v126
    v_exp_f32 v127, v127
p3_code:
    v_smfmac_f32_32x32x32_bf16 v[80:95], a[200:203], v[112:119], v244
    v_smfmac_f32_16x16x64_bf16 v[196:199], v[240:243], v[112:119], v244
    v_smfmac_f32_32x32x32_bf16 v[80:95], a[204:207], v[120:127], v244
    v_smfmac_f32_16x16x64_bf16 v[196:199], v[240:243], v[120:127], v244
    v_lshrrev_b32 v218, 2, v255
    v_and_b32 v219, 7, v218
    v_lshlrev_b32 v219, 5, v219
    s_xor_b32 s39, s57, 3
    s_lshl_b32 s39, s39, 6
    v_xor_b32 v219, s39, v219
    v_lshl_add_u32 v219, v218, 8, v219
    v_and_b32 v218, 3, v255
    v_lshl_add_u32 v224, v218, 3, v219
    v_xor_b32 v225, 32, v224
    v_xor_b32 v226, 64, v224
    v_xor_b32 v227, 96, v224
    v_xor_b32 v228, 128, v224
    v_xor_b32 v229, 160, v224
    v_xor_b32 v230, 192, v224
    v_xor_b32 v231, 224, v224
    s_waitcnt vmcnt(24)
    s_barrier
    ds_read_b64_tr_b16 v[128:129], v224 offset:0
    ds_read_b64_tr_b16 v[130:131], v224 offset:4096
    ds_read_b64_tr_b16 v[132:133], v224 offset:8192
    ds_read_b64_tr_b16 v[134:135], v224 offset:12288
    ds_read_b64_tr_b16 v[136:137], v225 offset:0
    ds_read_b64_tr_b16 v[138:139], v225 offset:4096
    ds_read_b64_tr_b16 v[140:141], v225 offset:8192
    ds_read_b64_tr_b16 v[142:143], v225 offset:12288
    ds_read_b64_tr_b16 v[144:145], v226 offset:0
    ds_read_b64_tr_b16 v[146:147], v226 offset:4096
    ds_read_b64_tr_b16 v[148:149], v226 offset:8192
    ds_read_b64_tr_b16 v[150:151], v226 offset:12288
    v_bfe_u32 v210, v255, 2, 1
    v_mul_u32_u24 v212, 147456, v210
    v_bfe_u32 v210, v255, 3, 2
    v_lshl_add_u32 v212, v210, 6, v212
    v_and_b32 v210, 3, v255
    v_lshl_add_u32 v212, v210, 4, v212
    v_lshrrev_b32 v210, 5, v255
    v_lshl_add_u32 v212, v210, 8, v212
    s_lshl_b32 s77, s36, 2
    s_add_u32 s77, s77, s3
    s_mul_i32 s77, s77, 576
    s_add_u32 s77, s77, s37
    s_lshl_b32 s77, s77, 10
    s_add_u32 s77, s77, 0xc1c000
    s_waitcnt vmcnt(48)
    s_mov_b32 s76, 0x53800000
    s_mov_b32 s39, 0x2b800000
    v_cmp_ngt_f32 vcc, s76, v192
    v_cmp_ngt_f32 s[78:79], s76, v196
    s_nop 3
    s_or_b64 s[78:79], s[78:79], vcc
    v_cmp_nlt_f32 vcc, s39, v192
    s_nop 3
    s_or_b64 s[78:79], s[78:79], vcc
    v_cmp_nlt_f32 vcc, s39, v196
    s_nop 3
    s_or_b64 s[78:79], s[78:79], vcc
    s_cbranch_scc1 p2_slow
p2_epi:
    v_rcp_f32 v214, v192
    s_nop 0
    v_mul_f32 v214, v214, v208
    v_mul_f32 v64, v64, v214
    v_mul_f32 v65, v65, v214
    v_mul_f32 v66, v66, v214
    v_mul_f32 v67, v67, v214
    v_mul_f32 v68, v68, v214
    v_mul_f32 v69, v69, v214
    v_mul_f32 v70, v70, v214
    v_mul_f32 v71, v71, v214
    v_mul_f32 v72, v72, v214
    v_mul_f32 v73, v73, v214
    v_mul_f32 v74, v74, v214
    v_mul_f32 v75, v75, v214
    v_mul_f32 v76, v76, v214
    v_mul_f32 v77, v77, v214
    v_mul_f32 v78, v78, v214
    v_mul_f32 v79, v79, v214
    v_cvt_pk_bf16_f32 v0, v64, v65
    v_cvt_pk_bf16_f32 v1, v66, v67
    v_cvt_pk_bf16_f32 v2, v72, v73
    v_cvt_pk_bf16_f32 v3, v74, v75
    buffer_store_dwordx4 v[0:3], v212, s[16:19], s77 offen offset:0 sc1
    v_cvt_pk_bf16_f32 v4, v68, v69
    v_cvt_pk_bf16_f32 v5, v70, v71
    v_cvt_pk_bf16_f32 v6, v76, v77
    v_cvt_pk_bf16_f32 v7, v78, v79
    buffer_store_dwordx4 v[4:7], v212, s[16:19], s77 offen offset:512 sc1
    s_add_u32 s77, s77, 294912
    v_rcp_f32 v214, v196
    s_nop 0
    v_mul_f32 v214, v214, v209
    v_mul_f32 v80, v80, v214
    v_mul_f32 v81, v81, v214
    v_mul_f32 v82, v82, v214
    v_mul_f32 v83, v83, v214
    v_mul_f32 v84, v84, v214
    v_mul_f32 v85, v85, v214
    v_mul_f32 v86, v86, v214
    v_mul_f32 v87, v87, v214
    v_mul_f32 v88, v88, v214
    v_mul_f32 v89, v89, v214
    v_mul_f32 v90, v90, v214
    v_mul_f32 v91, v91, v214
    v_mul_f32 v92, v92, v214
    v_mul_f32 v93, v93, v214
    v_mul_f32 v94, v94, v214
    v_mul_f32 v95, v95, v214
    v_cvt_pk_bf16_f32 v16, v80, v81
    v_cvt_pk_bf16_f32 v17, v82, v83
    v_cvt_pk_bf16_f32 v18, v88, v89
    v_cvt_pk_bf16_f32 v19, v90, v91
    buffer_store_dwordx4 v[16:19], v212, s[16:19], s77 offen offset:0 sc1
    v_cvt_pk_bf16_f32 v20, v84, v85
    v_cvt_pk_bf16_f32 v21, v86, v87
    v_cvt_pk_bf16_f32 v22, v92, v93
    v_cvt_pk_bf16_f32 v23, v94, v95
    buffer_store_dwordx4 v[20:23], v212, s[16:19], s77 offen offset:512 sc1
    s_mul_i32 s63, s57, 524288
    v_mov_b32 v238, v232
    v_mov_b32 v239, v233
    s_waitcnt lgkmcnt(8)
    v_mfma_f32_16x16x32_bf16 v[0:3], v[128:131], a[0:3], 0
    ds_read_b64_tr_b16 v[152:153], v227 offset:0
    v_mfma_f32_16x16x32_bf16 v[0:3], v[132:135], a[16:19], v[0:3]
    ds_read_b64_tr_b16 v[154:155], v227 offset:4096
    v_mfma_f32_16x16x32_bf16 v[4:7], v[128:131], a[4:7], 0
    ds_read_b64_tr_b16 v[156:157], v227 offset:8192
    v_mfma_f32_16x16x32_bf16 v[4:7], v[132:135], a[20:23], v[4:7]
    ds_read_b64_tr_b16 v[158:159], v227 offset:12288
    s_add_u32 m0, s54, 32768
    v_mfma_f32_16x16x32_bf16 v[8:11], v[128:131], a[8:11], 0
    buffer_load_dwordx4 v232, s[20:23], 0 offen offset:0 lds
    v_add_u32 v160, 65536, v224
    v_mfma_f32_16x16x32_bf16 v[8:11], v[132:135], a[24:27], v[8:11]
    v_add_u32 v161, 65536, v225
    v_add_u32 v232, 65536, v232
    v_mfma_f32_16x16x32_bf16 v[12:15], v[128:131], a[12:15], 0
    v_add_u32 v162, 65536, v226
    v_mfma_f32_16x16x32_bf16 v[12:15], v[132:135], a[28:31], v[12:15]
    s_waitcnt lgkmcnt(8)
    v_add_u32 v163, 65536, v227
    v_mfma_f32_16x16x32_bf16 v[16:19], v[136:139], a[0:3], 0
    ds_read_b64_tr_b16 v[128:129], v228 offset:0
    buffer_load_dwordx4 a[128:131], v234, s[12:15], 0 offen offset:0 sc1
    v_add_u32 v164, 65536, v228
    v_mfma_f32_16x16x32_bf16 v[16:19], v[140:143], a[16:19], v[16:19]
    ds_read_b64_tr_b16 v[130:131], v228 offset:4096
    v_add_u32 v165, 65536, v229
    v_mfma_f32_16x16x32_bf16 v[20:23], v[136:139], a[4:7], 0
    ds_read_b64_tr_b16 v[132:133], v228 offset:8192
    v_add_u32 v166, 65536, v230
    v_mfma_f32_16x16x32_bf16 v[20:23], v[140:143], a[20:23], v[20:23]
    ds_read_b64_tr_b16 v[134:135], v228 offset:12288
    v_add_u32 v167, 65536, v231
    v_mfma_f32_16x16x32_bf16 v[24:27], v[136:139], a[8:11], 0
    v_add_u32 v168, 131072, v224
    v_mfma_f32_16x16x32_bf16 v[24:27], v[140:143], a[24:27], v[24:27]
    buffer_load_dwordx4 a[132:135], v235, s[12:15], 0 offen offset:0 sc1
    v_add_u32 v169, 131072, v225
    v_mfma_f32_16x16x32_bf16 v[28:31], v[136:139], a[12:15], 0
    v_add_u32 v170, 131072, v226
    v_mfma_f32_16x16x32_bf16 v[28:31], v[140:143], a[28:31], v[28:31]
    s_waitcnt lgkmcnt(8)
    v_add_u32 v171, 131072, v227
    v_mfma_f32_16x16x32_bf16 v[32:35], v[144:147], a[0:3], 0
    ds_read_b64_tr_b16 v[136:137], v229 offset:0
    v_add_u32 v172, 131072, v228
    v_mfma_f32_16x16x32_bf16 v[32:35], v[148:151], a[16:19], v[32:35]
    ds_read_b64_tr_b16 v[138:139], v229 offset:4096
    v_add_u32 v173, 131072, v229
    v_mfma_f32_16x16x32_bf16 v[36:39], v[144:147], a[4:7], 0
    ds_read_b64_tr_b16 v[140:141], v229 offset:8192
    buffer_load_dwordx4 v233, s[20:23], 0 offen offset:1024 lds
    v_add_u32 v174, 131072, v230
    v_mfma_f32_16x16x32_bf16 v[36:39], v[148:151], a[20:23], v[36:39]
    ds_read_b64_tr_b16 v[142:143], v229 offset:12288
    v_add_u32 v175, 131072, v231
    v_add_u32 v233, 65536, v233
    v_mfma_f32_16x16x32_bf16 v[40:43], v[144:147], a[8:11], 0
    v_mfma_f32_16x16x32_bf16 v[40:43], v[148:151], a[24:27], v[40:43]
    v_mfma_f32_16x16x32_bf16 v[44:47], v[144:147], a[12:15], 0
    v_sub_f32 v200, 1.0, v200
    v_mfma_f32_16x16x32_bf16 v[44:47], v[148:151], a[28:31], v[44:47]
    s_waitcnt lgkmcnt(8)
    buffer_load_dwordx4 a[136:139], v236, s[12:15], 0 offen offset:0 sc1
    v_sub_f32 v201, 1.0, v201
    v_mfma_f32_16x16x32_bf16 v[48:51], v[152:155], a[0:3], 0
    ds_read_b64_tr_b16 v[144:145], v230 offset:0
    v_sub_f32 v202, 1.0, v202
    v_mfma_f32_16x16x32_bf16 v[48:51], v[156:159], a[16:19], v[48:51]
    ds_read_b64_tr_b16 v[146:147], v230 offset:4096
    v_sub_f32 v203, 1.0, v203
    v_mfma_f32_16x16x32_bf16 v[52:55], v[152:155], a[4:7], 0
    ds_read_b64_tr_b16 v[148:149], v230 offset:8192
    v_mfma_f32_16x16x32_bf16 v[52:55], v[156:159], a[20:23], v[52:55]
    ds_read_b64_tr_b16 v[150:151], v230 offset:12288
    v_mfma_f32_16x16x32_bf16 v[56:59], v[152:155], a[8:11], 0
    buffer_load_dwordx4 a[140:143], v237, s[12:15], 0 offen offset:0 sc1
    v_mfma_f32_16x16x32_bf16 v[56:59], v[156:159], a[24:27], v[56:59]
    v_mfma_f32_16x16x32_bf16 v[60:63], v[152:155], a[12:15], 0
    v_mfma_f32_16x16x32_bf16 v[60:63], v[156:159], a[28:31], v[60:63]
    s_waitcnt lgkmcnt(8)
    v_mfma_f32_16x16x32_bf16 v[64:67], v[128:131], a[0:3], 0
    ds_read_b64_tr_b16 v[152:153], v231 offset:0
    s_add_u32 m0, s54, 40960
    v_mfma_f32_16x16x32_bf16 v[64:67], v[132:135], a[16:19], v[64:67]
    ds_read_b64_tr_b16 v[154:155], v231 offset:4096
    buffer_load_dwordx4 v232, s[20:23], 0 offen offset:0 lds
    v_mfma_f32_16x16x32_bf16 v[68:71], v[128:131], a[4:7], 0
    ds_read_b64_tr_b16 v[156:157], v231 offset:8192
    v_add_u32 v232, 65536, v232
    v_mfma_f32_16x16x32_bf16 v[68:71], v[132:135], a[20:23], v[68:71]
    ds_read_b64_tr_b16 v[158:159], v231 offset:12288
    v_mfma_f32_16x16x32_bf16 v[72:75], v[128:131], a[8:11], 0
    v_mfma_f32_16x16x32_bf16 v[72:75], v[132:135], a[24:27], v[72:75]
    v_mfma_f32_16x16x32_bf16 v[76:79], v[128:131], a[12:15], 0
    buffer_load_dwordx4 a[144:147], v234, s[12:15], 0 offen offset:1024 sc1
    v_mfma_f32_16x16x32_bf16 v[76:79], v[132:135], a[28:31], v[76:79]
    s_waitcnt lgkmcnt(8)
    v_mfma_f32_16x16x32_bf16 v[80:83], v[136:139], a[0:3], 0
    ds_read_b64_tr_b16 v[128:129], v224 offset:16384
    v_mfma_f32_16x16x32_bf16 v[80:83], v[140:143], a[16:19], v[80:83]
    ds_read_b64_tr_b16 v[130:131], v224 offset:20480
    v_mfma_f32_16x16x32_bf16 v[84:87], v[136:139], a[4:7], 0
    ds_read_b64_tr_b16 v[132:133], v224 offset:24576
    v_mfma_f32_16x16x32_bf16 v[84:87], v[140:143], a[20:23], v[84:87]
    ds_read_b64_tr_b16 v[134:135], v224 offset:28672
    buffer_load_dwordx4 a[148:151], v235, s[12:15], 0 offen offset:1024 sc1
    v_mfma_f32_16x16x32_bf16 v[88:91], v[136:139], a[8:11], 0
    v_mfma_f32_16x16x32_bf16 v[88:91], v[140:143], a[24:27], v[88:91]
    v_mfma_f32_16x16x32_bf16 v[92:95], v[136:139], a[12:15], 0
    v_mfma_f32_16x16x32_bf16 v[92:95], v[140:143], a[28:31], v[92:95]
    s_waitcnt lgkmcnt(8)
    v_mfma_f32_16x16x32_bf16 v[96:99], v[144:147], a[0:3], 0
    ds_read_b64_tr_b16 v[136:137], v225 offset:16384
    buffer_load_dwordx4 v233, s[20:23], 0 offen offset:1024 lds
    v_mfma_f32_16x16x32_bf16 v[96:99], v[148:151], a[16:19], v[96:99]
    ds_read_b64_tr_b16 v[138:139], v225 offset:20480
    v_add_u32 v233, 65536, v233
    v_mfma_f32_16x16x32_bf16 v[100:103], v[144:147], a[4:7], 0
    ds_read_b64_tr_b16 v[140:141], v225 offset:24576
    v_mfma_f32_16x16x32_bf16 v[100:103], v[148:151], a[20:23], v[100:103]
    ds_read_b64_tr_b16 v[142:143], v225 offset:28672
    v_mfma_f32_16x16x32_bf16 v[104:107], v[144:147], a[8:11], 0
    v_mfma_f32_16x16x32_bf16 v[104:107], v[148:151], a[24:27], v[104:107]
    buffer_load_dwordx4 a[152:155], v236, s[12:15], 0 offen offset:1024 sc1
    v_mfma_f32_16x16x32_bf16 v[108:111], v[144:147], a[12:15], 0
    v_mfma_f32_16x16x32_bf16 v[108:111], v[148:151], a[28:31], v[108:111]
    s_waitcnt lgkmcnt(8)
    v_mfma_f32_16x16x32_bf16 v[112:115], v[152:155], a[0:3], 0
    ds_read_b64_tr_b16 v[144:145], v226 offset:16384
    v_mfma_f32_16x16x32_bf16 v[112:115], v[156:159], a[16:19], v[112:115]
    ds_read_b64_tr_b16 v[146:147], v226 offset:20480
    buffer_load_dwordx4 a[156:159], v237, s[12:15], 0 offen offset:1024 sc1
    v_mfma_f32_16x16x32_bf16 v[116:119], v[152:155], a[4:7], 0
    ds_read_b64_tr_b16 v[148:149], v226 offset:24576
    v_mfma_f32_16x16x32_bf16 v[116:119], v[156:159], a[20:23], v[116:119]
    ds_read_b64_tr_b16 v[150:151], v226 offset:28672
    v_mfma_f32_16x16x32_bf16 v[120:123], v[152:155], a[8:11], 0
    v_mfma_f32_16x16x32_bf16 v[120:123], v[156:159], a[24:27], v[120:123]
    s_add_u32 m0, s54, 49152
    v_mfma_f32_16x16x32_bf16 v[124:127], v[152:155], a[12:15], 0
    buffer_load_dwordx4 v232, s[20:23], 0 offen offset:0 lds
    v_mfma_f32_16x16x32_bf16 v[124:127], v[156:159], a[28:31], v[124:127]
    s_waitcnt lgkmcnt(8)
    v_add_u32 v232, 65536, v232
    v_mfma_f32_16x16x32_bf16 v[0:3], v[128:131], a[32:35], v[0:3]
    ds_read_b64_tr_b16 v[152:153], v227 offset:16384
    v_mfma_f32_16x16x32_bf16 v[0:3], v[132:135], a[48:51], v[0:3]
    ds_read_b64_tr_b16 v[154:155], v227 offset:20480
    v_mfma_f32_16x16x32_bf16 v[4:7], v[128:131], a[36:39], v[4:7]
    ds_read_b64_tr_b16 v[156:157], v227 offset:24576
    v_mfma_f32_16x16x32_bf16 v[4:7], v[132:135], a[52:55], v[4:7]
    ds_read_b64_tr_b16 v[158:159], v227 offset:28672
    buffer_load_dwordx4 a[160:163], v234, s[12:15], 0 offen offset:2048 sc1
    v_mfma_f32_16x16x32_bf16 v[8:11], v[128:131], a[40:43], v[8:11]
    v_mfma_f32_16x16x32_bf16 v[8:11], v[132:135], a[56:59], v[8:11]
    v_mfma_f32_16x16x32_bf16 v[12:15], v[128:131], a[44:47], v[12:15]
    v_mfma_f32_16x16x32_bf16 v[12:15], v[132:135], a[60:63], v[12:15]
    s_waitcnt lgkmcnt(8)
    v_mfma_f32_16x16x32_bf16 v[16:19], v[136:139], a[32:35], v[16:19]
    ds_read_b64_tr_b16 v[128:129], v228 offset:16384
    buffer_load_dwordx4 a[164:167], v235, s[12:15], 0 offen offset:2048 sc1
    v_mfma_f32_16x16x32_bf16 v[16:19], v[140:143], a[48:51], v[16:19]
    ds_read_b64_tr_b16 v[130:131], v228 offset:20480
    v_mfma_f32_16x16x32_bf16 v[20:23], v[136:139], a[36:39], v[20:23]
    ds_read_b64_tr_b16 v[132:133], v228 offset:24576
    v_mfma_f32_16x16x32_bf16 v[20:23], v[140:143], a[52:55], v[20:23]
    ds_read_b64_tr_b16 v[134:135], v228 offset:28672
    v_mfma_f32_16x16x32_bf16 v[24:27], v[136:139], a[40:43], v[24:27]
    v_mfma_f32_16x16x32_bf16 v[24:27], v[140:143], a[56:59], v[24:27]
    buffer_load_dwordx4 v233, s[20:23], 0 offen offset:1024 lds
    v_mfma_f32_16x16x32_bf16 v[28:31], v[136:139], a[44:47], v[28:31]
    v_add_u32 v233, 65536, v233
    v_mfma_f32_16x16x32_bf16 v[28:31], v[140:143], a[60:63], v[28:31]
    s_waitcnt lgkmcnt(8)
    v_mfma_f32_16x16x32_bf16 v[32:35], v[144:147], a[32:35], v[32:35]
    ds_read_b64_tr_b16 v[136:137], v229 offset:16384
    v_mfma_f32_16x16x32_bf16 v[32:35], v[148:151], a[48:51], v[32:35]
    ds_read_b64_tr_b16 v[138:139], v229 offset:20480
    v_mfma_f32_16x16x32_bf16 v[36:39], v[144:147], a[36:39], v[36:39]
    ds_read_b64_tr_b16 v[140:141], v229 offset:24576
    buffer_load_dwordx4 a[168:171], v236, s[12:15], 0 offen offset:2048 sc1
    v_mfma_f32_16x16x32_bf16 v[36:39], v[148:151], a[52:55], v[36:39]
    ds_read_b64_tr_b16 v[142:143], v229 offset:28672
    v_mfma_f32_16x16x32_bf16 v[40:43], v[144:147], a[40:43], v[40:43]
    v_mfma_f32_16x16x32_bf16 v[40:43], v[148:151], a[56:59], v[40:43]
    v_mfma_f32_16x16x32_bf16 v[44:47], v[144:147], a[44:47], v[44:47]
    v_mfma_f32_16x16x32_bf16 v[44:47], v[148:151], a[60:63], v[44:47]
    s_waitcnt lgkmcnt(8)
    buffer_load_dwordx4 a[172:175], v237, s[12:15], 0 offen offset:2048 sc1
    v_mfma_f32_16x16x32_bf16 v[48:51], v[152:155], a[32:35], v[48:51]
    ds_read_b64_tr_b16 v[144:145], v230 offset:16384
    v_mfma_f32_16x16x32_bf16 v[48:51], v[156:159], a[48:51], v[48:51]
    ds_read_b64_tr_b16 v[146:147], v230 offset:20480
    v_mfma_f32_16x16x32_bf16 v[52:55], v[152:155], a[36:39], v[52:55]
    ds_read_b64_tr_b16 v[148:149], v230 offset:24576
    v_mfma_f32_16x16x32_bf16 v[52:55], v[156:159], a[52:55], v[52:55]
    ds_read_b64_tr_b16 v[150:151], v230 offset:28672
    s_add_u32 m0, s54, 57344
    v_mfma_f32_16x16x32_bf16 v[56:59], v[152:155], a[40:43], v[56:59]
    buffer_load_dwordx4 v232, s[20:23], 0 offen offset:0 lds
    v_mfma_f32_16x16x32_bf16 v[56:59], v[156:159], a[56:59], v[56:59]
    v_add_u32 v232, 65536, v232
    v_mfma_f32_16x16x32_bf16 v[60:63], v[152:155], a[44:47], v[60:63]
    v_mfma_f32_16x16x32_bf16 v[60:63], v[156:159], a[60:63], v[60:63]
    s_waitcnt lgkmcnt(8)
    v_mfma_f32_16x16x32_bf16 v[64:67], v[128:131], a[32:35], v[64:67]
    ds_read_b64_tr_b16 v[152:153], v231 offset:16384
    v_mfma_f32_16x16x32_bf16 v[64:67], v[132:135], a[48:51], v[64:67]
    ds_read_b64_tr_b16 v[154:155], v231 offset:20480
    buffer_load_dwordx4 a[176:179], v234, s[12:15], 0 offen offset:3072 sc1
    v_mfma_f32_16x16x32_bf16 v[68:71], v[128:131], a[36:39], v[68:71]
    ds_read_b64_tr_b16 v[156:157], v231 offset:24576
    v_add_u32 v234, 4096, v234
    v_mfma_f32_16x16x32_bf16 v[68:71], v[132:135], a[52:55], v[68:71]
    ds_read_b64_tr_b16 v[158:159], v231 offset:28672
    v_mfma_f32_16x16x32_bf16 v[72:75], v[128:131], a[40:43], v[72:75]
    s_waitcnt vmcnt(20)
    buffer_atomic_add v253, v252, s[16:19], s72 offen sc1
    v_mfma_f32_16x16x32_bf16 v[72:75], v[132:135], a[56:59], v[72:75]
    v_mfma_f32_16x16x32_bf16 v[76:79], v[128:131], a[44:47], v[76:79]
    buffer_load_dwordx4 a[180:183], v235, s[12:15], 0 offen offset:3072 sc1
    v_mfma_f32_16x16x32_bf16 v[76:79], v[132:135], a[60:63], v[76:79]
    s_waitcnt lgkmcnt(8)
    v_add_u32 v235, 4096, v235
    v_mfma_f32_16x16x32_bf16 v[80:83], v[136:139], a[32:35], v[80:83]
    s_waitcnt vmcnt(26)
    s_barrier
    ds_read_b64_tr_b16 v[128:129], v168 offset:0
    v_mfma_f32_16x16x32_bf16 v[80:83], v[140:143], a[48:51], v[80:83]
    ds_read_b64_tr_b16 v[130:131], v168 offset:4096
    v_mfma_f32_16x16x32_bf16 v[84:87], v[136:139], a[36:39], v[84:87]
    ds_read_b64_tr_b16 v[132:133], v168 offset:8192
    buffer_load_dwordx4 v233, s[20:23], 0 offen offset:1024 lds
    v_mfma_f32_16x16x32_bf16 v[84:87], v[140:143], a[52:55], v[84:87]
    ds_read_b64_tr_b16 v[134:135], v168 offset:12288
    v_add_u32 v233, 65536, v233
    v_mfma_f32_16x16x32_bf16 v[88:91], v[136:139], a[40:43], v[88:91]
    v_mfma_f32_16x16x32_bf16 v[88:91], v[140:143], a[56:59], v[88:91]
    v_mfma_f32_16x16x32_bf16 v[92:95], v[136:139], a[44:47], v[92:95]
    v_mfma_f32_16x16x32_bf16 v[92:95], v[140:143], a[60:63], v[92:95]
    s_waitcnt lgkmcnt(8)
    buffer_load_dwordx4 a[184:187], v236, s[12:15], 0 offen offset:3072 sc1
    v_mfma_f32_16x16x32_bf16 v[96:99], v[144:147], a[32:35], v[96:99]
    ds_read_b64_tr_b16 v[136:137], v169 offset:0
    v_add_u32 v236, 4096, v236
    v_mfma_f32_16x16x32_bf16 v[96:99], v[148:151], a[48:51], v[96:99]
    ds_read_b64_tr_b16 v[138:139], v169 offset:4096
    v_mfma_f32_16x16x32_bf16 v[100:103], v[144:147], a[36:39], v[100:103]
    ds_read_b64_tr_b16 v[140:141], v169 offset:8192
    v_mfma_f32_16x16x32_bf16 v[100:103], v[148:151], a[52:55], v[100:103]
    ds_read_b64_tr_b16 v[142:143], v169 offset:12288
    v_mfma_f32_16x16x32_bf16 v[104:107], v[144:147], a[40:43], v[104:107]
    buffer_load_dwordx4 a[188:191], v237, s[12:15], 0 offen offset:3072 sc1
    v_mfma_f32_16x16x32_bf16 v[104:107], v[148:151], a[56:59], v[104:107]
    v_add_u32 v237, 4096, v237
    v_mfma_f32_16x16x32_bf16 v[108:111], v[144:147], a[44:47], v[108:111]
    v_mfma_f32_16x16x32_bf16 v[108:111], v[148:151], a[60:63], v[108:111]
    s_waitcnt lgkmcnt(8)
    v_mfma_f32_16x16x32_bf16 v[112:115], v[152:155], a[32:35], v[112:115]
    ds_read_b64_tr_b16 v[144:145], v170 offset:0
    s_add_u32 m0, s54, 65536
    v_mfma_f32_16x16x32_bf16 v[112:115], v[156:159], a[48:51], v[112:115]
    ds_read_b64_tr_b16 v[146:147], v170 offset:4096
    buffer_load_dwordx4 v232, s[20:23], 0 offen offset:0 lds
    v_mfma_f32_16x16x32_bf16 v[116:119], v[152:155], a[36:39], v[116:119]
    ds_read_b64_tr_b16 v[148:149], v170 offset:8192
    v_add_u32 v232, 65536, v232
    v_mfma_f32_16x16x32_bf16 v[116:119], v[156:159], a[52:55], v[116:119]
    ds_read_b64_tr_b16 v[150:151], v170 offset:12288
    v_mfma_f32_16x16x32_bf16 v[120:123], v[152:155], a[40:43], v[120:123]
    v_mfma_f32_16x16x32_bf16 v[120:123], v[156:159], a[56:59], v[120:123]
    v_mfma_f32_16x16x32_bf16 v[124:127], v[152:155], a[44:47], v[124:127]
    buffer_load_dwordx4 a[0:3], v234, s[12:15], 0 offen offset:0 sc1
    v_mfma_f32_16x16x32_bf16 v[124:127], v[156:159], a[60:63], v[124:127]
    s_waitcnt lgkmcnt(8)
    v_mfma_f32_16x16x32_bf16 v[0:3], v[128:131], a[64:67], v[0:3]
    ds_read_b64_tr_b16 v[152:153], v171 offset:0
    v_mfma_f32_16x16x32_bf16 v[0:3], v[132:135], a[80:83], v[0:3]
    ds_read_b64_tr_b16 v[154:155], v171 offset:4096
    v_mfma_f32_16x16x32_bf16 v[4:7], v[128:131], a[68:71], v[4:7]
    ds_read_b64_tr_b16 v[156:157], v171 offset:8192
    v_mfma_f32_16x16x32_bf16 v[4:7], v[132:135], a[84:87], v[4:7]
    ds_read_b64_tr_b16 v[158:159], v171 offset:12288
    buffer_load_dwordx4 a[4:7], v235, s[12:15], 0 offen offset:0 sc1
    v_mfma_f32_16x16x32_bf16 v[8:11], v[128:131], a[72:75], v[8:11]
    v_mfma_f32_16x16x32_bf16 v[8:11], v[132:135], a[88:91], v[8:11]
    v_mfma_f32_16x16x32_bf16 v[12:15], v[128:131], a[76:79], v[12:15]
    v_mfma_f32_16x16x32_bf16 v[12:15], v[132:135], a[92:95], v[12:15]
    s_waitcnt lgkmcnt(8)
    v_mfma_f32_16x16x32_bf16 v[16:19], v[136:139], a[64:67], v[16:19]
    ds_read_b64_tr_b16 v[128:129], v172 offset:0
    buffer_load_dwordx4 v233, s[20:23], 0 offen offset:1024 lds
    v_mfma_f32_16x16x32_bf16 v[16:19], v[140:143], a[80:83], v[16:19]
    ds_read_b64_tr_b16 v[130:131], v172 offset:4096
    v_add_u32 v233, 65536, v233
    v_mfma_f32_16x16x32_bf16 v[20:23], v[136:139], a[68:71], v[20:23]
    ds_read_b64_tr_b16 v[132:133], v172 offset:8192
    v_mfma_f32_16x16x32_bf16 v[20:23], v[140:143], a[84:87], v[20:23]
    ds_read_b64_tr_b16 v[134:135], v172 offset:12288
    v_mfma_f32_16x16x32_bf16 v[24:27], v[136:139], a[72:75], v[24:27]
    v_mfma_f32_16x16x32_bf16 v[24:27], v[140:143], a[88:91], v[24:27]
    buffer_load_dwordx4 a[8:11], v236, s[12:15], 0 offen offset:0 sc1
    v_mfma_f32_16x16x32_bf16 v[28:31], v[136:139], a[76:79], v[28:31]
    v_mfma_f32_16x16x32_bf16 v[28:31], v[140:143], a[92:95], v[28:31]
    s_waitcnt lgkmcnt(8)
    v_mfma_f32_16x16x32_bf16 v[32:35], v[144:147], a[64:67], v[32:35]
    ds_read_b64_tr_b16 v[136:137], v173 offset:0
    v_mfma_f32_16x16x32_bf16 v[32:35], v[148:151], a[80:83], v[32:35]
    ds_read_b64_tr_b16 v[138:139], v173 offset:4096
    v_mfma_f32_16x16x32_bf16 v[36:39], v[144:147], a[68:71], v[36:39]
    ds_read_b64_tr_b16 v[140:141], v173 offset:8192
    buffer_load_dwordx4 a[12:15], v237, s[12:15], 0 offen offset:0 sc1
    v_mfma_f32_16x16x32_bf16 v[36:39], v[148:151], a[84:87], v[36:39]
    ds_read_b64_tr_b16 v[142:143], v173 offset:12288
    v_mfma_f32_16x16x32_bf16 v[40:43], v[144:147], a[72:75], v[40:43]
    v_mfma_f32_16x16x32_bf16 v[40:43], v[148:151], a[88:91], v[40:43]
    v_mfma_f32_16x16x32_bf16 v[44:47], v[144:147], a[76:79], v[44:47]
    s_add_u32 m0, s54, 73728
    v_mfma_f32_16x16x32_bf16 v[44:47], v[148:151], a[92:95], v[44:47]
    s_waitcnt lgkmcnt(8)
    buffer_load_dwordx4 v232, s[20:23], 0 offen offset:0 lds
    v_mfma_f32_16x16x32_bf16 v[48:51], v[152:155], a[64:67], v[48:51]
    ds_read_b64_tr_b16 v[144:145], v174 offset:0
    v_add_u32 v232, 65536, v232
    v_mfma_f32_16x16x32_bf16 v[48:51], v[156:159], a[80:83], v[48:51]
    ds_read_b64_tr_b16 v[146:147], v174 offset:4096
    v_mfma_f32_16x16x32_bf16 v[52:55], v[152:155], a[68:71], v[52:55]
    ds_read_b64_tr_b16 v[148:149], v174 offset:8192
    v_mfma_f32_16x16x32_bf16 v[52:55], v[156:159], a[84:87], v[52:55]
    ds_read_b64_tr_b16 v[150:151], v174 offset:12288
    buffer_load_dwordx4 a[16:19], v234, s[12:15], 0 offen offset:1024 sc1
    v_mfma_f32_16x16x32_bf16 v[56:59], v[152:155], a[72:75], v[56:59]
    v_mfma_f32_16x16x32_bf16 v[56:59], v[156:159], a[88:91], v[56:59]
    v_mfma_f32_16x16x32_bf16 v[60:63], v[152:155], a[76:79], v[60:63]
    v_mfma_f32_16x16x32_bf16 v[60:63], v[156:159], a[92:95], v[60:63]
    s_waitcnt lgkmcnt(8)
    v_mfma_f32_16x16x32_bf16 v[64:67], v[128:131], a[64:67], v[64:67]
    ds_read_b64_tr_b16 v[152:153], v175 offset:0
    buffer_load_dwordx4 a[20:23], v235, s[12:15], 0 offen offset:1024 sc1
    v_mfma_f32_16x16x32_bf16 v[64:67], v[132:135], a[80:83], v[64:67]
    ds_read_b64_tr_b16 v[154:155], v175 offset:4096
    v_mfma_f32_16x16x32_bf16 v[68:71], v[128:131], a[68:71], v[68:71]
    ds_read_b64_tr_b16 v[156:157], v175 offset:8192
    v_mfma_f32_16x16x32_bf16 v[68:71], v[132:135], a[84:87], v[68:71]
    ds_read_b64_tr_b16 v[158:159], v175 offset:12288
    v_mfma_f32_16x16x32_bf16 v[72:75], v[128:131], a[72:75], v[72:75]
    v_mfma_f32_16x16x32_bf16 v[72:75], v[132:135], a[88:91], v[72:75]
    buffer_load_dwordx4 v233, s[20:23], 0 offen offset:1024 lds
    v_mfma_f32_16x16x32_bf16 v[76:79], v[128:131], a[76:79], v[76:79]
    v_add_u32 v233, 65536, v233
    v_mfma_f32_16x16x32_bf16 v[76:79], v[132:135], a[92:95], v[76:79]
    s_waitcnt lgkmcnt(8)
    v_mfma_f32_16x16x32_bf16 v[80:83], v[136:139], a[64:67], v[80:83]
    ds_read_b64_tr_b16 v[128:129], v168 offset:16384
    v_mfma_f32_16x16x32_bf16 v[80:83], v[140:143], a[80:83], v[80:83]
    ds_read_b64_tr_b16 v[130:131], v168 offset:20480
    v_mfma_f32_16x16x32_bf16 v[84:87], v[136:139], a[68:71], v[84:87]
    ds_read_b64_tr_b16 v[132:133], v168 offset:24576
    buffer_load_dwordx4 a[24:27], v236, s[12:15], 0 offen offset:1024 sc1
    v_mfma_f32_16x16x32_bf16 v[84:87], v[140:143], a[84:87], v[84:87]
    ds_read_b64_tr_b16 v[134:135], v168 offset:28672
    v_mfma_f32_16x16x32_bf16 v[88:91], v[136:139], a[72:75], v[88:91]
    v_mfma_f32_16x16x32_bf16 v[88:91], v[140:143], a[88:91], v[88:91]
    v_mfma_f32_16x16x32_bf16 v[92:95], v[136:139], a[76:79], v[92:95]
    v_mfma_f32_16x16x32_bf16 v[92:95], v[140:143], a[92:95], v[92:95]
    s_waitcnt lgkmcnt(8)
    buffer_load_dwordx4 a[28:31], v237, s[12:15], 0 offen offset:1024 sc1
    v_mfma_f32_16x16x32_bf16 v[96:99], v[144:147], a[64:67], v[96:99]
    ds_read_b64_tr_b16 v[136:137], v169 offset:16384
    v_mfma_f32_16x16x32_bf16 v[96:99], v[148:151], a[80:83], v[96:99]
    ds_read_b64_tr_b16 v[138:139], v169 offset:20480
    v_mfma_f32_16x16x32_bf16 v[100:103], v[144:147], a[68:71], v[100:103]
    ds_read_b64_tr_b16 v[140:141], v169 offset:24576
    v_mfma_f32_16x16x32_bf16 v[100:103], v[148:151], a[84:87], v[100:103]
    ds_read_b64_tr_b16 v[142:143], v169 offset:28672
    s_add_u32 m0, s54, 81920
    v_mfma_f32_16x16x32_bf16 v[104:107], v[144:147], a[72:75], v[104:107]
    buffer_load_dwordx4 v232, s[20:23], 0 offen offset:0 lds
    v_mfma_f32_16x16x32_bf16 v[104:107], v[148:151], a[88:91], v[104:107]
    v_add_u32 v232, 65536, v232
    v_mfma_f32_16x16x32_bf16 v[108:111], v[144:147], a[76:79], v[108:111]
    v_mfma_f32_16x16x32_bf16 v[108:111], v[148:151], a[92:95], v[108:111]
    s_waitcnt lgkmcnt(8)
    v_mfma_f32_16x16x32_bf16 v[112:115], v[152:155], a[64:67], v[112:115]
    ds_read_b64_tr_b16 v[144:145], v170 offset:16384
    v_mfma_f32_16x16x32_bf16 v[112:115], v[156:159], a[80:83], v[112:115]
    ds_read_b64_tr_b16 v[146:147], v170 offset:20480
    buffer_load_dwordx4 a[32:35], v234, s[12:15], 0 offen offset:2048 sc1
    v_mfma_f32_16x16x32_bf16 v[116:119], v[152:155], a[68:71], v[116:119]
    ds_read_b64_tr_b16 v[148:149], v170 offset:24576
    v_mfma_f32_16x16x32_bf16 v[116:119], v[156:159], a[84:87], v[116:119]
    ds_read_b64_tr_b16 v[150:151], v170 offset:28672
    v_mfma_f32_16x16x32_bf16 v[120:123], v[152:155], a[72:75], v[120:123]
    v_mfma_f32_16x16x32_bf16 v[120:123], v[156:159], a[88:91], v[120:123]
    v_mfma_f32_16x16x32_bf16 v[124:127], v[152:155], a[76:79], v[124:127]
    buffer_load_dwordx4 a[36:39], v235, s[12:15], 0 offen offset:2048 sc1
    v_mfma_f32_16x16x32_bf16 v[124:127], v[156:159], a[92:95], v[124:127]
    s_waitcnt lgkmcnt(8)
    v_mfma_f32_16x16x32_bf16 v[0:3], v[128:131], a[96:99], v[0:3]
    ds_read_b64_tr_b16 v[152:153], v171 offset:16384
    v_mfma_f32_16x16x32_bf16 v[0:3], v[132:135], a[112:115], v[0:3]
    ds_read_b64_tr_b16 v[154:155], v171 offset:20480
    v_mfma_f32_16x16x32_bf16 v[4:7], v[128:131], a[100:103], v[4:7]
    ds_read_b64_tr_b16 v[156:157], v171 offset:24576
    v_mfma_f32_16x16x32_bf16 v[4:7], v[132:135], a[116:119], v[4:7]
    ds_read_b64_tr_b16 v[158:159], v171 offset:28672
    buffer_load_dwordx4 v233, s[20:23], 0 offen offset:1024 lds
    v_mfma_f32_16x16x32_bf16 v[8:11], v[128:131], a[104:107], v[8:11]
    v_add_u32 v233, 65536, v233
    v_mfma_f32_16x16x32_bf16 v[8:11], v[132:135], a[120:123], v[8:11]
    v_mfma_f32_16x16x32_bf16 v[12:15], v[128:131], a[108:111], v[12:15]
    v_mfma_f32_16x16x32_bf16 v[12:15], v[132:135], a[124:127], v[12:15]
    s_waitcnt lgkmcnt(8)
    v_mfma_f32_16x16x32_bf16 v[16:19], v[136:139], a[96:99], v[16:19]
    ds_read_b64_tr_b16 v[128:129], v172 offset:16384
    buffer_load_dwordx4 a[40:43], v236, s[12:15], 0 offen offset:2048 sc1
    v_mfma_f32_16x16x32_bf16 v[16:19], v[140:143], a[112:115], v[16:19]
    ds_read_b64_tr_b16 v[130:131], v172 offset:20480
    v_mfma_f32_16x16x32_bf16 v[20:23], v[136:139], a[100:103], v[20:23]
    ds_read_b64_tr_b16 v[132:133], v172 offset:24576
    v_mfma_f32_16x16x32_bf16 v[20:23], v[140:143], a[116:119], v[20:23]
    ds_read_b64_tr_b16 v[134:135], v172 offset:28672
    v_mfma_f32_16x16x32_bf16 v[24:27], v[136:139], a[104:107], v[24:27]
    buffer_load_dwordx4 a[44:47], v237, s[12:15], 0 offen offset:2048 sc1
    v_mfma_f32_16x16x32_bf16 v[24:27], v[140:143], a[120:123], v[24:27]
    v_mfma_f32_16x16x32_bf16 v[28:31], v[136:139], a[108:111], v[28:31]
    v_mfma_f32_16x16x32_bf16 v[28:31], v[140:143], a[124:127], v[28:31]
    s_waitcnt lgkmcnt(8)
    v_mfma_f32_16x16x32_bf16 v[32:35], v[144:147], a[96:99], v[32:35]
    ds_read_b64_tr_b16 v[136:137], v173 offset:16384
    s_add_u32 m0, s54, 90112
    v_mfma_f32_16x16x32_bf16 v[32:35], v[148:151], a[112:115], v[32:35]
    ds_read_b64_tr_b16 v[138:139], v173 offset:20480
    buffer_load_dwordx4 v232, s[20:23], 0 offen offset:0 lds
    v_mfma_f32_16x16x32_bf16 v[36:39], v[144:147], a[100:103], v[36:39]
    ds_read_b64_tr_b16 v[140:141], v173 offset:24576
    v_add_u32 v232, 65536, v232
    v_mfma_f32_16x16x32_bf16 v[36:39], v[148:151], a[116:119], v[36:39]
    ds_read_b64_tr_b16 v[142:143], v173 offset:28672
    v_mfma_f32_16x16x32_bf16 v[40:43], v[144:147], a[104:107], v[40:43]
    v_mfma_f32_16x16x32_bf16 v[40:43], v[148:151], a[120:123], v[40:43]
    v_mfma_f32_16x16x32_bf16 v[44:47], v[144:147], a[108:111], v[44:47]
    buffer_load_dwordx4 a[48:51], v234, s[12:15], 0 offen offset:3072 sc1
    v_mfma_f32_16x16x32_bf16 v[44:47], v[148:151], a[124:127], v[44:47]
    s_waitcnt lgkmcnt(8)
    v_add_u32 v234, 4096, v234
    v_mfma_f32_16x16x32_bf16 v[48:51], v[152:155], a[96:99], v[48:51]
    ds_read_b64_tr_b16 v[144:145], v174 offset:16384
    v_mfma_f32_16x16x32_bf16 v[48:51], v[156:159], a[112:115], v[48:51]
    ds_read_b64_tr_b16 v[146:147], v174 offset:20480
    v_mfma_f32_16x16x32_bf16 v[52:55], v[152:155], a[100:103], v[52:55]
    ds_read_b64_tr_b16 v[148:149], v174 offset:24576
    v_mfma_f32_16x16x32_bf16 v[52:55], v[156:159], a[116:119], v[52:55]
    ds_read_b64_tr_b16 v[150:151], v174 offset:28672
    buffer_load_dwordx4 a[52:55], v235, s[12:15], 0 offen offset:3072 sc1
    v_mfma_f32_16x16x32_bf16 v[56:59], v[152:155], a[104:107], v[56:59]
    v_add_u32 v235, 4096, v235
    v_mfma_f32_16x16x32_bf16 v[56:59], v[156:159], a[120:123], v[56:59]
    v_mfma_f32_16x16x32_bf16 v[60:63], v[152:155], a[108:111], v[60:63]
    v_mfma_f32_16x16x32_bf16 v[60:63], v[156:159], a[124:127], v[60:63]
    s_waitcnt lgkmcnt(8)
    v_mfma_f32_16x16x32_bf16 v[64:67], v[128:131], a[96:99], v[64:67]
    ds_read_b64_tr_b16 v[152:153], v175 offset:16384
    buffer_load_dwordx4 v233, s[20:23], 0 offen offset:1024 lds
    v_mfma_f32_16x16x32_bf16 v[64:67], v[132:135], a[112:115], v[64:67]
    ds_read_b64_tr_b16 v[154:155], v175 offset:20480
    v_add_u32 v233, 65536, v233
    v_mfma_f32_16x16x32_bf16 v[68:71], v[128:131], a[100:103], v[68:71]
    ds_read_b64_tr_b16 v[156:157], v175 offset:24576
    v_mfma_f32_16x16x32_bf16 v[68:71], v[132:135], a[116:119], v[68:71]
    ds_read_b64_tr_b16 v[158:159], v175 offset:28672
    v_mfma_f32_16x16x32_bf16 v[72:75], v[128:131], a[104:107], v[72:75]
    v_mfma_f32_16x16x32_bf16 v[72:75], v[132:135], a[120:123], v[72:75]
    buffer_load_dwordx4 a[56:59], v236, s[12:15], 0 offen offset:3072 sc1
    v_mfma_f32_16x16x32_bf16 v[76:79], v[128:131], a[108:111], v[76:79]
    v_add_u32 v236, 4096, v236
    v_mfma_f32_16x16x32_bf16 v[76:79], v[132:135], a[124:127], v[76:79]
    s_waitcnt lgkmcnt(8)
    v_mfma_f32_16x16x32_bf16 v[80:83], v[136:139], a[96:99], v[80:83]
    s_waitcnt vmcnt(23)
    s_barrier
    ds_read_b64_tr_b16 v[128:129], v224 offset:32768
    v_mfma_f32_16x16x32_bf16 v[80:83], v[140:143], a[112:115], v[80:83]
    ds_read_b64_tr_b16 v[130:131], v224 offset:36864
    v_mfma_f32_16x16x32_bf16 v[84:87], v[136:139], a[100:103], v[84:87]
    ds_read_b64_tr_b16 v[132:133], v224 offset:40960
    buffer_load_dwordx4 a[60:63], v237, s[12:15], 0 offen offset:3072 sc1
    v_mfma_f32_16x16x32_bf16 v[84:87], v[140:143], a[116:119], v[84:87]
    ds_read_b64_tr_b16 v[134:135], v224 offset:45056
    v_add_u32 v237, 4096, v237
    v_mfma_f32_16x16x32_bf16 v[88:91], v[136:139], a[104:107], v[88:91]
    v_mfma_f32_16x16x32_bf16 v[88:91], v[140:143], a[120:123], v[88:91]
    v_mfma_f32_16x16x32_bf16 v[92:95], v[136:139], a[108:111], v[92:95]
    s_add_u32 m0, s54, 98304
    v_mfma_f32_16x16x32_bf16 v[92:95], v[140:143], a[124:127], v[92:95]
    s_waitcnt lgkmcnt(8)
    buffer_load_dwordx4 v232, s[20:23], 0 offen offset:0 lds
    v_mfma_f32_16x16x32_bf16 v[96:99], v[144:147], a[96:99], v[96:99]
    ds_read_b64_tr_b16 v[136:137], v225 offset:32768
    v_add_u32 v232, 65536, v232
    v_mfma_f32_16x16x32_bf16 v[96:99], v[148:151], a[112:115], v[96:99]
    ds_read_b64_tr_b16 v[138:139], v225 offset:36864
    v_mfma_f32_16x16x32_bf16 v[100:103], v[144:147], a[100:103], v[100:103]
    ds_read_b64_tr_b16 v[140:141], v225 offset:40960
    v_mfma_f32_16x16x32_bf16 v[100:103], v[148:151], a[116:119], v[100:103]
    ds_read_b64_tr_b16 v[142:143], v225 offset:45056
    v_mfma_f32_16x16x32_bf16 v[104:107], v[144:147], a[104:107], v[104:107]
    buffer_load_dwordx4 a[64:67], v234, s[12:15], 0 offen offset:0 sc1
    v_mfma_f32_16x16x32_bf16 v[104:107], v[148:151], a[120:123], v[104:107]
    v_mfma_f32_16x16x32_bf16 v[108:111], v[144:147], a[108:111], v[108:111]
    v_mfma_f32_16x16x32_bf16 v[108:111], v[148:151], a[124:127], v[108:111]
    s_waitcnt lgkmcnt(8)
    v_mfma_f32_16x16x32_bf16 v[112:115], v[152:155], a[96:99], v[112:115]
    ds_read_b64_tr_b16 v[144:145], v226 offset:32768
    v_mfma_f32_16x16x32_bf16 v[112:115], v[156:159], a[112:115], v[112:115]
    ds_read_b64_tr_b16 v[146:147], v226 offset:36864
    buffer_load_dwordx4 a[68:71], v235, s[12:15], 0 offen offset:0 sc1
    v_mfma_f32_16x16x32_bf16 v[116:119], v[152:155], a[100:103], v[116:119]
    ds_read_b64_tr_b16 v[148:149], v226 offset:40960
    v_mfma_f32_16x16x32_bf16 v[116:119], v[156:159], a[116:119], v[116:119]
    ds_read_b64_tr_b16 v[150:151], v226 offset:45056
    v_mfma_f32_16x16x32_bf16 v[120:123], v[152:155], a[104:107], v[120:123]
    v_mfma_f32_16x16x32_bf16 v[120:123], v[156:159], a[120:123], v[120:123]
    buffer_load_dwordx4 v233, s[20:23], 0 offen offset:1024 lds
    v_mfma_f32_16x16x32_bf16 v[124:127], v[152:155], a[108:111], v[124:127]
    v_add_u32 v233, 65536, v233
    v_mfma_f32_16x16x32_bf16 v[124:127], v[156:159], a[124:127], v[124:127]
    s_waitcnt lgkmcnt(8)
    v_mfma_f32_16x16x32_bf16 v[0:3], v[128:131], a[128:131], v[0:3]
    ds_read_b64_tr_b16 v[152:153], v227 offset:32768
    v_mfma_f32_16x16x32_bf16 v[0:3], v[132:135], a[144:147], v[0:3]
    ds_read_b64_tr_b16 v[154:155], v227 offset:36864
    v_mfma_f32_16x16x32_bf16 v[4:7], v[128:131], a[132:135], v[4:7]
    ds_read_b64_tr_b16 v[156:157], v227 offset:40960
    buffer_load_dwordx4 a[72:75], v236, s[12:15], 0 offen offset:0 sc1
    v_mfma_f32_16x16x32_bf16 v[4:7], v[132:135], a[148:151], v[4:7]
    ds_read_b64_tr_b16 v[158:159], v227 offset:45056
    v_mfma_f32_16x16x32_bf16 v[8:11], v[128:131], a[136:139], v[8:11]
    v_mfma_f32_16x16x32_bf16 v[8:11], v[132:135], a[152:155], v[8:11]
    v_mfma_f32_16x16x32_bf16 v[12:15], v[128:131], a[140:143], v[12:15]
    v_mfma_f32_16x16x32_bf16 v[12:15], v[132:135], a[156:159], v[12:15]
    s_waitcnt lgkmcnt(8)
    buffer_load_dwordx4 a[76:79], v237, s[12:15], 0 offen offset:0 sc1
    v_mfma_f32_16x16x32_bf16 v[16:19], v[136:139], a[128:131], v[16:19]
    ds_read_b64_tr_b16 v[128:129], v228 offset:32768
    v_mfma_f32_16x16x32_bf16 v[16:19], v[140:143], a[144:147], v[16:19]
    ds_read_b64_tr_b16 v[130:131], v228 offset:36864
    v_mfma_f32_16x16x32_bf16 v[20:23], v[136:139], a[132:135], v[20:23]
    ds_read_b64_tr_b16 v[132:133], v228 offset:40960
    v_mfma_f32_16x16x32_bf16 v[20:23], v[140:143], a[148:151], v[20:23]
    ds_read_b64_tr_b16 v[134:135], v228 offset:45056
    s_add_u32 m0, s54, 106496
    v_mfma_f32_16x16x32_bf16 v[24:27], v[136:139], a[136:139], v[24:27]
    buffer_load_dwordx4 v232, s[20:23], 0 offen offset:0 lds
    v_mfma_f32_16x16x32_bf16 v[24:27], v[140:143], a[152:155], v[24:27]
    v_add_u32 v232, 65536, v232
    v_mfma_f32_16x16x32_bf16 v[28:31], v[136:139], a[140:143], v[28:31]
    v_mfma_f32_16x16x32_bf16 v[28:31], v[140:143], a[156:159], v[28:31]
    s_waitcnt lgkmcnt(8)
    v_mfma_f32_16x16x32_bf16 v[32:35], v[144:147], a[128:131], v[32:35]
    ds_read_b64_tr_b16 v[136:137], v229 offset:32768
    v_mfma_f32_16x16x32_bf16 v[32:35], v[148:151], a[144:147], v[32:35]
    ds_read_b64_tr_b16 v[138:139], v229 offset:36864
    buffer_load_dwordx4 a[80:83], v234, s[12:15], 0 offen offset:1024 sc1
    v_mfma_f32_16x16x32_bf16 v[36:39], v[144:147], a[132:135], v[36:39]
    ds_read_b64_tr_b16 v[140:141], v229 offset:40960
    v_mfma_f32_16x16x32_bf16 v[36:39], v[148:151], a[148:151], v[36:39]
    ds_read_b64_tr_b16 v[142:143], v229 offset:45056
    v_mfma_f32_16x16x32_bf16 v[40:43], v[144:147], a[136:139], v[40:43]
    v_mfma_f32_16x16x32_bf16 v[40:43], v[148:151], a[152:155], v[40:43]
    v_mfma_f32_16x16x32_bf16 v[44:47], v[144:147], a[140:143], v[44:47]
    buffer_load_dwordx4 a[84:87], v235, s[12:15], 0 offen offset:1024 sc1
    v_mfma_f32_16x16x32_bf16 v[44:47], v[148:151], a[156:159], v[44:47]
    s_waitcnt lgkmcnt(8)
    v_mfma_f32_16x16x32_bf16 v[48:51], v[152:155], a[128:131], v[48:51]
    ds_read_b64_tr_b16 v[144:145], v230 offset:32768
    v_mfma_f32_16x16x32_bf16 v[48:51], v[156:159], a[144:147], v[48:51]
    ds_read_b64_tr_b16 v[146:147], v230 offset:36864
    v_mfma_f32_16x16x32_bf16 v[52:55], v[152:155], a[132:135], v[52:55]
    ds_read_b64_tr_b16 v[148:149], v230 offset:40960
    v_mfma_f32_16x16x32_bf16 v[52:55], v[156:159], a[148:151], v[52:55]
    ds_read_b64_tr_b16 v[150:151], v230 offset:45056
    buffer_load_dwordx4 v233, s[20:23], 0 offen offset:1024 lds
    v_mfma_f32_16x16x32_bf16 v[56:59], v[152:155], a[136:139], v[56:59]
    v_add_u32 v233, 65536, v233
    v_mfma_f32_16x16x32_bf16 v[56:59], v[156:159], a[152:155], v[56:59]
    v_mfma_f32_16x16x32_bf16 v[60:63], v[152:155], a[140:143], v[60:63]
    v_mfma_f32_16x16x32_bf16 v[60:63], v[156:159], a[156:159], v[60:63]
    s_waitcnt lgkmcnt(8)
    v_mfma_f32_16x16x32_bf16 v[64:67], v[128:131], a[128:131], v[64:67]
    ds_read_b64_tr_b16 v[152:153], v231 offset:32768
    buffer_load_dwordx4 a[88:91], v236, s[12:15], 0 offen offset:1024 sc1
    v_mfma_f32_16x16x32_bf16 v[64:67], v[132:135], a[144:147], v[64:67]
    ds_read_b64_tr_b16 v[154:155], v231 offset:36864
    v_mfma_f32_16x16x32_bf16 v[68:71], v[128:131], a[132:135], v[68:71]
    ds_read_b64_tr_b16 v[156:157], v231 offset:40960
    v_mfma_f32_16x16x32_bf16 v[68:71], v[132:135], a[148:151], v[68:71]
    ds_read_b64_tr_b16 v[158:159], v231 offset:45056
    v_mfma_f32_16x16x32_bf16 v[72:75], v[128:131], a[136:139], v[72:75]
    v_mfma_f32_16x16x32_bf16 v[72:75], v[132:135], a[152:155], v[72:75]
    buffer_load_dwordx4 a[92:95], v237, s[12:15], 0 offen offset:1024 sc1
    v_mfma_f32_16x16x32_bf16 v[76:79], v[128:131], a[140:143], v[76:79]
    v_mfma_f32_16x16x32_bf16 v[76:79], v[132:135], a[156:159], v[76:79]
    s_waitcnt lgkmcnt(8)
    v_mfma_f32_16x16x32_bf16 v[80:83], v[136:139], a[128:131], v[80:83]
    ds_read_b64_tr_b16 v[128:129], v224 offset:49152
    v_mfma_f32_16x16x32_bf16 v[80:83], v[140:143], a[144:147], v[80:83]
    ds_read_b64_tr_b16 v[130:131], v224 offset:53248
    s_add_u32 m0, s54, 114688
    v_mfma_f32_16x16x32_bf16 v[84:87], v[136:139], a[132:135], v[84:87]
    ds_read_b64_tr_b16 v[132:133], v224 offset:57344
    buffer_load_dwordx4 v232, s[20:23], 0 offen offset:0 lds
    v_mfma_f32_16x16x32_bf16 v[84:87], v[140:143], a[148:151], v[84:87]
    ds_read_b64_tr_b16 v[134:135], v224 offset:61440
    v_add_u32 v232, 65536, v232
    v_mfma_f32_16x16x32_bf16 v[88:91], v[136:139], a[136:139], v[88:91]
    v_mfma_f32_16x16x32_bf16 v[88:91], v[140:143], a[152:155], v[88:91]
    v_mfma_f32_16x16x32_bf16 v[92:95], v[136:139], a[140:143], v[92:95]
    buffer_load_dwordx4 a[96:99], v234, s[12:15], 0 offen offset:2048 sc1
    v_mfma_f32_16x16x32_bf16 v[92:95], v[140:143], a[156:159], v[92:95]
    s_waitcnt lgkmcnt(8)
    v_mfma_f32_16x16x32_bf16 v[96:99], v[144:147], a[128:131], v[96:99]
    ds_read_b64_tr_b16 v[136:137], v225 offset:49152
    v_mfma_f32_16x16x32_bf16 v[96:99], v[148:151], a[144:147], v[96:99]
    ds_read_b64_tr_b16 v[138:139], v225 offset:53248
    v_mfma_f32_16x16x32_bf16 v[100:103], v[144:147], a[132:135], v[100:103]
    ds_read_b64_tr_b16 v[140:141], v225 offset:57344
    v_mfma_f32_16x16x32_bf16 v[100:103], v[148:151], a[148:151], v[100:103]
    ds_read_b64_tr_b16 v[142:143], v225 offset:61440
    buffer_load_dwordx4 a[100:103], v235, s[12:15], 0 offen offset:2048 sc1
    v_mfma_f32_16x16x32_bf16 v[104:107], v[144:147], a[136:139], v[104:107]
    v_mfma_f32_16x16x32_bf16 v[104:107], v[148:151], a[152:155], v[104:107]
    v_mfma_f32_16x16x32_bf16 v[108:111], v[144:147], a[140:143], v[108:111]
    v_mfma_f32_16x16x32_bf16 v[108:111], v[148:151], a[156:159], v[108:111]
    s_waitcnt lgkmcnt(8)
    v_mfma_f32_16x16x32_bf16 v[112:115], v[152:155], a[128:131], v[112:115]
    ds_read_b64_tr_b16 v[144:145], v226 offset:49152
    buffer_load_dwordx4 v233, s[20:23], 0 offen offset:1024 lds
    v_mfma_f32_16x16x32_bf16 v[112:115], v[156:159], a[144:147], v[112:115]
    ds_read_b64_tr_b16 v[146:147], v226 offset:53248
    v_add_u32 v233, 65536, v233
    v_mfma_f32_16x16x32_bf16 v[116:119], v[152:155], a[132:135], v[116:119]
    ds_read_b64_tr_b16 v[148:149], v226 offset:57344
    v_mfma_f32_16x16x32_bf16 v[116:119], v[156:159], a[148:151], v[116:119]
    ds_read_b64_tr_b16 v[150:151], v226 offset:61440
    v_mfma_f32_16x16x32_bf16 v[120:123], v[152:155], a[136:139], v[120:123]
    v_mfma_f32_16x16x32_bf16 v[120:123], v[156:159], a[152:155], v[120:123]
    buffer_load_dwordx4 a[104:107], v236, s[12:15], 0 offen offset:2048 sc1
    v_mfma_f32_16x16x32_bf16 v[124:127], v[152:155], a[140:143], v[124:127]
    v_mfma_f32_16x16x32_bf16 v[124:127], v[156:159], a[156:159], v[124:127]
    s_waitcnt lgkmcnt(8)
    v_mfma_f32_16x16x32_bf16 v[0:3], v[128:131], a[160:163], v[0:3]
    ds_read_b64_tr_b16 v[152:153], v227 offset:49152
    v_mfma_f32_16x16x32_bf16 v[0:3], v[132:135], a[176:179], v[0:3]
    ds_read_b64_tr_b16 v[154:155], v227 offset:53248
    v_mfma_f32_16x16x32_bf16 v[4:7], v[128:131], a[164:167], v[4:7]
    ds_read_b64_tr_b16 v[156:157], v227 offset:57344
    buffer_load_dwordx4 a[108:111], v237, s[12:15], 0 offen offset:2048 sc1
    v_mfma_f32_16x16x32_bf16 v[4:7], v[132:135], a[180:183], v[4:7]
    ds_read_b64_tr_b16 v[158:159], v227 offset:61440
    v_mfma_f32_16x16x32_bf16 v[8:11], v[128:131], a[168:171], v[8:11]
    v_mfma_f32_16x16x32_bf16 v[8:11], v[132:135], a[184:187], v[8:11]
    v_mfma_f32_16x16x32_bf16 v[12:15], v[128:131], a[172:175], v[12:15]
    s_add_u32 m0, s54, 122880
    v_mfma_f32_16x16x32_bf16 v[12:15], v[132:135], a[188:191], v[12:15]
    s_waitcnt lgkmcnt(8)
    buffer_load_dwordx4 v232, s[20:23], 0 offen offset:0 lds
    v_mfma_f32_16x16x32_bf16 v[16:19], v[136:139], a[160:163], v[16:19]
    ds_read_b64_tr_b16 v[128:129], v228 offset:49152
    v_add_u32 v232, 65536, v232
    v_mfma_f32_16x16x32_bf16 v[16:19], v[140:143], a[176:179], v[16:19]
    ds_read_b64_tr_b16 v[130:131], v228 offset:53248
    v_mfma_f32_16x16x32_bf16 v[20:23], v[136:139], a[164:167], v[20:23]
    ds_read_b64_tr_b16 v[132:133], v228 offset:57344
    v_mfma_f32_16x16x32_bf16 v[20:23], v[140:143], a[180:183], v[20:23]
    ds_read_b64_tr_b16 v[134:135], v228 offset:61440
    v_mfma_f32_16x16x32_bf16 v[24:27], v[136:139], a[168:171], v[24:27]
    buffer_load_dwordx4 a[112:115], v234, s[12:15], 0 offen offset:3072 sc1
    v_mfma_f32_16x16x32_bf16 v[24:27], v[140:143], a[184:187], v[24:27]
    v_add_u32 v234, 4096, v234
    v_mfma_f32_16x16x32_bf16 v[28:31], v[136:139], a[172:175], v[28:31]
    v_mfma_f32_16x16x32_bf16 v[28:31], v[140:143], a[188:191], v[28:31]
    s_waitcnt lgkmcnt(8)
    v_mfma_f32_16x16x32_bf16 v[32:35], v[144:147], a[160:163], v[32:35]
    ds_read_b64_tr_b16 v[136:137], v229 offset:49152
    v_mfma_f32_16x16x32_bf16 v[32:35], v[148:151], a[176:179], v[32:35]
    ds_read_b64_tr_b16 v[138:139], v229 offset:53248
    buffer_load_dwordx4 a[116:119], v235, s[12:15], 0 offen offset:3072 sc1
    v_mfma_f32_16x16x32_bf16 v[36:39], v[144:147], a[164:167], v[36:39]
    ds_read_b64_tr_b16 v[140:141], v229 offset:57344
    v_add_u32 v235, 4096, v235
    v_mfma_f32_16x16x32_bf16 v[36:39], v[148:151], a[180:183], v[36:39]
    ds_read_b64_tr_b16 v[142:143], v229 offset:61440
    v_mfma_f32_16x16x32_bf16 v[40:43], v[144:147], a[168:171], v[40:43]
    v_mfma_f32_16x16x32_bf16 v[40:43], v[148:151], a[184:187], v[40:43]
    v_mfma_f32_16x16x32_bf16 v[44:47], v[144:147], a[172:175], v[44:47]
    buffer_load_dwordx4 v233, s[20:23], 0 offen offset:1024 lds
    v_mfma_f32_16x16x32_bf16 v[44:47], v[148:151], a[188:191], v[44:47]
    s_waitcnt lgkmcnt(8)
    v_add_u32 v233, 65536, v233
    v_mfma_f32_16x16x32_bf16 v[48:51], v[152:155], a[160:163], v[48:51]
    ds_read_b64_tr_b16 v[144:145], v230 offset:49152
    v_mfma_f32_16x16x32_bf16 v[48:51], v[156:159], a[176:179], v[48:51]
    ds_read_b64_tr_b16 v[146:147], v230 offset:53248
    v_mfma_f32_16x16x32_bf16 v[52:55], v[152:155], a[164:167], v[52:55]
    ds_read_b64_tr_b16 v[148:149], v230 offset:57344
    v_mfma_f32_16x16x32_bf16 v[52:55], v[156:159], a[180:183], v[52:55]
    ds_read_b64_tr_b16 v[150:151], v230 offset:61440
    buffer_load_dwordx4 a[120:123], v236, s[12:15], 0 offen offset:3072 sc1
    v_mfma_f32_16x16x32_bf16 v[56:59], v[152:155], a[168:171], v[56:59]
    v_add_u32 v236, 4096, v236
    v_mfma_f32_16x16x32_bf16 v[56:59], v[156:159], a[184:187], v[56:59]
    v_mfma_f32_16x16x32_bf16 v[60:63], v[152:155], a[172:175], v[60:63]
    v_mfma_f32_16x16x32_bf16 v[60:63], v[156:159], a[188:191], v[60:63]
    s_waitcnt lgkmcnt(8)
    buffer_load_dwordx4 a[124:127], v237, s[12:15], 0 offen offset:3072 sc1
    v_mfma_f32_16x16x32_bf16 v[64:67], v[128:131], a[160:163], v[64:67]
    ds_read_b64_tr_b16 v[152:153], v231 offset:49152
    v_add_u32 v237, 4096, v237
    v_mfma_f32_16x16x32_bf16 v[64:67], v[132:135], a[176:179], v[64:67]
    ds_read_b64_tr_b16 v[154:155], v231 offset:53248
    v_mfma_f32_16x16x32_bf16 v[68:71], v[128:131], a[164:167], v[68:71]
    ds_read_b64_tr_b16 v[156:157], v231 offset:57344
    v_mfma_f32_16x16x32_bf16 v[68:71], v[132:135], a[180:183], v[68:71]
    ds_read_b64_tr_b16 v[158:159], v231 offset:61440
    s_add_u32 m0, s54, 0
    v_mfma_f32_16x16x32_bf16 v[72:75], v[128:131], a[168:171], v[72:75]
    buffer_load_dwordx4 v232, s[20:23], 0 offen offset:0 lds
    v_mfma_f32_16x16x32_bf16 v[72:75], v[132:135], a[184:187], v[72:75]
    v_add_u32 v232, 65536, v232
    v_mfma_f32_16x16x32_bf16 v[76:79], v[128:131], a[172:175], v[76:79]
    v_mfma_f32_16x16x32_bf16 v[76:79], v[132:135], a[188:191], v[76:79]
    s_waitcnt lgkmcnt(8)
    v_mfma_f32_16x16x32_bf16 v[80:83], v[136:139], a[160:163], v[80:83]
    s_waitcnt vmcnt(25)
    s_barrier
    ds_read_b64_tr_b16 v[128:129], v160 offset:0
    v_mfma_f32_16x16x32_bf16 v[80:83], v[140:143], a[176:179], v[80:83]
    ds_read_b64_tr_b16 v[130:131], v160 offset:4096
    buffer_load_dwordx4 a[128:131], v234, s[12:15], 0 offen offset:0 sc1
    v_mfma_f32_16x16x32_bf16 v[84:87], v[136:139], a[164:167], v[84:87]
    ds_read_b64_tr_b16 v[132:133], v160 offset:8192
    v_mfma_f32_16x16x32_bf16 v[84:87], v[140:143], a[180:183], v[84:87]
    ds_read_b64_tr_b16 v[134:135], v160 offset:12288
    v_mfma_f32_16x16x32_bf16 v[88:91], v[136:139], a[168:171], v[88:91]
    v_mfma_f32_16x16x32_bf16 v[88:91], v[140:143], a[184:187], v[88:91]
    v_mfma_f32_16x16x32_bf16 v[92:95], v[136:139], a[172:175], v[92:95]
    buffer_load_dwordx4 a[132:135], v235, s[12:15], 0 offen offset:0 sc1
    v_mfma_f32_16x16x32_bf16 v[92:95], v[140:143], a[188:191], v[92:95]
    s_waitcnt lgkmcnt(8)
    v_mfma_f32_16x16x32_bf16 v[96:99], v[144:147], a[160:163], v[96:99]
    ds_read_b64_tr_b16 v[136:137], v161 offset:0
    v_mfma_f32_16x16x32_bf16 v[96:99], v[148:151], a[176:179], v[96:99]
    ds_read_b64_tr_b16 v[138:139], v161 offset:4096
    v_mfma_f32_16x16x32_bf16 v[100:103], v[144:147], a[164:167], v[100:103]
    ds_read_b64_tr_b16 v[140:141], v161 offset:8192
    v_mfma_f32_16x16x32_bf16 v[100:103], v[148:151], a[180:183], v[100:103]
    ds_read_b64_tr_b16 v[142:143], v161 offset:12288
    buffer_load_dwordx4 v233, s[20:23], 0 offen offset:1024 lds
    v_mfma_f32_16x16x32_bf16 v[104:107], v[144:147], a[168:171], v[104:107]
    v_add_u32 v233, 65536, v233
    v_mfma_f32_16x16x32_bf16 v[104:107], v[148:151], a[184:187], v[104:107]
    v_mfma_f32_16x16x32_bf16 v[108:111], v[144:147], a[172:175], v[108:111]
    v_mfma_f32_16x16x32_bf16 v[108:111], v[148:151], a[188:191], v[108:111]
    s_waitcnt lgkmcnt(8)
    v_mfma_f32_16x16x32_bf16 v[112:115], v[152:155], a[160:163], v[112:115]
    ds_read_b64_tr_b16 v[144:145], v162 offset:0
    buffer_load_dwordx4 a[136:139], v236, s[12:15], 0 offen offset:0 sc1
    v_mfma_f32_16x16x32_bf16 v[112:115], v[156:159], a[176:179], v[112:115]
    ds_read_b64_tr_b16 v[146:147], v162 offset:4096
    v_mfma_f32_16x16x32_bf16 v[116:119], v[152:155], a[164:167], v[116:119]
    ds_read_b64_tr_b16 v[148:149], v162 offset:8192
    v_mfma_f32_16x16x32_bf16 v[116:119], v[156:159], a[180:183], v[116:119]
    ds_read_b64_tr_b16 v[150:151], v162 offset:12288
    v_mfma_f32_16x16x32_bf16 v[120:123], v[152:155], a[168:171], v[120:123]
    v_mfma_f32_16x16x32_bf16 v[120:123], v[156:159], a[184:187], v[120:123]
    buffer_load_dwordx4 a[140:143], v237, s[12:15], 0 offen offset:0 sc1
    v_mfma_f32_16x16x32_bf16 v[124:127], v[152:155], a[172:175], v[124:127]
    v_mfma_f32_16x16x32_bf16 v[124:127], v[156:159], a[188:191], v[124:127]
    s_waitcnt lgkmcnt(8)
    v_mfma_f32_16x16x32_bf16 v[0:3], v[128:131], a[0:3], v[0:3]
    ds_read_b64_tr_b16 v[152:153], v163 offset:0
    v_mfma_f32_16x16x32_bf16 v[0:3], v[132:135], a[16:19], v[0:3]
    ds_read_b64_tr_b16 v[154:155], v163 offset:4096
    s_add_u32 m0, s54, 8192
    v_mfma_f32_16x16x32_bf16 v[4:7], v[128:131], a[4:7], v[4:7]
    ds_read_b64_tr_b16 v[156:157], v163 offset:8192
    buffer_load_dwordx4 v232, s[20:23], 0 offen offset:0 lds
    v_mfma_f32_16x16x32_bf16 v[4:7], v[132:135], a[20:23], v[4:7]
    ds_read_b64_tr_b16 v[158:159], v163 offset:12288
    v_add_u32 v232, 65536, v232
    v_mfma_f32_16x16x32_bf16 v[8:11], v[128:131], a[8:11], v[8:11]
    v_mfma_f32_16x16x32_bf16 v[8:11], v[132:135], a[24:27], v[8:11]
    v_mfma_f32_16x16x32_bf16 v[12:15], v[128:131], a[12:15], v[12:15]
    v_mfma_f32_16x16x32_bf16 v[12:15], v[132:135], a[28:31], v[12:15]
    s_waitcnt lgkmcnt(8)
    buffer_load_dwordx4 a[144:147], v234, s[12:15], 0 offen offset:1024 sc1
    v_mfma_f32_16x16x32_bf16 v[16:19], v[136:139], a[0:3], v[16:19]
    ds_read_b64_tr_b16 v[128:129], v164 offset:0
    v_mfma_f32_16x16x32_bf16 v[16:19], v[140:143], a[16:19], v[16:19]
    ds_read_b64_tr_b16 v[130:131], v164 offset:4096
    v_mfma_f32_16x16x32_bf16 v[20:23], v[136:139], a[4:7], v[20:23]
    ds_read_b64_tr_b16 v[132:133], v164 offset:8192
    v_mfma_f32_16x16x32_bf16 v[20:23], v[140:143], a[20:23], v[20:23]
    ds_read_b64_tr_b16 v[134:135], v164 offset:12288
    v_mfma_f32_16x16x32_bf16 v[24:27], v[136:139], a[8:11], v[24:27]
    buffer_load_dwordx4 a[148:151], v235, s[12:15], 0 offen offset:1024 sc1
    v_mfma_f32_16x16x32_bf16 v[24:27], v[140:143], a[24:27], v[24:27]
    v_mfma_f32_16x16x32_bf16 v[28:31], v[136:139], a[12:15], v[28:31]
    v_mfma_f32_16x16x32_bf16 v[28:31], v[140:143], a[28:31], v[28:31]
    s_waitcnt lgkmcnt(8)
    v_mfma_f32_16x16x32_bf16 v[32:35], v[144:147], a[0:3], v[32:35]
    ds_read_b64_tr_b16 v[136:137], v165 offset:0
    buffer_load_dwordx4 v233, s[20:23], 0 offen offset:1024 lds
    v_mfma_f32_16x16x32_bf16 v[32:35], v[148:151], a[16:19], v[32:35]
    ds_read_b64_tr_b16 v[138:139], v165 offset:4096
    v_add_u32 v233, 65536, v233
    v_mfma_f32_16x16x32_bf16 v[36:39], v[144:147], a[4:7], v[36:39]
    ds_read_b64_tr_b16 v[140:141], v165 offset:8192
    v_mfma_f32_16x16x32_bf16 v[36:39], v[148:151], a[20:23], v[36:39]
    ds_read_b64_tr_b16 v[142:143], v165 offset:12288
    v_mfma_f32_16x16x32_bf16 v[40:43], v[144:147], a[8:11], v[40:43]
    v_mfma_f32_16x16x32_bf16 v[40:43], v[148:151], a[24:27], v[40:43]
    buffer_load_dwordx4 a[152:155], v236, s[12:15], 0 offen offset:1024 sc1
    v_mfma_f32_16x16x32_bf16 v[44:47], v[144:147], a[12:15], v[44:47]
    v_mfma_f32_16x16x32_bf16 v[44:47], v[148:151], a[28:31], v[44:47]
    s_waitcnt lgkmcnt(8)
    v_mfma_f32_16x16x32_bf16 v[48:51], v[152:155], a[0:3], v[48:51]
    ds_read_b64_tr_b16 v[144:145], v166 offset:0
    v_mfma_f32_16x16x32_bf16 v[48:51], v[156:159], a[16:19], v[48:51]
    ds_read_b64_tr_b16 v[146:147], v166 offset:4096
    v_mfma_f32_16x16x32_bf16 v[52:55], v[152:155], a[4:7], v[52:55]
    ds_read_b64_tr_b16 v[148:149], v166 offset:8192
    buffer_load_dwordx4 a[156:159], v237, s[12:15], 0 offen offset:1024 sc1
    v_mfma_f32_16x16x32_bf16 v[52:55], v[156:159], a[20:23], v[52:55]
    ds_read_b64_tr_b16 v[150:151], v166 offset:12288
    v_mfma_f32_16x16x32_bf16 v[56:59], v[152:155], a[8:11], v[56:59]
    v_mfma_f32_16x16x32_bf16 v[56:59], v[156:159], a[24:27], v[56:59]
    v_mfma_f32_16x16x32_bf16 v[60:63], v[152:155], a[12:15], v[60:63]
    s_add_u32 m0, s54, 16384
    v_mfma_f32_16x16x32_bf16 v[60:63], v[156:159], a[28:31], v[60:63]
    s_waitcnt lgkmcnt(8)
    buffer_load_dwordx4 v232, s[20:23], 0 offen offset:0 lds
    v_mfma_f32_16x16x32_bf16 v[64:67], v[128:131], a[0:3], v[64:67]
    ds_read_b64_tr_b16 v[152:153], v167 offset:0
    v_add_u32 v232, 65536, v232
    v_mfma_f32_16x16x32_bf16 v[64:67], v[132:135], a[16:19], v[64:67]
    ds_read_b64_tr_b16 v[154:155], v167 offset:4096
    v_mfma_f32_16x16x32_bf16 v[68:71], v[128:131], a[4:7], v[68:71]
    ds_read_b64_tr_b16 v[156:157], v167 offset:8192
    v_mfma_f32_16x16x32_bf16 v[68:71], v[132:135], a[20:23], v[68:71]
    ds_read_b64_tr_b16 v[158:159], v167 offset:12288
    v_mfma_f32_16x16x32_bf16 v[72:75], v[128:131], a[8:11], v[72:75]
    buffer_load_dwordx4 a[160:163], v234, s[12:15], 0 offen offset:2048 sc1
    v_mfma_f32_16x16x32_bf16 v[72:75], v[132:135], a[24:27], v[72:75]
    v_mfma_f32_16x16x32_bf16 v[76:79], v[128:131], a[12:15], v[76:79]
    v_mfma_f32_16x16x32_bf16 v[76:79], v[132:135], a[28:31], v[76:79]
    s_waitcnt lgkmcnt(8)
    v_mfma_f32_16x16x32_bf16 v[80:83], v[136:139], a[0:3], v[80:83]
    ds_read_b64_tr_b16 v[128:129], v160 offset:16384
    v_mfma_f32_16x16x32_bf16 v[80:83], v[140:143], a[16:19], v[80:83]
    ds_read_b64_tr_b16 v[130:131], v160 offset:20480
    buffer_load_dwordx4 a[164:167], v235, s[12:15], 0 offen offset:2048 sc1
    v_mfma_f32_16x16x32_bf16 v[84:87], v[136:139], a[4:7], v[84:87]
    ds_read_b64_tr_b16 v[132:133], v160 offset:24576
    v_mfma_f32_16x16x32_bf16 v[84:87], v[140:143], a[20:23], v[84:87]
    ds_read_b64_tr_b16 v[134:135], v160 offset:28672
    v_mfma_f32_16x16x32_bf16 v[88:91], v[136:139], a[8:11], v[88:91]
    v_mfma_f32_16x16x32_bf16 v[88:91], v[140:143], a[24:27], v[88:91]
    v_mfma_f32_16x16x32_bf16 v[92:95], v[136:139], a[12:15], v[92:95]
    buffer_load_dwordx4 v233, s[20:23], 0 offen offset:1024 lds
    v_mfma_f32_16x16x32_bf16 v[92:95], v[140:143], a[28:31], v[92:95]
    s_waitcnt lgkmcnt(8)
    v_add_u32 v233, 65536, v233
    v_mfma_f32_16x16x32_bf16 v[96:99], v[144:147], a[0:3], v[96:99]
    ds_read_b64_tr_b16 v[136:137], v161 offset:16384
    v_mfma_f32_16x16x32_bf16 v[96:99], v[148:151], a[16:19], v[96:99]
    ds_read_b64_tr_b16 v[138:139], v161 offset:20480
    v_mfma_f32_16x16x32_bf16 v[100:103], v[144:147], a[4:7], v[100:103]
    ds_read_b64_tr_b16 v[140:141], v161 offset:24576
    v_mfma_f32_16x16x32_bf16 v[100:103], v[148:151], a[20:23], v[100:103]
    ds_read_b64_tr_b16 v[142:143], v161 offset:28672
    buffer_load_dwordx4 a[168:171], v236, s[12:15], 0 offen offset:2048 sc1
    v_mfma_f32_16x16x32_bf16 v[104:107], v[144:147], a[8:11], v[104:107]
    v_mfma_f32_16x16x32_bf16 v[104:107], v[148:151], a[24:27], v[104:107]
    v_mfma_f32_16x16x32_bf16 v[108:111], v[144:147], a[12:15], v[108:111]
    v_mfma_f32_16x16x32_bf16 v[108:111], v[148:151], a[28:31], v[108:111]
    s_waitcnt lgkmcnt(8)
    v_mfma_f32_16x16x32_bf16 v[112:115], v[152:155], a[0:3], v[112:115]
    ds_read_b64_tr_b16 v[144:145], v162 offset:16384
    buffer_load_dwordx4 a[172:175], v237, s[12:15], 0 offen offset:2048 sc1
    v_mfma_f32_16x16x32_bf16 v[112:115], v[156:159], a[16:19], v[112:115]
    ds_read_b64_tr_b16 v[146:147], v162 offset:20480
    v_mfma_f32_16x16x32_bf16 v[116:119], v[152:155], a[4:7], v[116:119]
    ds_read_b64_tr_b16 v[148:149], v162 offset:24576
    v_mfma_f32_16x16x32_bf16 v[116:119], v[156:159], a[20:23], v[116:119]
    ds_read_b64_tr_b16 v[150:151], v162 offset:28672
    v_mfma_f32_16x16x32_bf16 v[120:123], v[152:155], a[8:11], v[120:123]
    s_add_u32 m0, s54, 24576
    v_mfma_f32_16x16x32_bf16 v[120:123], v[156:159], a[24:27], v[120:123]
    buffer_load_dwordx4 v232, s[20:23], 0 offen offset:0 lds
    v_mfma_f32_16x16x32_bf16 v[124:127], v[152:155], a[12:15], v[124:127]
    v_add_u32 v232, 65536, v232
    v_mfma_f32_16x16x32_bf16 v[124:127], v[156:159], a[28:31], v[124:127]
    s_waitcnt lgkmcnt(8)
    v_mfma_f32_16x16x32_bf16 v[0:3], v[128:131], a[32:35], v[0:3]
    ds_read_b64_tr_b16 v[152:153], v163 offset:16384
    v_mfma_f32_16x16x32_bf16 v[0:3], v[132:135], a[48:51], v[0:3]
    ds_read_b64_tr_b16 v[154:155], v163 offset:20480
    buffer_load_dwordx4 a[176:179], v234, s[12:15], 0 offen offset:3072 sc1
    v_mfma_f32_16x16x32_bf16 v[4:7], v[128:131], a[36:39], v[4:7]
    ds_read_b64_tr_b16 v[156:157], v163 offset:24576
    v_add_u32 v234, 4096, v234
    v_mfma_f32_16x16x32_bf16 v[4:7], v[132:135], a[52:55], v[4:7]
    ds_read_b64_tr_b16 v[158:159], v163 offset:28672
    v_mfma_f32_16x16x32_bf16 v[8:11], v[128:131], a[40:43], v[8:11]
    v_mfma_f32_16x16x32_bf16 v[8:11], v[132:135], a[56:59], v[8:11]
    v_mfma_f32_16x16x32_bf16 v[12:15], v[128:131], a[44:47], v[12:15]
    buffer_load_dwordx4 a[180:183], v235, s[12:15], 0 offen offset:3072 sc1
    v_mfma_f32_16x16x32_bf16 v[12:15], v[132:135], a[60:63], v[12:15]
    s_waitcnt lgkmcnt(8)
    v_add_u32 v235, 4096, v235
    v_mfma_f32_16x16x32_bf16 v[16:19], v[136:139], a[32:35], v[16:19]
    ds_read_b64_tr_b16 v[128:129], v164 offset:16384
    v_mfma_f32_16x16x32_bf16 v[16:19], v[140:143], a[48:51], v[16:19]
    ds_read_b64_tr_b16 v[130:131], v164 offset:20480
    v_mfma_f32_16x16x32_bf16 v[20:23], v[136:139], a[36:39], v[20:23]
    ds_read_b64_tr_b16 v[132:133], v164 offset:24576
    v_mfma_f32_16x16x32_bf16 v[20:23], v[140:143], a[52:55], v[20:23]
    ds_read_b64_tr_b16 v[134:135], v164 offset:28672
    buffer_load_dwordx4 v233, s[20:23], 0 offen offset:1024 lds
    v_mfma_f32_16x16x32_bf16 v[24:27], v[136:139], a[40:43], v[24:27]
    v_add_u32 v233, 65536, v233
    v_mfma_f32_16x16x32_bf16 v[24:27], v[140:143], a[56:59], v[24:27]
    v_mfma_f32_16x16x32_bf16 v[28:31], v[136:139], a[44:47], v[28:31]
    v_mfma_f32_16x16x32_bf16 v[28:31], v[140:143], a[60:63], v[28:31]
    s_waitcnt lgkmcnt(8)
    v_mfma_f32_16x16x32_bf16 v[32:35], v[144:147], a[32:35], v[32:35]
    ds_read_b64_tr_b16 v[136:137], v165 offset:16384
    buffer_load_dwordx4 a[184:187], v236, s[12:15], 0 offen offset:3072 sc1
    v_mfma_f32_16x16x32_bf16 v[32:35], v[148:151], a[48:51], v[32:35]
    ds_read_b64_tr_b16 v[138:139], v165 offset:20480
    v_add_u32 v236, 4096, v236
    v_mfma_f32_16x16x32_bf16 v[36:39], v[144:147], a[36:39], v[36:39]
    ds_read_b64_tr_b16 v[140:141], v165 offset:24576
    v_mfma_f32_16x16x32_bf16 v[36:39], v[148:151], a[52:55], v[36:39]
    ds_read_b64_tr_b16 v[142:143], v165 offset:28672
    v_mfma_f32_16x16x32_bf16 v[40:43], v[144:147], a[40:43], v[40:43]
    v_mfma_f32_16x16x32_bf16 v[40:43], v[148:151], a[56:59], v[40:43]
    buffer_load_dwordx4 a[188:191], v237, s[12:15], 0 offen offset:3072 sc1
    v_mfma_f32_16x16x32_bf16 v[44:47], v[144:147], a[44:47], v[44:47]
    v_add_u32 v237, 4096, v237
    v_mfma_f32_16x16x32_bf16 v[44:47], v[148:151], a[60:63], v[44:47]
    s_waitcnt lgkmcnt(8)
    v_mfma_f32_16x16x32_bf16 v[48:51], v[152:155], a[32:35], v[48:51]
    ds_read_b64_tr_b16 v[144:145], v166 offset:16384
    v_mfma_f32_16x16x32_bf16 v[48:51], v[156:159], a[48:51], v[48:51]
    ds_read_b64_tr_b16 v[146:147], v166 offset:20480
    s_add_u32 m0, s54, 131072
    v_mfma_f32_16x16x32_bf16 v[52:55], v[152:155], a[36:39], v[52:55]
    ds_read_b64_tr_b16 v[148:149], v166 offset:24576
    buffer_load_dwordx4 v232, s[20:23], 0 offen offset:0 lds
    v_mfma_f32_16x16x32_bf16 v[52:55], v[156:159], a[52:55], v[52:55]
    ds_read_b64_tr_b16 v[150:151], v166 offset:28672
    v_add_u32 v232, 65536, v232
    v_mfma_f32_16x16x32_bf16 v[56:59], v[152:155], a[40:43], v[56:59]
    v_mfma_f32_16x16x32_bf16 v[56:59], v[156:159], a[56:59], v[56:59]
    v_mfma_f32_16x16x32_bf16 v[60:63], v[152:155], a[44:47], v[60:63]
    v_mfma_f32_16x16x32_bf16 v[60:63], v[156:159], a[60:63], v[60:63]
    s_waitcnt lgkmcnt(8)
    buffer_load_dwordx4 a[0:3], v234, s[12:15], 0 offen offset:0 sc1
    v_mfma_f32_16x16x32_bf16 v[64:67], v[128:131], a[32:35], v[64:67]
    ds_read_b64_tr_b16 v[152:153], v167 offset:16384
    v_mfma_f32_16x16x32_bf16 v[64:67], v[132:135], a[48:51], v[64:67]
    ds_read_b64_tr_b16 v[154:155], v167 offset:20480
    v_mfma_f32_16x16x32_bf16 v[68:71], v[128:131], a[36:39], v[68:71]
    ds_read_b64_tr_b16 v[156:157], v167 offset:24576
    v_mfma_f32_16x16x32_bf16 v[68:71], v[132:135], a[52:55], v[68:71]
    ds_read_b64_tr_b16 v[158:159], v167 offset:28672
    v_mfma_f32_16x16x32_bf16 v[72:75], v[128:131], a[40:43], v[72:75]
    buffer_load_dwordx4 a[4:7], v235, s[12:15], 0 offen offset:0 sc1
    v_mfma_f32_16x16x32_bf16 v[72:75], v[132:135], a[56:59], v[72:75]
    v_mfma_f32_16x16x32_bf16 v[76:79], v[128:131], a[44:47], v[76:79]
    v_mfma_f32_16x16x32_bf16 v[76:79], v[132:135], a[60:63], v[76:79]
    s_waitcnt lgkmcnt(8)
    v_mfma_f32_16x16x32_bf16 v[80:83], v[136:139], a[32:35], v[80:83]
    s_waitcnt vmcnt(27)
    s_barrier
    ds_read_b64_tr_b16 v[128:129], v160 offset:32768
    v_mfma_f32_16x16x32_bf16 v[80:83], v[140:143], a[48:51], v[80:83]
    ds_read_b64_tr_b16 v[130:131], v160 offset:36864
    buffer_load_dwordx4 v233, s[20:23], 0 offen offset:1024 lds
    v_mfma_f32_16x16x32_bf16 v[84:87], v[136:139], a[36:39], v[84:87]
    ds_read_b64_tr_b16 v[132:133], v160 offset:40960
    v_add_u32 v233, 65536, v233
    v_mfma_f32_16x16x32_bf16 v[84:87], v[140:143], a[52:55], v[84:87]
    ds_read_b64_tr_b16 v[134:135], v160 offset:45056
    v_mfma_f32_16x16x32_bf16 v[88:91], v[136:139], a[40:43], v[88:91]
    v_mfma_f32_16x16x32_bf16 v[88:91], v[140:143], a[56:59], v[88:91]
    v_mfma_f32_16x16x32_bf16 v[92:95], v[136:139], a[44:47], v[92:95]
    buffer_load_dwordx4 a[8:11], v236, s[12:15], 0 offen offset:0 sc1
    v_mfma_f32_16x16x32_bf16 v[92:95], v[140:143], a[60:63], v[92:95]
    s_waitcnt lgkmcnt(8)
    v_mfma_f32_16x16x32_bf16 v[96:99], v[144:147], a[32:35], v[96:99]
    ds_read_b64_tr_b16 v[136:137], v161 offset:32768
    v_mfma_f32_16x16x32_bf16 v[96:99], v[148:151], a[48:51], v[96:99]
    ds_read_b64_tr_b16 v[138:139], v161 offset:36864
    v_mfma_f32_16x16x32_bf16 v[100:103], v[144:147], a[36:39], v[100:103]
    ds_read_b64_tr_b16 v[140:141], v161 offset:40960
    buffer_load_dwordx4 a[12:15], v237, s[12:15], 0 offen offset:0 sc1
    v_mfma_f32_16x16x32_bf16 v[100:103], v[148:151], a[52:55], v[100:103]
    ds_read_b64_tr_b16 v[142:143], v161 offset:45056
    v_mfma_f32_16x16x32_bf16 v[104:107], v[144:147], a[40:43], v[104:107]
    v_mfma_f32_16x16x32_bf16 v[104:107], v[148:151], a[56:59], v[104:107]
    v_mfma_f32_16x16x32_bf16 v[108:111], v[144:147], a[44:47], v[108:111]
    s_add_u32 m0, s54, 139264
    v_mfma_f32_16x16x32_bf16 v[108:111], v[148:151], a[60:63], v[108:111]
    s_waitcnt lgkmcnt(8)
    buffer_load_dwordx4 v232, s[20:23], 0 offen offset:0 lds
    v_mfma_f32_16x16x32_bf16 v[112:115], v[152:155], a[32:35], v[112:115]
    ds_read_b64_tr_b16 v[144:145], v162 offset:32768
    v_add_u32 v232, 65536, v232
    v_mfma_f32_16x16x32_bf16 v[112:115], v[156:159], a[48:51], v[112:115]
    ds_read_b64_tr_b16 v[146:147], v162 offset:36864
    v_mfma_f32_16x16x32_bf16 v[116:119], v[152:155], a[36:39], v[116:119]
    ds_read_b64_tr_b16 v[148:149], v162 offset:40960
    v_mfma_f32_16x16x32_bf16 v[116:119], v[156:159], a[52:55], v[116:119]
    ds_read_b64_tr_b16 v[150:151], v162 offset:45056
    v_mfma_f32_16x16x32_bf16 v[120:123], v[152:155], a[40:43], v[120:123]
    buffer_load_dwordx4 a[16:19], v234, s[12:15], 0 offen offset:1024 sc1
    v_mfma_f32_16x16x32_bf16 v[120:123], v[156:159], a[56:59], v[120:123]
    v_mfma_f32_16x16x32_bf16 v[124:127], v[152:155], a[44:47], v[124:127]
    v_mfma_f32_16x16x32_bf16 v[124:127], v[156:159], a[60:63], v[124:127]
    s_waitcnt lgkmcnt(8)
    v_mfma_f32_16x16x32_bf16 v[0:3], v[128:131], a[64:67], v[0:3]
    ds_read_b64_tr_b16 v[152:153], v163 offset:32768
    v_mfma_f32_16x16x32_bf16 v[0:3], v[132:135], a[80:83], v[0:3]
    ds_read_b64_tr_b16 v[154:155], v163 offset:36864
    buffer_load_dwordx4 a[20:23], v235, s[12:15], 0 offen offset:1024 sc1
    v_mfma_f32_16x16x32_bf16 v[4:7], v[128:131], a[68:71], v[4:7]
    ds_read_b64_tr_b16 v[156:157], v163 offset:40960
    v_mfma_f32_16x16x32_bf16 v[4:7], v[132:135], a[84:87], v[4:7]
    ds_read_b64_tr_b16 v[158:159], v163 offset:45056
    v_mfma_f32_16x16x32_bf16 v[8:11], v[128:131], a[72:75], v[8:11]
    v_mfma_f32_16x16x32_bf16 v[8:11], v[132:135], a[88:91], v[8:11]
    v_mfma_f32_16x16x32_bf16 v[12:15], v[128:131], a[76:79], v[12:15]
    buffer_load_dwordx4 v233, s[20:23], 0 offen offset:1024 lds
    v_mfma_f32_16x16x32_bf16 v[12:15], v[132:135], a[92:95], v[12:15]
    s_waitcnt lgkmcnt(8)
    v_add_u32 v233, 65536, v233
    v_mfma_f32_16x16x32_bf16 v[16:19], v[136:139], a[64:67], v[16:19]
    ds_read_b64_tr_b16 v[128:129], v164 offset:32768
    v_mfma_f32_16x16x32_bf16 v[16:19], v[140:143], a[80:83], v[16:19]
    ds_read_b64_tr_b16 v[130:131], v164 offset:36864
    v_mfma_f32_16x16x32_bf16 v[20:23], v[136:139], a[68:71], v[20:23]
    ds_read_b64_tr_b16 v[132:133], v164 offset:40960
    buffer_load_dword v251, v252, s[16:19], s72 offen sc1
    v_mfma_f32_16x16x32_bf16 v[20:23], v[140:143], a[84:87], v[20:23]
    ds_read_b64_tr_b16 v[134:135], v164 offset:45056
    buffer_load_dwordx4 a[24:27], v236, s[12:15], 0 offen offset:1024 sc1
    v_mfma_f32_16x16x32_bf16 v[24:27], v[136:139], a[72:75], v[24:27]
    v_mfma_f32_16x16x32_bf16 v[24:27], v[140:143], a[88:91], v[24:27]
    v_mfma_f32_16x16x32_bf16 v[28:31], v[136:139], a[76:79], v[28:31]
    v_mfma_f32_16x16x32_bf16 v[28:31], v[140:143], a[92:95], v[28:31]
    s_waitcnt lgkmcnt(8)
    v_mfma_f32_16x16x32_bf16 v[32:35], v[144:147], a[64:67], v[32:35]
    ds_read_b64_tr_b16 v[136:137], v165 offset:32768
    buffer_load_dwordx4 a[28:31], v237, s[12:15], 0 offen offset:1024 sc1
    v_mfma_f32_16x16x32_bf16 v[32:35], v[148:151], a[80:83], v[32:35]
    ds_read_b64_tr_b16 v[138:139], v165 offset:36864
    v_mfma_f32_16x16x32_bf16 v[36:39], v[144:147], a[68:71], v[36:39]
    ds_read_b64_tr_b16 v[140:141], v165 offset:40960
    v_mfma_f32_16x16x32_bf16 v[36:39], v[148:151], a[84:87], v[36:39]
    ds_read_b64_tr_b16 v[142:143], v165 offset:45056
    v_mfma_f32_16x16x32_bf16 v[40:43], v[144:147], a[72:75], v[40:43]
    s_add_u32 m0, s54, 147456
    v_mfma_f32_16x16x32_bf16 v[40:43], v[148:151], a[88:91], v[40:43]
    buffer_load_dwordx4 v232, s[20:23], 0 offen offset:0 lds
    v_mfma_f32_16x16x32_bf16 v[44:47], v[144:147], a[76:79], v[44:47]
    v_add_u32 v232, 65536, v232
    v_mfma_f32_16x16x32_bf16 v[44:47], v[148:151], a[92:95], v[44:47]
    s_waitcnt lgkmcnt(8)
    v_mfma_f32_16x16x32_bf16 v[48:51], v[152:155], a[64:67], v[48:51]
    ds_read_b64_tr_b16 v[144:145], v166 offset:32768
    v_mfma_f32_16x16x32_bf16 v[48:51], v[156:159], a[80:83], v[48:51]
    ds_read_b64_tr_b16 v[146:147], v166 offset:36864
    v_mfma_f32_16x16x32_bf16 v[52:55], v[152:155], a[68:71], v[52:55]
    ds_read_b64_tr_b16 v[148:149], v166 offset:40960
    buffer_load_dwordx4 a[32:35], v234, s[12:15], 0 offen offset:2048 sc1
    v_mfma_f32_16x16x32_bf16 v[52:55], v[156:159], a[84:87], v[52:55]
    ds_read_b64_tr_b16 v[150:151], v166 offset:45056
    v_mfma_f32_16x16x32_bf16 v[56:59], v[152:155], a[72:75], v[56:59]
    v_mfma_f32_16x16x32_bf16 v[56:59], v[156:159], a[88:91], v[56:59]
    v_mfma_f32_16x16x32_bf16 v[60:63], v[152:155], a[76:79], v[60:63]
    v_mfma_f32_16x16x32_bf16 v[60:63], v[156:159], a[92:95], v[60:63]
    s_waitcnt lgkmcnt(8)
    buffer_load_dwordx4 a[36:39], v235, s[12:15], 0 offen offset:2048 sc1
    v_mfma_f32_16x16x32_bf16 v[64:67], v[128:131], a[64:67], v[64:67]
    ds_read_b64_tr_b16 v[152:153], v167 offset:32768
    v_mfma_f32_16x16x32_bf16 v[64:67], v[132:135], a[80:83], v[64:67]
    ds_read_b64_tr_b16 v[154:155], v167 offset:36864
    v_mfma_f32_16x16x32_bf16 v[68:71], v[128:131], a[68:71], v[68:71]
    ds_read_b64_tr_b16 v[156:157], v167 offset:40960
    v_mfma_f32_16x16x32_bf16 v[68:71], v[132:135], a[84:87], v[68:71]
    ds_read_b64_tr_b16 v[158:159], v167 offset:45056
    buffer_load_dwordx4 v233, s[20:23], 0 offen offset:1024 lds
    v_mfma_f32_16x16x32_bf16 v[72:75], v[128:131], a[72:75], v[72:75]
    v_add_u32 v233, 65536, v233
    v_mfma_f32_16x16x32_bf16 v[72:75], v[132:135], a[88:91], v[72:75]
    v_mfma_f32_16x16x32_bf16 v[76:79], v[128:131], a[76:79], v[76:79]
    v_mfma_f32_16x16x32_bf16 v[76:79], v[132:135], a[92:95], v[76:79]
    s_waitcnt lgkmcnt(8)
    v_mfma_f32_16x16x32_bf16 v[80:83], v[136:139], a[64:67], v[80:83]
    ds_read_b64_tr_b16 v[128:129], v160 offset:49152
    buffer_load_dwordx4 a[40:43], v236, s[12:15], 0 offen offset:2048 sc1
    v_mfma_f32_16x16x32_bf16 v[80:83], v[140:143], a[80:83], v[80:83]
    ds_read_b64_tr_b16 v[130:131], v160 offset:53248
    v_mfma_f32_16x16x32_bf16 v[84:87], v[136:139], a[68:71], v[84:87]
    ds_read_b64_tr_b16 v[132:133], v160 offset:57344
    v_mfma_f32_16x16x32_bf16 v[84:87], v[140:143], a[84:87], v[84:87]
    ds_read_b64_tr_b16 v[134:135], v160 offset:61440
    v_mfma_f32_16x16x32_bf16 v[88:91], v[136:139], a[72:75], v[88:91]
    v_mfma_f32_16x16x32_bf16 v[88:91], v[140:143], a[88:91], v[88:91]
    buffer_load_dwordx4 a[44:47], v237, s[12:15], 0 offen offset:2048 sc1
    v_mfma_f32_16x16x32_bf16 v[92:95], v[136:139], a[76:79], v[92:95]
    v_mfma_f32_16x16x32_bf16 v[92:95], v[140:143], a[92:95], v[92:95]
    s_waitcnt lgkmcnt(8)
    v_mfma_f32_16x16x32_bf16 v[96:99], v[144:147], a[64:67], v[96:99]
    ds_read_b64_tr_b16 v[136:137], v161 offset:49152
    v_mfma_f32_16x16x32_bf16 v[96:99], v[148:151], a[80:83], v[96:99]
    ds_read_b64_tr_b16 v[138:139], v161 offset:53248
    s_add_u32 m0, s54, 155648
    v_mfma_f32_16x16x32_bf16 v[100:103], v[144:147], a[68:71], v[100:103]
    ds_read_b64_tr_b16 v[140:141], v161 offset:57344
    buffer_load_dwordx4 v232, s[20:23], 0 offen offset:0 lds
    v_mfma_f32_16x16x32_bf16 v[100:103], v[148:151], a[84:87], v[100:103]
    ds_read_b64_tr_b16 v[142:143], v161 offset:61440
    v_add_u32 v232, 65536, v232
    v_mfma_f32_16x16x32_bf16 v[104:107], v[144:147], a[72:75], v[104:107]
    v_mfma_f32_16x16x32_bf16 v[104:107], v[148:151], a[88:91], v[104:107]
    v_mfma_f32_16x16x32_bf16 v[108:111], v[144:147], a[76:79], v[108:111]
    v_mfma_f32_16x16x32_bf16 v[108:111], v[148:151], a[92:95], v[108:111]
    s_waitcnt lgkmcnt(8)
    buffer_load_dwordx4 a[48:51], v234, s[12:15], 0 offen offset:3072 sc1
    v_mfma_f32_16x16x32_bf16 v[112:115], v[152:155], a[64:67], v[112:115]
    ds_read_b64_tr_b16 v[144:145], v162 offset:49152
    v_add_u32 v234, 4096, v234
    v_mfma_f32_16x16x32_bf16 v[112:115], v[156:159], a[80:83], v[112:115]
    ds_read_b64_tr_b16 v[146:147], v162 offset:53248
    v_mfma_f32_16x16x32_bf16 v[116:119], v[152:155], a[68:71], v[116:119]
    ds_read_b64_tr_b16 v[148:149], v162 offset:57344
    v_mfma_f32_16x16x32_bf16 v[116:119], v[156:159], a[84:87], v[116:119]
    ds_read_b64_tr_b16 v[150:151], v162 offset:61440
    v_mfma_f32_16x16x32_bf16 v[120:123], v[152:155], a[72:75], v[120:123]
    buffer_load_dwordx4 a[52:55], v235, s[12:15], 0 offen offset:3072 sc1
    v_mfma_f32_16x16x32_bf16 v[120:123], v[156:159], a[88:91], v[120:123]
    v_add_u32 v235, 4096, v235
    v_mfma_f32_16x16x32_bf16 v[124:127], v[152:155], a[76:79], v[124:127]
    v_mfma_f32_16x16x32_bf16 v[124:127], v[156:159], a[92:95], v[124:127]
    s_waitcnt lgkmcnt(8)
    v_mfma_f32_16x16x32_bf16 v[0:3], v[128:131], a[96:99], v[0:3]
    ds_read_b64_tr_b16 v[152:153], v163 offset:49152
    v_mfma_f32_16x16x32_bf16 v[0:3], v[132:135], a[112:115], v[0:3]
    ds_read_b64_tr_b16 v[154:155], v163 offset:53248
    buffer_load_dwordx4 v233, s[20:23], 0 offen offset:1024 lds
    v_mfma_f32_16x16x32_bf16 v[4:7], v[128:131], a[100:103], v[4:7]
    ds_read_b64_tr_b16 v[156:157], v163 offset:57344
    v_add_u32 v233, 65536, v233
    v_mfma_f32_16x16x32_bf16 v[4:7], v[132:135], a[116:119], v[4:7]
    ds_read_b64_tr_b16 v[158:159], v163 offset:61440
    v_mfma_f32_16x16x32_bf16 v[8:11], v[128:131], a[104:107], v[8:11]
    v_mfma_f32_16x16x32_bf16 v[8:11], v[132:135], a[120:123], v[8:11]
    v_mfma_f32_16x16x32_bf16 v[12:15], v[128:131], a[108:111], v[12:15]
    buffer_load_dwordx4 a[56:59], v236, s[12:15], 0 offen offset:3072 sc1
    v_mfma_f32_16x16x32_bf16 v[12:15], v[132:135], a[124:127], v[12:15]
    s_waitcnt lgkmcnt(8)
    v_add_u32 v236, 4096, v236
    v_mfma_f32_16x16x32_bf16 v[16:19], v[136:139], a[96:99], v[16:19]
    ds_read_b64_tr_b16 v[128:129], v164 offset:49152
    v_mfma_f32_16x16x32_bf16 v[16:19], v[140:143], a[112:115], v[16:19]
    ds_read_b64_tr_b16 v[130:131], v164 offset:53248
    v_mfma_f32_16x16x32_bf16 v[20:23], v[136:139], a[100:103], v[20:23]
    ds_read_b64_tr_b16 v[132:133], v164 offset:57344
    v_mfma_f32_16x16x32_bf16 v[20:23], v[140:143], a[116:119], v[20:23]
    ds_read_b64_tr_b16 v[134:135], v164 offset:61440
    buffer_load_dwordx4 a[60:63], v237, s[12:15], 0 offen offset:3072 sc1
    v_mfma_f32_16x16x32_bf16 v[24:27], v[136:139], a[104:107], v[24:27]
    s_waitcnt vmcnt(14)
    v_add_u32 v237, 4096, v237
    v_readfirstlane_b32 s62, v251
    s_nop 0
    s_cmp_ge_u32 s62, 128
    s_cbranch_scc0 oready_spin
oready_ok:
    v_mfma_f32_16x16x32_bf16 v[24:27], v[140:143], a[120:123], v[24:27]
    s_mov_b32 s20, s44
    v_add_u32 v232, s63, v238
    v_add_u32 v233, s63, v239
    v_mfma_f32_16x16x32_bf16 v[28:31], v[136:139], a[108:111], v[28:31]
    s_mov_b32 s21, s45
    v_add_u32 v234, s66, v254
    v_add_u32 v235, 147456, v234
    v_mfma_f32_16x16x32_bf16 v[28:31], v[140:143], a[124:127], v[28:31]
    s_waitcnt lgkmcnt(8)
    s_mov_b32 s22, 0x200000
    s_add_u32 m0, s54, 32768
    v_add_u32 v236, 294912, v234
    v_add_u32 v237, 442368, v234
    v_mfma_f32_16x16x32_bf16 v[32:35], v[144:147], a[96:99], v[32:35]
    ds_read_b64_tr_b16 v[136:137], v165 offset:49152
    buffer_load_dwordx4 v232, s[20:23], 0 offen offset:0 lds
    v_mfma_f32_16x16x32_bf16 v[32:35], v[148:151], a[112:115], v[32:35]
    ds_read_b64_tr_b16 v[138:139], v165 offset:53248
    v_add_u32 v232, 65536, v232
    v_mfma_f32_16x16x32_bf16 v[36:39], v[144:147], a[100:103], v[36:39]
    ds_read_b64_tr_b16 v[140:141], v165 offset:57344
    v_mfma_f32_16x16x32_bf16 v[36:39], v[148:151], a[116:119], v[36:39]
    ds_read_b64_tr_b16 v[142:143], v165 offset:61440
    v_mfma_f32_16x16x32_bf16 v[40:43], v[144:147], a[104:107], v[40:43]
    buffer_load_dwordx4 a[64:67], v234, s[12:15], 0 offen offset:0 sc1
    v_mfma_f32_16x16x32_bf16 v[40:43], v[148:151], a[120:123], v[40:43]
    v_mfma_f32_16x16x32_bf16 v[44:47], v[144:147], a[108:111], v[44:47]
    v_mfma_f32_16x16x32_bf16 v[44:47], v[148:151], a[124:127], v[44:47]
    s_waitcnt lgkmcnt(8)
    v_mfma_f32_16x16x32_bf16 v[48:51], v[152:155], a[96:99], v[48:51]
    ds_read_b64_tr_b16 v[144:145], v166 offset:49152
    v_mfma_f32_16x16x32_bf16 v[48:51], v[156:159], a[112:115], v[48:51]
    ds_read_b64_tr_b16 v[146:147], v166 offset:53248
    buffer_load_dwordx4 a[68:71], v235, s[12:15], 0 offen offset:0 sc1
    v_mfma_f32_16x16x32_bf16 v[52:55], v[152:155], a[100:103], v[52:55]
    ds_read_b64_tr_b16 v[148:149], v166 offset:57344
    v_mfma_f32_16x16x32_bf16 v[52:55], v[156:159], a[116:119], v[52:55]
    ds_read_b64_tr_b16 v[150:151], v166 offset:61440
    v_mfma_f32_16x16x32_bf16 v[56:59], v[152:155], a[104:107], v[56:59]
    v_mfma_f32_16x16x32_bf16 v[56:59], v[156:159], a[120:123], v[56:59]
    v_mfma_f32_16x16x32_bf16 v[60:63], v[152:155], a[108:111], v[60:63]
    buffer_load_dwordx4 v233, s[20:23], 0 offen offset:1024 lds
    v_mfma_f32_16x16x32_bf16 v[60:63], v[156:159], a[124:127], v[60:63]
    s_waitcnt lgkmcnt(8)
    v_add_u32 v233, 65536, v233
    v_mfma_f32_16x16x32_bf16 v[64:67], v[128:131], a[96:99], v[64:67]
    ds_read_b64_tr_b16 v[152:153], v167 offset:49152
    v_mfma_f32_16x16x32_bf16 v[64:67], v[132:135], a[112:115], v[64:67]
    ds_read_b64_tr_b16 v[154:155], v167 offset:53248
    v_mfma_f32_16x16x32_bf16 v[68:71], v[128:131], a[100:103], v[68:71]
    ds_read_b64_tr_b16 v[156:157], v167 offset:57344
    v_mfma_f32_16x16x32_bf16 v[68:71], v[132:135], a[116:119], v[68:71]
    ds_read_b64_tr_b16 v[158:159], v167 offset:61440
    buffer_load_dwordx4 a[72:75], v236, s[12:15], 0 offen offset:0 sc1
    v_mfma_f32_16x16x32_bf16 v[72:75], v[128:131], a[104:107], v[72:75]
    v_mfma_f32_16x16x32_bf16 v[72:75], v[132:135], a[120:123], v[72:75]
    v_mfma_f32_16x16x32_bf16 v[76:79], v[128:131], a[108:111], v[76:79]
    s_xor_b32 s39, s57, 3
    v_mfma_f32_16x16x32_bf16 v[76:79], v[132:135], a[124:127], v[76:79]
    s_waitcnt lgkmcnt(8)
    v_mfma_f32_16x16x32_bf16 v[80:83], v[136:139], a[96:99], v[80:83]
    s_waitcnt vmcnt(30)
    s_barrier
    ds_read_b64_tr_b16 v[128:129], v224 offset:0
    buffer_load_dwordx4 a[76:79], v237, s[12:15], 0 offen offset:0 sc1
    s_lshl_b32 s51, s56, 2
    v_mfma_f32_16x16x32_bf16 v[80:83], v[140:143], a[112:115], v[80:83]
    ds_read_b64_tr_b16 v[130:131], v224 offset:4096
    v_mfma_f32_16x16x32_bf16 v[84:87], v[136:139], a[100:103], v[84:87]
    ds_read_b64_tr_b16 v[132:133], v224 offset:8192
    s_add_u32 s51, s51, s39
    v_mfma_f32_16x16x32_bf16 v[84:87], v[140:143], a[116:119], v[84:87]
    ds_read_b64_tr_b16 v[134:135], v224 offset:12288
    v_mfma_f32_16x16x32_bf16 v[88:91], v[136:139], a[104:107], v[88:91]
    s_add_u32 m0, s54, 40960
    s_lshl_b32 s51, s51, 2
    v_mfma_f32_16x16x32_bf16 v[88:91], v[140:143], a[120:123], v[88:91]
    buffer_load_dwordx4 v232, s[20:23], 0 offen offset:0 lds
    v_mfma_f32_16x16x32_bf16 v[92:95], v[136:139], a[108:111], v[92:95]
    s_add_u32 s51, s51, s3
    v_add_u32 v232, 65536, v232
    v_mfma_f32_16x16x32_bf16 v[92:95], v[140:143], a[124:127], v[92:95]
    s_waitcnt lgkmcnt(8)
    v_mfma_f32_16x16x32_bf16 v[96:99], v[144:147], a[96:99], v[96:99]
    ds_read_b64_tr_b16 v[136:137], v225 offset:0
    s_mul_i32 s51, s51, 12288
    v_mfma_f32_16x16x32_bf16 v[96:99], v[148:151], a[112:115], v[96:99]
    ds_read_b64_tr_b16 v[138:139], v225 offset:4096
    v_mfma_f32_16x16x32_bf16 v[100:103], v[144:147], a[100:103], v[100:103]
    ds_read_b64_tr_b16 v[140:141], v225 offset:8192
    buffer_load_dwordx4 a[80:83], v234, s[12:15], 0 offen offset:1024 sc1
    s_add_u32 s51, s51, 0x2400000
    v_mfma_f32_16x16x32_bf16 v[100:103], v[148:151], a[116:119], v[100:103]
    ds_read_b64_tr_b16 v[142:143], v225 offset:12288
    v_mfma_f32_16x16x32_bf16 v[104:107], v[144:147], a[104:107], v[104:107]
    s_add_u32 s51, s51, 0
    v_mfma_f32_16x16x32_bf16 v[104:107], v[148:151], a[120:123], v[104:107]
    v_mfma_f32_16x16x32_bf16 v[108:111], v[144:147], a[108:111], v[108:111]
    s_xor_b32 s39, s57, 2
    v_mfma_f32_16x16x32_bf16 v[108:111], v[148:151], a[124:127], v[108:111]
    s_waitcnt lgkmcnt(8)
    buffer_load_dwordx4 a[84:87], v235, s[12:15], 0 offen offset:1024 sc1
    v_mfma_f32_16x16x32_bf16 v[112:115], v[152:155], a[96:99], v[112:115]
    ds_read_b64_tr_b16 v[144:145], v226 offset:0
    s_lshl_b32 s55, s56, 2
    v_mfma_f32_16x16x32_bf16 v[112:115], v[156:159], a[112:115], v[112:115]
    ds_read_b64_tr_b16 v[146:147], v226 offset:4096
    v_mfma_f32_16x16x32_bf16 v[116:119], v[152:155], a[100:103], v[116:119]
    ds_read_b64_tr_b16 v[148:149], v226 offset:8192
    s_add_u32 s55, s55, s39
    v_mfma_f32_16x16x32_bf16 v[116:119], v[156:159], a[116:119], v[116:119]
    ds_read_b64_tr_b16 v[150:151], v226 offset:12288
    v_mfma_f32_16x16x32_bf16 v[120:123], v[152:155], a[104:107], v[120:123]
    buffer_load_dwordx4 v233, s[20:23], 0 offen offset:1024 lds
    s_lshl_b32 s55, s55, 2
    v_mfma_f32_16x16x32_bf16 v[120:123], v[156:159], a[120:123], v[120:123]
    v_add_u32 v233, 65536, v233
    v_mfma_f32_16x16x32_bf16 v[124:127], v[152:155], a[108:111], v[124:127]
    s_add_u32 s55, s55, s3
    v_mfma_f32_16x16x32_bf16 v[124:127], v[156:159], a[124:127], v[124:127]
    s_waitcnt lgkmcnt(8)
    v_mfma_f32_16x16x32_bf16 v[0:3], v[128:131], a[128:131], v[0:3]
    ds_read_b64_tr_b16 v[152:153], v227 offset:0
    s_mul_i32 s55, s55, 12288
    v_mfma_f32_16x16x32_bf16 v[0:3], v[132:135], a[144:147], v[0:3]
    ds_read_b64_tr_b16 v[154:155], v227 offset:4096
    buffer_load_dwordx4 a[88:91], v236, s[12:15], 0 offen offset:1024 sc1
    v_mfma_f32_16x16x32_bf16 v[4:7], v[128:131], a[132:135], v[4:7]
    ds_read_b64_tr_b16 v[156:157], v227 offset:8192
    s_add_u32 s55, s55, 0x2400000
    v_mfma_f32_16x16x32_bf16 v[4:7], v[132:135], a[148:151], v[4:7]
    ds_read_b64_tr_b16 v[158:159], v227 offset:12288
    v_mfma_f32_16x16x32_bf16 v[8:11], v[128:131], a[136:139], v[8:11]
    s_add_u32 s55, s55, 4096
    v_mfma_f32_16x16x32_bf16 v[8:11], v[132:135], a[152:155], v[8:11]
    buffer_load_dwordx4 a[92:95], v237, s[12:15], 0 offen offset:1024 sc1
    v_mfma_f32_16x16x32_bf16 v[12:15], v[128:131], a[140:143], v[12:15]
    s_xor_b32 s39, s57, 1
    v_mfma_f32_16x16x32_bf16 v[12:15], v[132:135], a[156:159], v[12:15]
    s_waitcnt lgkmcnt(8)
    v_mfma_f32_16x16x32_bf16 v[16:19], v[136:139], a[128:131], v[16:19]
    ds_read_b64_tr_b16 v[128:129], v228 offset:0
    s_lshl_b32 s58, s56, 2
    v_mfma_f32_16x16x32_bf16 v[16:19], v[140:143], a[144:147], v[16:19]
    ds_read_b64_tr_b16 v[130:131], v228 offset:4096
    s_add_u32 m0, s54, 49152
    v_mfma_f32_16x16x32_bf16 v[20:23], v[136:139], a[132:135], v[20:23]
    ds_read_b64_tr_b16 v[132:133], v228 offset:8192
    buffer_load_dwordx4 v232, s[20:23], 0 offen offset:0 lds
    s_add_u32 s58, s58, s39
    v_mfma_f32_16x16x32_bf16 v[20:23], v[140:143], a[148:151], v[20:23]
    ds_read_b64_tr_b16 v[134:135], v228 offset:12288
    v_add_u32 v232, 65536, v232
    v_mfma_f32_16x16x32_bf16 v[24:27], v[136:139], a[136:139], v[24:27]
    s_lshl_b32 s58, s58, 2
    v_mfma_f32_16x16x32_bf16 v[24:27], v[140:143], a[152:155], v[24:27]
    v_mfma_f32_16x16x32_bf16 v[28:31], v[136:139], a[140:143], v[28:31]
    s_add_u32 s58, s58, s3
    v_mfma_f32_16x16x32_bf16 v[28:31], v[140:143], a[156:159], v[28:31]
    s_waitcnt lgkmcnt(8)
    buffer_load_dwordx4 a[96:99], v234, s[12:15], 0 offen offset:2048 sc1
    v_mfma_f32_16x16x32_bf16 v[32:35], v[144:147], a[128:131], v[32:35]
    ds_read_b64_tr_b16 v[136:137], v229 offset:0
    s_mul_i32 s58, s58, 12288
    v_mfma_f32_16x16x32_bf16 v[32:35], v[148:151], a[144:147], v[32:35]
    ds_read_b64_tr_b16 v[138:139], v229 offset:4096
    v_mfma_f32_16x16x32_bf16 v[36:39], v[144:147], a[132:135], v[36:39]
    ds_read_b64_tr_b16 v[140:141], v229 offset:8192
    s_add_u32 s58, s58, 0x2400000
    v_mfma_f32_16x16x32_bf16 v[36:39], v[148:151], a[148:151], v[36:39]
    ds_read_b64_tr_b16 v[142:143], v229 offset:12288
    v_mfma_f32_16x16x32_bf16 v[40:43], v[144:147], a[136:139], v[40:43]
    buffer_load_dwordx4 a[100:103], v235, s[12:15], 0 offen offset:2048 sc1
    s_add_u32 s58, s58, 8192
    v_mfma_f32_16x16x32_bf16 v[40:43], v[148:151], a[152:155], v[40:43]
    v_mfma_f32_16x16x32_bf16 v[44:47], v[144:147], a[140:143], v[44:47]
    s_lshl_b32 s73, s36, 2
    v_mfma_f32_16x16x32_bf16 v[44:47], v[148:151], a[156:159], v[44:47]
    s_waitcnt lgkmcnt(8)
    v_mfma_f32_16x16x32_bf16 v[48:51], v[152:155], a[128:131], v[48:51]
    ds_read_b64_tr_b16 v[144:145], v230 offset:0
    s_add_u32 s73, s73, s3
    v_mfma_f32_16x16x32_bf16 v[48:51], v[156:159], a[144:147], v[48:51]
    ds_read_b64_tr_b16 v[146:147], v230 offset:4096
    buffer_load_dwordx4 v233, s[20:23], 0 offen offset:1024 lds
    v_mfma_f32_16x16x32_bf16 v[52:55], v[152:155], a[132:135], v[52:55]
    ds_read_b64_tr_b16 v[148:149], v230 offset:8192
    s_lshl_b32 s73, s73, 17
    v_add_u32 v233, 65536, v233
    v_mfma_f32_16x16x32_bf16 v[52:55], v[156:159], a[148:151], v[52:55]
    ds_read_b64_tr_b16 v[150:151], v230 offset:12288
    v_mfma_f32_16x16x32_bf16 v[56:59], v[152:155], a[136:139], v[56:59]
    s_lshl_b32 s39, s71, 8
    v_mfma_f32_16x16x32_bf16 v[56:59], v[156:159], a[152:155], v[56:59]
    v_mfma_f32_16x16x32_bf16 v[60:63], v[152:155], a[140:143], v[60:63]
    buffer_load_dwordx4 a[104:107], v236, s[12:15], 0 offen offset:2048 sc1
    s_add_u32 s73, s73, s39
    v_mfma_f32_16x16x32_bf16 v[60:63], v[156:159], a[156:159], v[60:63]
    s_waitcnt lgkmcnt(8)
    v_mfma_f32_16x16x32_bf16 v[64:67], v[128:131], a[128:131], v[64:67]
    ds_read_b64_tr_b16 v[152:153], v231 offset:0
    s_lshl_b32 s39, s57, 6
    v_mfma_f32_16x16x32_bf16 v[64:67], v[132:135], a[144:147], v[64:67]
    ds_read_b64_tr_b16 v[154:155], v231 offset:4096
    v_mfma_f32_16x16x32_bf16 v[68:71], v[128:131], a[132:135], v[68:71]
    ds_read_b64_tr_b16 v[156:157], v231 offset:8192
    s_add_u32 s73, s73, s39
    v_mfma_f32_16x16x32_bf16 v[68:71], v[132:135], a[148:151], v[68:71]
    ds_read_b64_tr_b16 v[158:159], v231 offset:12288
    buffer_load_dwordx4 a[108:111], v237, s[12:15], 0 offen offset:2048 sc1
    v_mfma_f32_16x16x32_bf16 v[72:75], v[128:131], a[136:139], v[72:75]
    v_mfma_f32_16x16x32_bf16 v[72:75], v[132:135], a[152:155], v[72:75]
    v_mfma_f32_16x16x32_bf16 v[76:79], v[128:131], a[140:143], v[76:79]
    v_mfma_f32_16x16x32_bf16 v[76:79], v[132:135], a[156:159], v[76:79]
    s_waitcnt lgkmcnt(8)
    s_add_u32 m0, s54, 57344
    v_mfma_f32_16x16x32_bf16 v[80:83], v[136:139], a[128:131], v[80:83]
    ds_read_b64_tr_b16 v[128:129], v224 offset:16384
    buffer_load_dwordx4 v232, s[20:23], 0 offen offset:0 lds
    v_mfma_f32_16x16x32_bf16 v[80:83], v[140:143], a[144:147], v[80:83]
    ds_read_b64_tr_b16 v[130:131], v224 offset:20480
    v_add_u32 v232, 65536, v232
    v_mfma_f32_16x16x32_bf16 v[84:87], v[136:139], a[132:135], v[84:87]
    ds_read_b64_tr_b16 v[132:133], v224 offset:24576
    v_mfma_f32_16x16x32_bf16 v[84:87], v[140:143], a[148:151], v[84:87]
    ds_read_b64_tr_b16 v[134:135], v224 offset:28672
    v_mfma_f32_16x16x32_bf16 v[88:91], v[136:139], a[136:139], v[88:91]
    v_mfma_f32_16x16x32_bf16 v[88:91], v[140:143], a[152:155], v[88:91]
    buffer_load_dwordx4 a[112:115], v234, s[12:15], 0 offen offset:3072 sc1
    v_mfma_f32_16x16x32_bf16 v[92:95], v[136:139], a[140:143], v[92:95]
    v_add_u32 v234, 4096, v234
    v_mfma_f32_16x16x32_bf16 v[92:95], v[140:143], a[156:159], v[92:95]
    s_waitcnt lgkmcnt(8)
    v_mfma_f32_16x16x32_bf16 v[96:99], v[144:147], a[128:131], v[96:99]
    ds_read_b64_tr_b16 v[136:137], v225 offset:16384
    v_mfma_f32_16x16x32_bf16 v[96:99], v[148:151], a[144:147], v[96:99]
    ds_read_b64_tr_b16 v[138:139], v225 offset:20480
    v_mfma_f32_16x16x32_bf16 v[100:103], v[144:147], a[132:135], v[100:103]
    ds_read_b64_tr_b16 v[140:141], v225 offset:24576
    buffer_load_dwordx4 a[116:119], v235, s[12:15], 0 offen offset:3072 sc1
    v_mfma_f32_16x16x32_bf16 v[100:103], v[148:151], a[148:151], v[100:103]
    ds_read_b64_tr_b16 v[142:143], v225 offset:28672
    v_add_u32 v235, 4096, v235
    v_mfma_f32_16x16x32_bf16 v[104:107], v[144:147], a[136:139], v[104:107]
    v_mfma_f32_16x16x32_bf16 v[104:107], v[148:151], a[152:155], v[104:107]
    v_mfma_f32_16x16x32_bf16 v[108:111], v[144:147], a[140:143], v[108:111]
    buffer_load_dwordx4 v233, s[20:23], 0 offen offset:1024 lds
    v_add_u32 v210, s51, v254
    v_mfma_f32_16x16x32_bf16 v[108:111], v[148:151], a[156:159], v[108:111]
    s_waitcnt lgkmcnt(8)
    v_add_u32 v233, 65536, v233
    v_mfma_f32_16x16x32_bf16 v[112:115], v[152:155], a[128:131], v[112:115]
    ds_read_b64_tr_b16 v[144:145], v226 offset:16384
    v_add_u32 v211, s55, v254
    v_mfma_f32_16x16x32_bf16 v[112:115], v[156:159], a[144:147], v[112:115]
    ds_read_b64_tr_b16 v[146:147], v226 offset:20480
    v_add_u32 v212, s58, v254
    v_mfma_f32_16x16x32_bf16 v[116:119], v[152:155], a[132:135], v[116:119]
    ds_read_b64_tr_b16 v[148:149], v226 offset:24576
    v_add_u32 v213, s74, v254
    v_mfma_f32_16x16x32_bf16 v[116:119], v[156:159], a[148:151], v[116:119]
    ds_read_b64_tr_b16 v[150:151], v226 offset:28672
    buffer_load_dwordx4 a[120:123], v236, s[12:15], 0 offen offset:3072 sc1
    v_add_u32 v214, 4096, v213
    v_mfma_f32_16x16x32_bf16 v[120:123], v[152:155], a[136:139], v[120:123]
    v_add_u32 v236, 4096, v236
    v_add_u32 v215, 8192, v213
    v_mfma_f32_16x16x32_bf16 v[120:123], v[156:159], a[152:155], v[120:123]
    v_min_u32 v208, 2, v255
    v_lshlrev_b32 v208, 12, v208
    v_mfma_f32_16x16x32_bf16 v[124:127], v[152:155], a[140:143], v[124:127]
    v_add_u32 v208, 4092, v208
    v_add_u32 v220, s74, v208
    v_mfma_f32_16x16x32_bf16 v[124:127], v[156:159], a[156:159], v[124:127]
    s_waitcnt lgkmcnt(8)
    v_and_b32 v208, 15, v255
    v_mfma_f32_16x16x32_bf16 v[0:3], v[128:131], a[160:163], v[0:3]
    ds_read_b64_tr_b16 v[152:153], v227 offset:16384
    buffer_load_dwordx4 a[124:127], v237, s[12:15], 0 offen offset:3072 sc1
    v_lshlrev_b32 v216, 11, v208
    v_mfma_f32_16x16x32_bf16 v[0:3], v[132:135], a[176:179], v[0:3]
    ds_read_b64_tr_b16 v[154:155], v227 offset:20480
    v_add_u32 v237, 4096, v237
    v_mfma_f32_16x16x32_bf16 v[4:7], v[128:131], a[164:167], v[4:7]
    ds_read_b64_tr_b16 v[156:157], v227 offset:24576
    v_bfe_u32 v208, v255, 4, 1
    v_mfma_f32_16x16x32_bf16 v[4:7], v[132:135], a[180:183], v[4:7]
    ds_read_b64_tr_b16 v[158:159], v227 offset:28672
    v_lshl_add_u32 v216, v208, 5, v216
    v_mfma_f32_16x16x32_bf16 v[8:11], v[128:131], a[168:171], v[8:11]
    s_add_u32 m0, s54, 65536
    v_lshrrev_b32 v208, 5, v255
    v_mfma_f32_16x16x32_bf16 v[8:11], v[132:135], a[184:187], v[8:11]
    buffer_load_dwordx4 v232, s[20:23], 0 offen offset:0 lds
    v_lshl_add_u32 v216, v208, 4, v216
    v_mfma_f32_16x16x32_bf16 v[12:15], v[128:131], a[172:175], v[12:15]
    v_add_u32 v232, 65536, v232
    v_add_u32 v216, s73, v216
    v_mfma_f32_16x16x32_bf16 v[12:15], v[132:135], a[188:191], v[12:15]
    s_waitcnt lgkmcnt(8)
    v_add_u32 v217, 32768, v216
    v_mfma_f32_16x16x32_bf16 v[16:19], v[136:139], a[160:163], v[16:19]
    ds_read_b64_tr_b16 v[128:129], v228 offset:16384
    v_add_u32 v218, 65536, v216
    v_mfma_f32_16x16x32_bf16 v[16:19], v[140:143], a[176:179], v[16:19]
    ds_read_b64_tr_b16 v[130:131], v228 offset:20480
    v_add_u32 v219, 98304, v216
    v_mfma_f32_16x16x32_bf16 v[20:23], v[136:139], a[164:167], v[20:23]
    ds_read_b64_tr_b16 v[132:133], v228 offset:24576
    buffer_load_dwordx4 a[128:131], v234, s[12:15], 0 offen offset:0 sc1
    v_mfma_f32_16x16x32_bf16 v[20:23], v[140:143], a[180:183], v[20:23]
    ds_read_b64_tr_b16 v[134:135], v228 offset:28672
    v_mfma_f32_16x16x32_bf16 v[24:27], v[136:139], a[168:171], v[24:27]
    v_mfma_f32_16x16x32_bf16 v[24:27], v[140:143], a[184:187], v[24:27]
    v_mfma_f32_16x16x32_bf16 v[28:31], v[136:139], a[172:175], v[28:31]
    v_mfma_f32_16x16x32_bf16 v[28:31], v[140:143], a[188:191], v[28:31]
    s_waitcnt lgkmcnt(8)
    buffer_load_dwordx4 a[132:135], v235, s[12:15], 0 offen offset:0 sc1
    v_mfma_f32_16x16x32_bf16 v[32:35], v[144:147], a[160:163], v[32:35]
    ds_read_b64_tr_b16 v[136:137], v229 offset:16384
    v_mfma_f32_16x16x32_bf16 v[32:35], v[148:151], a[176:179], v[32:35]
    ds_read_b64_tr_b16 v[138:139], v229 offset:20480
    v_mfma_f32_16x16x32_bf16 v[36:39], v[144:147], a[164:167], v[36:39]
    ds_read_b64_tr_b16 v[140:141], v229 offset:24576
    v_mfma_f32_16x16x32_bf16 v[36:39], v[148:151], a[180:183], v[36:39]
    ds_read_b64_tr_b16 v[142:143], v229 offset:28672
    v_mfma_f32_16x16x32_bf16 v[40:43], v[144:147], a[168:171], v[40:43]
    buffer_load_dwordx4 v233, s[20:23], 0 offen offset:1024 lds
    v_mfma_f32_16x16x32_bf16 v[40:43], v[148:151], a[184:187], v[40:43]
    v_add_u32 v233, 65536, v233
    v_mfma_f32_16x16x32_bf16 v[44:47], v[144:147], a[172:175], v[44:47]
    v_mfma_f32_16x16x32_bf16 v[44:47], v[148:151], a[188:191], v[44:47]
    s_waitcnt lgkmcnt(8)
    v_mfma_f32_16x16x32_bf16 v[48:51], v[152:155], a[160:163], v[48:51]
    ds_read_b64_tr_b16 v[144:145], v230 offset:16384
    v_mfma_f32_16x16x32_bf16 v[48:51], v[156:159], a[176:179], v[48:51]
    ds_read_b64_tr_b16 v[146:147], v230 offset:20480
    buffer_load_dwordx4 a[136:139], v236, s[12:15], 0 offen offset:0 sc1
    v_mfma_f32_16x16x32_bf16 v[52:55], v[152:155], a[164:167], v[52:55]
    ds_read_b64_tr_b16 v[148:149], v230 offset:24576
    v_mfma_f32_16x16x32_bf16 v[52:55], v[156:159], a[180:183], v[52:55]
    ds_read_b64_tr_b16 v[150:151], v230 offset:28672
    v_mfma_f32_16x16x32_bf16 v[56:59], v[152:155], a[168:171], v[56:59]
    v_mfma_f32_16x16x32_bf16 v[56:59], v[156:159], a[184:187], v[56:59]
    v_mfma_f32_16x16x32_bf16 v[60:63], v[152:155], a[172:175], v[60:63]
    buffer_load_dwordx4 a[140:143], v237, s[12:15], 0 offen offset:0 sc1
    v_mfma_f32_16x16x32_bf16 v[60:63], v[156:159], a[188:191], v[60:63]
    s_waitcnt lgkmcnt(8)
    v_mfma_f32_16x16x32_bf16 v[64:67], v[128:131], a[160:163], v[64:67]
    ds_read_b64_tr_b16 v[152:153], v231 offset:16384
    v_mfma_f32_16x16x32_bf16 v[64:67], v[132:135], a[176:179], v[64:67]
    ds_read_b64_tr_b16 v[154:155], v231 offset:20480
    v_mfma_f32_16x16x32_bf16 v[68:71], v[128:131], a[164:167], v[68:71]
    ds_read_b64_tr_b16 v[156:157], v231 offset:24576
    s_add_u32 m0, s54, 73728
    v_mfma_f32_16x16x32_bf16 v[68:71], v[132:135], a[180:183], v[68:71]
    ds_read_b64_tr_b16 v[158:159], v231 offset:28672
    buffer_load_dwordx4 v232, s[20:23], 0 offen offset:0 lds
    v_mfma_f32_16x16x32_bf16 v[72:75], v[128:131], a[168:171], v[72:75]
    v_add_u32 v232, 65536, v232
    v_mfma_f32_16x16x32_bf16 v[72:75], v[132:135], a[184:187], v[72:75]
    v_mfma_f32_16x16x32_bf16 v[76:79], v[128:131], a[172:175], v[76:79]
    v_mfma_f32_16x16x32_bf16 v[76:79], v[132:135], a[188:191], v[76:79]
    s_waitcnt lgkmcnt(8)
    buffer_load_dwordx4 a[144:147], v234, s[12:15], 0 offen offset:1024 sc1
    v_mfma_f32_16x16x32_bf16 v[80:83], v[136:139], a[160:163], v[80:83]
    s_waitcnt vmcnt(32)
    s_barrier
    ds_read_b64_tr_b16 v[128:129], v168 offset:0
    v_mfma_f32_16x16x32_bf16 v[80:83], v[140:143], a[176:179], v[80:83]
    ds_read_b64_tr_b16 v[130:131], v168 offset:4096
    v_mfma_f32_16x16x32_bf16 v[84:87], v[136:139], a[164:167], v[84:87]
    ds_read_b64_tr_b16 v[132:133], v168 offset:8192
    v_mfma_f32_16x16x32_bf16 v[84:87], v[140:143], a[180:183], v[84:87]
    ds_read_b64_tr_b16 v[134:135], v168 offset:12288
    v_mfma_f32_16x16x32_bf16 v[88:91], v[136:139], a[168:171], v[88:91]
    buffer_load_dwordx4 a[148:151], v235, s[12:15], 0 offen offset:1024 sc1
    v_mfma_f32_16x16x32_bf16 v[88:91], v[140:143], a[184:187], v[88:91]
    v_mfma_f32_16x16x32_bf16 v[92:95], v[136:139], a[172:175], v[92:95]
    v_mfma_f32_16x16x32_bf16 v[92:95], v[140:143], a[188:191], v[92:95]
    s_waitcnt lgkmcnt(8)
    v_mfma_f32_16x16x32_bf16 v[96:99], v[144:147], a[160:163], v[96:99]
    ds_read_b64_tr_b16 v[136:137], v169 offset:0
    v_mfma_f32_16x16x32_bf16 v[96:99], v[148:151], a[176:179], v[96:99]
    ds_read_b64_tr_b16 v[138:139], v169 offset:4096
    buffer_load_dwordx4 v233, s[20:23], 0 offen offset:1024 lds
    v_mfma_f32_16x16x32_bf16 v[100:103], v[144:147], a[164:167], v[100:103]
    ds_read_b64_tr_b16 v[140:141], v169 offset:8192
    v_add_u32 v233, 65536, v233
    v_mfma_f32_16x16x32_bf16 v[100:103], v[148:151], a[180:183], v[100:103]
    ds_read_b64_tr_b16 v[142:143], v169 offset:12288
    v_mfma_f32_16x16x32_bf16 v[104:107], v[144:147], a[168:171], v[104:107]
    v_mfma_f32_16x16x32_bf16 v[104:107], v[148:151], a[184:187], v[104:107]
    v_mfma_f32_16x16x32_bf16 v[108:111], v[144:147], a[172:175], v[108:111]
    buffer_load_dwordx4 a[152:155], v236, s[12:15], 0 offen offset:1024 sc1
    v_mfma_f32_16x16x32_bf16 v[108:111], v[148:151], a[188:191], v[108:111]
    s_waitcnt lgkmcnt(8)
    v_mfma_f32_16x16x32_bf16 v[112:115], v[152:155], a[160:163], v[112:115]
    ds_read_b64_tr_b16 v[144:145], v170 offset:0
    v_mfma_f32_16x16x32_bf16 v[112:115], v[156:159], a[176:179], v[112:115]
    ds_read_b64_tr_b16 v[146:147], v170 offset:4096
    v_mfma_f32_16x16x32_bf16 v[116:119], v[152:155], a[164:167], v[116:119]
    ds_read_b64_tr_b16 v[148:149], v170 offset:8192
    v_mfma_f32_16x16x32_bf16 v[116:119], v[156:159], a[180:183], v[116:119]
    ds_read_b64_tr_b16 v[150:151], v170 offset:12288
    buffer_load_dwordx4 a[156:159], v237, s[12:15], 0 offen offset:1024 sc1
    v_mfma_f32_16x16x32_bf16 v[120:123], v[152:155], a[168:171], v[120:123]
    s_mov_b32 s40, 1048576
    s_mov_b32 s50, 0
    v_mfma_f32_16x16x32_bf16 v[120:123], v[156:159], a[184:187], v[120:123]
    v_mfma_f32_16x16x32_bf16 v[124:127], v[152:155], a[172:175], v[124:127]
    v_mfma_f32_16x16x32_bf16 v[124:127], v[156:159], a[188:191], v[124:127]
    s_waitcnt lgkmcnt(8)
    s_add_u32 m0, s54, 81920
    v_mfma_f32_16x16x32_bf16 v[0:3], v[128:131], a[0:3], v[0:3]
    ds_read_b64_tr_b16 v[152:153], v171 offset:0
    buffer_load_dwordx4 v232, s[20:23], 0 offen offset:0 lds
    v_mfma_f32_16x16x32_bf16 v[0:3], v[132:135], a[16:19], v[0:3]
    ds_read_b64_tr_b16 v[154:155], v171 offset:4096
    v_add_u32 v232, 65536, v232
    v_mfma_f32_16x16x32_bf16 v[4:7], v[128:131], a[4:7], v[4:7]
    ds_read_b64_tr_b16 v[156:157], v171 offset:8192
    v_mfma_f32_16x16x32_bf16 v[4:7], v[132:135], a[20:23], v[4:7]
    ds_read_b64_tr_b16 v[158:159], v171 offset:12288
    v_mfma_f32_16x16x32_bf16 v[8:11], v[128:131], a[8:11], v[8:11]
    v_mfma_f32_16x16x32_bf16 v[8:11], v[132:135], a[24:27], v[8:11]
    buffer_load_dwordx4 a[160:163], v234, s[12:15], 0 offen offset:2048 sc1
    v_mfma_f32_16x16x32_bf16 v[12:15], v[128:131], a[12:15], v[12:15]
    v_mfma_f32_16x16x32_bf16 v[12:15], v[132:135], a[28:31], v[12:15]
    s_waitcnt lgkmcnt(8)
    v_mfma_f32_16x16x32_bf16 v[16:19], v[136:139], a[0:3], v[16:19]
    ds_read_b64_tr_b16 v[128:129], v172 offset:0
    v_mfma_f32_16x16x32_bf16 v[16:19], v[140:143], a[16:19], v[16:19]
    ds_read_b64_tr_b16 v[130:131], v172 offset:4096
    v_mfma_f32_16x16x32_bf16 v[20:23], v[136:139], a[4:7], v[20:23]
    ds_read_b64_tr_b16 v[132:133], v172 offset:8192
    buffer_load_dwordx4 a[164:167], v235, s[12:15], 0 offen offset:2048 sc1
    v_mfma_f32_16x16x32_bf16 v[20:23], v[140:143], a[20:23], v[20:23]
    ds_read_b64_tr_b16 v[134:135], v172 offset:12288
    v_mfma_f32_16x16x32_bf16 v[24:27], v[136:139], a[8:11], v[24:27]
    v_mfma_f32_16x16x32_bf16 v[24:27], v[140:143], a[24:27], v[24:27]
    v_mfma_f32_16x16x32_bf16 v[28:31], v[136:139], a[12:15], v[28:31]
    v_mfma_f32_16x16x32_bf16 v[28:31], v[140:143], a[28:31], v[28:31]
    s_waitcnt lgkmcnt(8)
    buffer_load_dwordx4 v233, s[20:23], 0 offen offset:1024 lds
    v_mfma_f32_16x16x32_bf16 v[32:35], v[144:147], a[0:3], v[32:35]
    ds_read_b64_tr_b16 v[136:137], v173 offset:0
    v_add_u32 v233, 65536, v233
    v_mfma_f32_16x16x32_bf16 v[32:35], v[148:151], a[16:19], v[32:35]
    ds_read_b64_tr_b16 v[138:139], v173 offset:4096
    v_mfma_f32_16x16x32_bf16 v[36:39], v[144:147], a[4:7], v[36:39]
    ds_read_b64_tr_b16 v[140:141], v173 offset:8192
    v_mfma_f32_16x16x32_bf16 v[36:39], v[148:151], a[20:23], v[36:39]
    ds_read_b64_tr_b16 v[142:143], v173 offset:12288
    v_mfma_f32_16x16x32_bf16 v[40:43], v[144:147], a[8:11], v[40:43]
    buffer_load_dwordx4 a[168:171], v236, s[12:15], 0 offen offset:2048 sc1
    v_mfma_f32_16x16x32_bf16 v[40:43], v[148:151], a[24:27], v[40:43]
    v_mfma_f32_16x16x32_bf16 v[44:47], v[144:147], a[12:15], v[44:47]
    v_mfma_f32_16x16x32_bf16 v[44:47], v[148:151], a[28:31], v[44:47]
    s_waitcnt lgkmcnt(8)
    v_mfma_f32_16x16x32_bf16 v[48:51], v[152:155], a[0:3], v[48:51]
    ds_read_b64_tr_b16 v[144:145], v168 offset:16384
    buffer_load_dwordx4 a[172:175], v237, s[12:15], 0 offen offset:2048 sc1
    v_mfma_f32_16x16x32_bf16 v[48:51], v[156:159], a[16:19], v[48:51]
    ds_read_b64_tr_b16 v[146:147], v168 offset:20480
    v_mfma_f32_16x16x32_bf16 v[52:55], v[152:155], a[4:7], v[52:55]
    ds_read_b64_tr_b16 v[148:149], v168 offset:24576
    v_mfma_f32_16x16x32_bf16 v[52:55], v[156:159], a[20:23], v[52:55]
    ds_read_b64_tr_b16 v[150:151], v168 offset:28672
    v_mfma_f32_16x16x32_bf16 v[56:59], v[152:155], a[8:11], v[56:59]
    s_add_u32 m0, s54, 90112
    v_mfma_f32_16x16x32_bf16 v[56:59], v[156:159], a[24:27], v[56:59]
    buffer_load_dwordx4 v232, s[20:23], 0 offen offset:0 lds
    v_mfma_f32_16x16x32_bf16 v[60:63], v[152:155], a[12:15], v[60:63]
    v_add_u32 v232, 65536, v232
    v_mfma_f32_16x16x32_bf16 v[60:63], v[156:159], a[28:31], v[60:63]
    s_waitcnt lgkmcnt(8)
    v_mfma_f32_16x16x32_bf16 v[64:67], v[128:131], a[0:3], v[64:67]
    ds_read_b64_tr_b16 v[152:153], v169 offset:16384
    v_mfma_f32_16x16x32_bf16 v[64:67], v[132:135], a[16:19], v[64:67]
    ds_read_b64_tr_b16 v[154:155], v169 offset:20480
    v_mfma_f32_16x16x32_bf16 v[68:71], v[128:131], a[4:7], v[68:71]
    ds_read_b64_tr_b16 v[156:157], v169 offset:24576
    buffer_load_dwordx4 a[176:179], v234, s[12:15], 0 offen offset:3072 sc1
    v_mfma_f32_16x16x32_bf16 v[68:71], v[132:135], a[20:23], v[68:71]
    ds_read_b64_tr_b16 v[158:159], v169 offset:28672
    v_add_u32 v234, 4096, v234
    v_mfma_f32_16x16x32_bf16 v[72:75], v[128:131], a[8:11], v[72:75]
    v_mfma_f32_16x16x32_bf16 v[72:75], v[132:135], a[24:27], v[72:75]
    v_mfma_f32_16x16x32_bf16 v[76:79], v[128:131], a[12:15], v[76:79]
    v_mfma_f32_16x16x32_bf16 v[76:79], v[132:135], a[28:31], v[76:79]
    s_waitcnt lgkmcnt(8)
    buffer_load_dwordx4 a[180:183], v235, s[12:15], 0 offen offset:3072 sc1
    v_mfma_f32_16x16x32_bf16 v[80:83], v[136:139], a[0:3], v[80:83]
    ds_read_b64_tr_b16 v[128:129], v170 offset:16384
    v_add_u32 v235, 4096, v235
    v_mfma_f32_16x16x32_bf16 v[80:83], v[140:143], a[16:19], v[80:83]
    ds_read_b64_tr_b16 v[130:131], v170 offset:20480
    v_mfma_f32_16x16x32_bf16 v[84:87], v[136:139], a[4:7], v[84:87]
    ds_read_b64_tr_b16 v[132:133], v170 offset:24576
    v_mfma_f32_16x16x32_bf16 v[84:87], v[140:143], a[20:23], v[84:87]
    ds_read_b64_tr_b16 v[134:135], v170 offset:28672
    v_mfma_f32_16x16x32_bf16 v[88:91], v[136:139], a[8:11], v[88:91]
    buffer_load_dwordx4 v233, s[20:23], 0 offen offset:1024 lds
    v_mfma_f32_16x16x32_bf16 v[88:91], v[140:143], a[24:27], v[88:91]
    v_add_u32 v233, 65536, v233
    v_mfma_f32_16x16x32_bf16 v[92:95], v[136:139], a[12:15], v[92:95]
    v_mfma_f32_16x16x32_bf16 v[92:95], v[140:143], a[28:31], v[92:95]
    s_waitcnt lgkmcnt(8)
    v_mfma_f32_16x16x32_bf16 v[0:3], v[144:147], a[32:35], v[0:3]
    ds_read_b64_tr_b16 v[136:137], v171 offset:16384
    v_mfma_f32_16x16x32_bf16 v[0:3], v[148:151], a[48:51], v[0:3]
    ds_read_b64_tr_b16 v[138:139], v171 offset:20480
    buffer_load_dwordx4 a[184:187], v236, s[12:15], 0 offen offset:3072 sc1
    v_mfma_f32_16x16x32_bf16 v[4:7], v[144:147], a[36:39], v[4:7]
    ds_read_b64_tr_b16 v[140:141], v171 offset:24576
    v_add_u32 v236, 4096, v236
    v_mfma_f32_16x16x32_bf16 v[4:7], v[148:151], a[52:55], v[4:7]
    ds_read_b64_tr_b16 v[142:143], v171 offset:28672
    v_mfma_f32_16x16x32_bf16 v[8:11], v[144:147], a[40:43], v[8:11]
    v_mfma_f32_16x16x32_bf16 v[8:11], v[148:151], a[56:59], v[8:11]
    v_mfma_f32_16x16x32_bf16 v[12:15], v[144:147], a[44:47], v[12:15]
    buffer_load_dwordx4 a[188:191], v237, s[12:15], 0 offen offset:3072 sc1
    v_mfma_f32_16x16x32_bf16 v[12:15], v[148:151], a[60:63], v[12:15]
    s_waitcnt lgkmcnt(8)
    v_add_u32 v237, 4096, v237
    v_mfma_f32_16x16x32_bf16 v[16:19], v[152:155], a[32:35], v[16:19]
    ds_read_b64_tr_b16 v[144:145], v172 offset:16384
    v_mfma_f32_16x16x32_bf16 v[16:19], v[156:159], a[48:51], v[16:19]
    ds_read_b64_tr_b16 v[146:147], v172 offset:20480
    v_mfma_f32_16x16x32_bf16 v[20:23], v[152:155], a[36:39], v[20:23]
    ds_read_b64_tr_b16 v[148:149], v172 offset:24576
    v_mfma_f32_16x16x32_bf16 v[20:23], v[156:159], a[52:55], v[20:23]
    ds_read_b64_tr_b16 v[150:151], v172 offset:28672
    v_mfma_f32_16x16x32_bf16 v[24:27], v[152:155], a[40:43], v[24:27]
    v_mfma_f32_16x16x32_bf16 v[24:27], v[156:159], a[56:59], v[24:27]
    v_mfma_f32_16x16x32_bf16 v[28:31], v[152:155], a[44:47], v[28:31]
    v_mfma_f32_16x16x32_bf16 v[28:31], v[156:159], a[60:63], v[28:31]
    s_waitcnt lgkmcnt(8)
    v_mfma_f32_16x16x32_bf16 v[32:35], v[128:131], a[32:35], v[32:35]
    ds_read_b64_tr_b16 v[152:153], v173 offset:16384
    v_mfma_f32_16x16x32_bf16 v[32:35], v[132:135], a[48:51], v[32:35]
    ds_read_b64_tr_b16 v[154:155], v173 offset:20480
    v_mfma_f32_16x16x32_bf16 v[36:39], v[128:131], a[36:39], v[36:39]
    ds_read_b64_tr_b16 v[156:157], v173 offset:24576
    v_mfma_f32_16x16x32_bf16 v[36:39], v[132:135], a[52:55], v[36:39]
    ds_read_b64_tr_b16 v[158:159], v173 offset:28672
    v_mfma_f32_16x16x32_bf16 v[40:43], v[128:131], a[40:43], v[40:43]
    v_mfma_f32_16x16x32_bf16 v[40:43], v[132:135], a[56:59], v[40:43]
    v_mfma_f32_16x16x32_bf16 v[44:47], v[128:131], a[44:47], v[44:47]
    v_mul_f32 v0, v0, v200
    v_mul_f32 v1, v1, v200
    v_mfma_f32_16x16x32_bf16 v[44:47], v[132:135], a[60:63], v[44:47]
    s_waitcnt lgkmcnt(8)
    v_mul_f32 v2, v2, v200
    v_mfma_f32_16x16x32_bf16 v[48:51], v[136:139], a[32:35], v[48:51]
    s_waitcnt vmcnt(24)
    s_barrier
    ds_read_b64_tr_b16 v[128:129], v224 offset:32768
    v_mul_f32 v3, v3, v200
    v_mfma_f32_16x16x32_bf16 v[48:51], v[140:143], a[48:51], v[48:51]
    ds_read_b64_tr_b16 v[130:131], v224 offset:36864
    v_mul_f32 v4, v4, v201
    v_mfma_f32_16x16x32_bf16 v[52:55], v[136:139], a[36:39], v[52:55]
    ds_read_b64_tr_b16 v[132:133], v224 offset:40960
    v_mul_f32 v5, v5, v201
    v_mfma_f32_16x16x32_bf16 v[52:55], v[140:143], a[52:55], v[52:55]
    ds_read_b64_tr_b16 v[134:135], v224 offset:45056
    v_mul_f32 v6, v6, v201
    v_mfma_f32_16x16x32_bf16 v[56:59], v[136:139], a[40:43], v[56:59]
    v_mul_f32 v7, v7, v201
    v_mul_f32 v8, v8, v202
    v_mfma_f32_16x16x32_bf16 v[56:59], v[140:143], a[56:59], v[56:59]
    v_mul_f32 v9, v9, v202
    v_mul_f32 v10, v10, v202
    v_mfma_f32_16x16x32_bf16 v[60:63], v[136:139], a[44:47], v[60:63]
    v_mul_f32 v11, v11, v202
    v_mul_f32 v12, v12, v203
    v_mfma_f32_16x16x32_bf16 v[60:63], v[140:143], a[60:63], v[60:63]
    s_waitcnt lgkmcnt(8)
    v_mul_f32 v13, v13, v203
    v_mfma_f32_16x16x32_bf16 v[64:67], v[144:147], a[32:35], v[64:67]
    ds_read_b64_tr_b16 v[136:137], v225 offset:32768
    v_mul_f32 v14, v14, v203
    v_mfma_f32_16x16x32_bf16 v[64:67], v[148:151], a[48:51], v[64:67]
    ds_read_b64_tr_b16 v[138:139], v225 offset:36864
    v_mul_f32 v15, v15, v203
    v_mfma_f32_16x16x32_bf16 v[68:71], v[144:147], a[36:39], v[68:71]
    ds_read_b64_tr_b16 v[140:141], v225 offset:40960
    v_mul_f32 v16, v16, v200
    v_mfma_f32_16x16x32_bf16 v[68:71], v[148:151], a[52:55], v[68:71]
    ds_read_b64_tr_b16 v[142:143], v225 offset:45056
    v_mul_f32 v17, v17, v200
    v_mfma_f32_16x16x32_bf16 v[72:75], v[144:147], a[40:43], v[72:75]
    v_mul_f32 v18, v18, v200
    v_mul_f32 v19, v19, v200
    v_mfma_f32_16x16x32_bf16 v[72:75], v[148:151], a[56:59], v[72:75]
    v_mul_f32 v20, v20, v201
    v_mul_f32 v21, v21, v201
    v_mfma_f32_16x16x32_bf16 v[76:79], v[144:147], a[44:47], v[76:79]
    v_mul_f32 v22, v22, v201
    v_mul_f32 v23, v23, v201
    v_mfma_f32_16x16x32_bf16 v[76:79], v[148:151], a[60:63], v[76:79]
    s_waitcnt lgkmcnt(8)
    v_mul_f32 v24, v24, v202
    v_mfma_f32_16x16x32_bf16 v[80:83], v[152:155], a[32:35], v[80:83]
    ds_read_b64_tr_b16 v[144:145], v224 offset:49152
    v_mul_f32 v25, v25, v202
    v_mfma_f32_16x16x32_bf16 v[80:83], v[156:159], a[48:51], v[80:83]
    ds_read_b64_tr_b16 v[146:147], v224 offset:53248
    v_mul_f32 v26, v26, v202
    v_mfma_f32_16x16x32_bf16 v[84:87], v[152:155], a[36:39], v[84:87]
    ds_read_b64_tr_b16 v[148:149], v224 offset:57344
    v_mul_f32 v27, v27, v202
    v_mfma_f32_16x16x32_bf16 v[84:87], v[156:159], a[52:55], v[84:87]
    ds_read_b64_tr_b16 v[150:151], v224 offset:61440
    v_mul_f32 v28, v28, v203
    v_mfma_f32_16x16x32_bf16 v[88:91], v[152:155], a[40:43], v[88:91]
    v_mul_f32 v29, v29, v203
    v_mul_f32 v30, v30, v203
    v_mfma_f32_16x16x32_bf16 v[88:91], v[156:159], a[56:59], v[88:91]
    v_mul_f32 v31, v31, v203
    v_mul_f32 v32, v32, v200
    v_mfma_f32_16x16x32_bf16 v[92:95], v[152:155], a[44:47], v[92:95]
    v_mul_f32 v33, v33, v200
    v_mul_f32 v34, v34, v200
    v_mfma_f32_16x16x32_bf16 v[92:95], v[156:159], a[60:63], v[92:95]
    s_waitcnt lgkmcnt(8)
    v_mul_f32 v35, v35, v200
    v_mfma_f32_16x16x32_bf16 v[0:3], v[128:131], a[64:67], v[0:3]
    ds_read_b64_tr_b16 v[152:153], v225 offset:49152
    v_mul_f32 v36, v36, v201
    v_mfma_f32_16x16x32_bf16 v[0:3], v[132:135], a[80:83], v[0:3]
    ds_read_b64_tr_b16 v[154:155], v225 offset:53248
    v_mul_f32 v37, v37, v201
    v_mfma_f32_16x16x32_bf16 v[4:7], v[128:131], a[68:71], v[4:7]
    ds_read_b64_tr_b16 v[156:157], v225 offset:57344
    v_mul_f32 v38, v38, v201
    v_mfma_f32_16x16x32_bf16 v[4:7], v[132:135], a[84:87], v[4:7]
    ds_read_b64_tr_b16 v[158:159], v225 offset:61440
    v_mul_f32 v39, v39, v201
    v_mfma_f32_16x16x32_bf16 v[8:11], v[128:131], a[72:75], v[8:11]
    v_mul_f32 v40, v40, v202
    v_mul_f32 v41, v41, v202
    v_mfma_f32_16x16x32_bf16 v[8:11], v[132:135], a[88:91], v[8:11]
    v_mul_f32 v42, v42, v202
    v_mul_f32 v43, v43, v202
    v_mfma_f32_16x16x32_bf16 v[12:15], v[128:131], a[76:79], v[12:15]
    v_mul_f32 v44, v44, v203
    v_mul_f32 v45, v45, v203
    v_mfma_f32_16x16x32_bf16 v[12:15], v[132:135], a[92:95], v[12:15]
    s_waitcnt lgkmcnt(8)
    v_mul_f32 v46, v46, v203
    v_mfma_f32_16x16x32_bf16 v[16:19], v[136:139], a[64:67], v[16:19]
    s_waitcnt vmcnt(0)
    s_barrier
    ds_read_b64_tr_b16 v[128:129], v160 offset:0
    v_mul_f32 v47, v47, v203
    v_mfma_f32_16x16x32_bf16 v[16:19], v[140:143], a[80:83], v[16:19]
    ds_read_b64_tr_b16 v[130:131], v160 offset:4096
    v_mul_f32 v48, v48, v200
    v_mfma_f32_16x16x32_bf16 v[20:23], v[136:139], a[68:71], v[20:23]
    ds_read_b64_tr_b16 v[132:133], v160 offset:8192
    v_mul_f32 v49, v49, v200
    v_mfma_f32_16x16x32_bf16 v[20:23], v[140:143], a[84:87], v[20:23]
    ds_read_b64_tr_b16 v[134:135], v160 offset:12288
    v_mul_f32 v50, v50, v200
    v_mfma_f32_16x16x32_bf16 v[24:27], v[136:139], a[72:75], v[24:27]
    v_mul_f32 v51, v51, v200
    v_mul_f32 v52, v52, v201
    v_mfma_f32_16x16x32_bf16 v[24:27], v[140:143], a[88:91], v[24:27]
    v_mul_f32 v53, v53, v201
    v_mul_f32 v54, v54, v201
    v_mfma_f32_16x16x32_bf16 v[28:31], v[136:139], a[76:79], v[28:31]
    v_mul_f32 v55, v55, v201
    v_mul_f32 v56, v56, v202
    v_mfma_f32_16x16x32_bf16 v[28:31], v[140:143], a[92:95], v[28:31]
    s_waitcnt lgkmcnt(8)
    v_mul_f32 v57, v57, v202
    v_mfma_f32_16x16x32_bf16 v[0:3], v[144:147], a[96:99], v[0:3]
    ds_read_b64_tr_b16 v[136:137], v161 offset:0
    v_mul_f32 v58, v58, v202
    v_mfma_f32_16x16x32_bf16 v[0:3], v[148:151], a[112:115], v[0:3]
    ds_read_b64_tr_b16 v[138:139], v161 offset:4096
    v_mul_f32 v59, v59, v202
    v_mfma_f32_16x16x32_bf16 v[4:7], v[144:147], a[100:103], v[4:7]
    ds_read_b64_tr_b16 v[140:141], v161 offset:8192
    v_mul_f32 v60, v60, v203
    v_mfma_f32_16x16x32_bf16 v[4:7], v[148:151], a[116:119], v[4:7]
    ds_read_b64_tr_b16 v[142:143], v161 offset:12288
    v_mul_f32 v61, v61, v203
    v_mfma_f32_16x16x32_bf16 v[8:11], v[144:147], a[104:107], v[8:11]
    v_mul_f32 v62, v62, v203
    v_mul_f32 v63, v63, v203
    v_mfma_f32_16x16x32_bf16 v[8:11], v[148:151], a[120:123], v[8:11]
    v_mul_f32 v64, v64, v200
    v_mul_f32 v65, v65, v200
    v_mfma_f32_16x16x32_bf16 v[12:15], v[144:147], a[108:111], v[12:15]
    buffer_load_dword v251, v220, s[16:19], 0 offen sc1
    v_mul_f32 v66, v66, v200
    v_mul_f32 v67, v67, v200
    v_mfma_f32_16x16x32_bf16 v[12:15], v[148:151], a[124:127], v[12:15]
    s_waitcnt lgkmcnt(8)
    v_mul_f32 v68, v68, v201
    v_mfma_f32_16x16x32_bf16 v[16:19], v[152:155], a[96:99], v[16:19]
    ds_read_b64_tr_b16 v[144:145], v160 offset:16384
    v_mul_f32 v69, v69, v201
    v_mfma_f32_16x16x32_bf16 v[16:19], v[156:159], a[112:115], v[16:19]
    ds_read_b64_tr_b16 v[146:147], v160 offset:20480
    v_mul_f32 v70, v70, v201
    v_mfma_f32_16x16x32_bf16 v[20:23], v[152:155], a[100:103], v[20:23]
    ds_read_b64_tr_b16 v[148:149], v160 offset:24576
    v_mul_f32 v71, v71, v201
    v_mfma_f32_16x16x32_bf16 v[20:23], v[156:159], a[116:119], v[20:23]
    ds_read_b64_tr_b16 v[150:151], v160 offset:28672
    v_mul_f32 v72, v72, v202
    v_mfma_f32_16x16x32_bf16 v[24:27], v[152:155], a[104:107], v[24:27]
    v_mul_f32 v73, v73, v202
    v_mul_f32 v74, v74, v202
    v_mfma_f32_16x16x32_bf16 v[24:27], v[156:159], a[120:123], v[24:27]
    v_mul_f32 v75, v75, v202
    v_mul_f32 v76, v76, v203
    v_mfma_f32_16x16x32_bf16 v[28:31], v[152:155], a[108:111], v[28:31]
    v_mul_f32 v77, v77, v203
    v_mul_f32 v78, v78, v203
    v_mfma_f32_16x16x32_bf16 v[28:31], v[156:159], a[124:127], v[28:31]
    s_waitcnt lgkmcnt(8)
    v_mul_f32 v79, v79, v203
    v_mfma_f32_16x16x32_bf16 v[0:3], v[128:131], a[128:131], v[0:3]
    ds_read_b64_tr_b16 v[152:153], v161 offset:16384
    v_mul_f32 v80, v80, v200
    v_mfma_f32_16x16x32_bf16 v[0:3], v[132:135], a[144:147], v[0:3]
    ds_read_b64_tr_b16 v[154:155], v161 offset:20480
    v_mul_f32 v81, v81, v200
    v_mfma_f32_16x16x32_bf16 v[4:7], v[128:131], a[132:135], v[4:7]
    ds_read_b64_tr_b16 v[156:157], v161 offset:24576
    v_mul_f32 v82, v82, v200
    v_mfma_f32_16x16x32_bf16 v[4:7], v[132:135], a[148:151], v[4:7]
    ds_read_b64_tr_b16 v[158:159], v161 offset:28672
    v_mul_f32 v83, v83, v200
    v_mfma_f32_16x16x32_bf16 v[8:11], v[128:131], a[136:139], v[8:11]
    v_mul_f32 v84, v84, v201
    v_mul_f32 v85, v85, v201
    v_mfma_f32_16x16x32_bf16 v[8:11], v[132:135], a[152:155], v[8:11]
    v_mul_f32 v86, v86, v201
    v_mul_f32 v87, v87, v201
    v_mfma_f32_16x16x32_bf16 v[12:15], v[128:131], a[140:143], v[12:15]
    v_mul_f32 v88, v88, v202
    v_mul_f32 v89, v89, v202
    v_mfma_f32_16x16x32_bf16 v[12:15], v[132:135], a[156:159], v[12:15]
    s_waitcnt lgkmcnt(8)
    v_mul_f32 v90, v90, v202
    v_mfma_f32_16x16x32_bf16 v[16:19], v[136:139], a[128:131], v[16:19]
    ds_read_b64_tr_b16 v[128:129], v226 offset:32768
    v_mul_f32 v91, v91, v202
    v_mfma_f32_16x16x32_bf16 v[16:19], v[140:143], a[144:147], v[16:19]
    ds_read_b64_tr_b16 v[130:131], v226 offset:36864
    v_mul_f32 v92, v92, v203
    v_mfma_f32_16x16x32_bf16 v[20:23], v[136:139], a[132:135], v[20:23]
    ds_read_b64_tr_b16 v[132:133], v226 offset:40960
    v_mul_f32 v93, v93, v203
    v_mfma_f32_16x16x32_bf16 v[20:23], v[140:143], a[148:151], v[20:23]
    ds_read_b64_tr_b16 v[134:135], v226 offset:45056
    v_mul_f32 v94, v94, v203
    v_mfma_f32_16x16x32_bf16 v[24:27], v[136:139], a[136:139], v[24:27]
    v_mul_f32 v95, v95, v203
    v_mfma_f32_16x16x32_bf16 v[24:27], v[140:143], a[152:155], v[24:27]
    v_mfma_f32_16x16x32_bf16 v[28:31], v[136:139], a[140:143], v[28:31]
    v_mfma_f32_16x16x32_bf16 v[28:31], v[140:143], a[156:159], v[28:31]
    s_waitcnt lgkmcnt(8)
    v_mfma_f32_16x16x32_bf16 v[0:3], v[144:147], a[160:163], v[0:3]
    ds_read_b64_tr_b16 v[136:137], v227 offset:32768
    v_mfma_f32_16x16x32_bf16 v[0:3], v[148:151], a[176:179], v[0:3]
    ds_read_b64_tr_b16 v[138:139], v227 offset:36864
    v_mfma_f32_16x16x32_bf16 v[4:7], v[144:147], a[164:167], v[4:7]
    ds_read_b64_tr_b16 v[140:141], v227 offset:40960
    v_mfma_f32_16x16x32_bf16 v[4:7], v[148:151], a[180:183], v[4:7]
    ds_read_b64_tr_b16 v[142:143], v227 offset:45056
    v_mfma_f32_16x16x32_bf16 v[8:11], v[144:147], a[168:171], v[8:11]
    v_mfma_f32_16x16x32_bf16 v[8:11], v[148:151], a[184:187], v[8:11]
    v_mfma_f32_16x16x32_bf16 v[12:15], v[144:147], a[172:175], v[12:15]
    v_mfma_f32_16x16x32_bf16 v[12:15], v[148:151], a[188:191], v[12:15]
    s_waitcnt lgkmcnt(8)
    v_mfma_f32_16x16x32_bf16 v[16:19], v[152:155], a[160:163], v[16:19]
    ds_read_b64_tr_b16 v[144:145], v226 offset:49152
    v_mfma_f32_16x16x32_bf16 v[16:19], v[156:159], a[176:179], v[16:19]
    ds_read_b64_tr_b16 v[146:147], v226 offset:53248
    v_mfma_f32_16x16x32_bf16 v[20:23], v[152:155], a[164:167], v[20:23]
    ds_read_b64_tr_b16 v[148:149], v226 offset:57344
    s_waitcnt vmcnt(0)
    v_cmp_eq_u32 vcc, -1, v251
    s_nop 3
    v_mfma_f32_16x16x32_bf16 v[20:23], v[156:159], a[180:183], v[20:23]
    ds_read_b64_tr_b16 v[150:151], v226 offset:61440
    s_or_b32 s39, vcc_lo, s50
    s_bitcmp1_b32 s39, 0
    s_cbranch_scc1 p3_t0_0
    s_bitset1_b32 s50, 0
    buffer_load_dwordx4 a[192:195], v213, s[16:19], 0 offen offset:0 sc1
    buffer_load_dwordx4 a[196:199], v213, s[16:19], 0 offen offset:1024 sc1
    buffer_load_dwordx4 a[200:203], v213, s[16:19], 0 offen offset:2048 sc1
    buffer_load_dwordx4 a[204:207], v213, s[16:19], 0 offen offset:3072 sc1
p3_t0_0:
    v_mfma_f32_16x16x32_bf16 v[24:27], v[152:155], a[168:171], v[24:27]
    v_mfma_f32_16x16x32_bf16 v[24:27], v[156:159], a[184:187], v[24:27]
    v_mfma_f32_16x16x32_bf16 v[28:31], v[152:155], a[172:175], v[28:31]
    v_mfma_f32_16x16x32_bf16 v[28:31], v[156:159], a[188:191], v[28:31]
    s_waitcnt lgkmcnt(8)
    v_mfma_f32_16x16x32_bf16 v[32:35], v[128:131], a[64:67], v[32:35]
    ds_read_b64_tr_b16 v[152:153], v227 offset:49152
    v_mfma_f32_16x16x32_bf16 v[32:35], v[132:135], a[80:83], v[32:35]
    ds_read_b64_tr_b16 v[154:155], v227 offset:53248
    v_mfma_f32_16x16x32_bf16 v[36:39], v[128:131], a[68:71], v[36:39]
    ds_read_b64_tr_b16 v[156:157], v227 offset:57344
    v_cvt_pk_bf16_f32 v176, v0, v1
    v_mfma_f32_16x16x32_bf16 v[36:39], v[132:135], a[84:87], v[36:39]
    ds_read_b64_tr_b16 v[158:159], v227 offset:61440
    v_cvt_pk_bf16_f32 v177, v2, v3
    v_mfma_f32_16x16x32_bf16 v[40:43], v[128:131], a[72:75], v[40:43]
    v_cvt_pk_bf16_f32 v178, v16, v17
    v_cvt_pk_bf16_f32 v179, v18, v19
    v_mfma_f32_16x16x32_bf16 v[40:43], v[132:135], a[88:91], v[40:43]
    v_min_u32 v176, -2, v176
    v_min_u32 v177, -2, v177
    v_mfma_f32_16x16x32_bf16 v[44:47], v[128:131], a[76:79], v[44:47]
    v_min_u32 v178, -2, v178
    v_min_u32 v179, -2, v179
    v_mfma_f32_16x16x32_bf16 v[44:47], v[132:135], a[92:95], v[44:47]
    s_waitcnt lgkmcnt(8)
    v_mfma_f32_16x16x32_bf16 v[48:51], v[136:139], a[64:67], v[48:51]
    ds_read_b64_tr_b16 v[128:129], v162 offset:0
    v_mfma_f32_16x16x32_bf16 v[48:51], v[140:143], a[80:83], v[48:51]
    ds_read_b64_tr_b16 v[130:131], v162 offset:4096
    v_mfma_f32_16x16x32_bf16 v[52:55], v[136:139], a[68:71], v[52:55]
    ds_read_b64_tr_b16 v[132:133], v162 offset:8192
    v_mfma_f32_16x16x32_bf16 v[52:55], v[140:143], a[84:87], v[52:55]
    ds_read_b64_tr_b16 v[134:135], v162 offset:12288
    v_mfma_f32_16x16x32_bf16 v[56:59], v[136:139], a[72:75], v[56:59]
    buffer_store_dwordx4 v[176:179], v210, s[16:19], 0 offen offset:0 sc1
    v_mfma_f32_16x16x32_bf16 v[56:59], v[140:143], a[88:91], v[56:59]
    v_mfma_f32_16x16x32_bf16 v[60:63], v[136:139], a[76:79], v[60:63]
    v_cvt_pk_bf16_f32 v180, v4, v5
    v_cvt_pk_bf16_f32 v181, v6, v7
    v_mfma_f32_16x16x32_bf16 v[60:63], v[140:143], a[92:95], v[60:63]
    s_waitcnt lgkmcnt(8)
    v_cvt_pk_bf16_f32 v182, v20, v21
    v_mfma_f32_16x16x32_bf16 v[32:35], v[144:147], a[96:99], v[32:35]
    ds_read_b64_tr_b16 v[136:137], v163 offset:0
    v_cvt_pk_bf16_f32 v183, v22, v23
    v_mfma_f32_16x16x32_bf16 v[32:35], v[148:151], a[112:115], v[32:35]
    ds_read_b64_tr_b16 v[138:139], v163 offset:4096
    v_min_u32 v180, -2, v180
    v_mfma_f32_16x16x32_bf16 v[36:39], v[144:147], a[100:103], v[36:39]
    ds_read_b64_tr_b16 v[140:141], v163 offset:8192
    v_min_u32 v181, -2, v181
    v_mfma_f32_16x16x32_bf16 v[36:39], v[148:151], a[116:119], v[36:39]
    ds_read_b64_tr_b16 v[142:143], v163 offset:12288
    v_min_u32 v182, -2, v182
    v_mfma_f32_16x16x32_bf16 v[40:43], v[144:147], a[104:107], v[40:43]
    v_min_u32 v183, -2, v183
    v_mfma_f32_16x16x32_bf16 v[40:43], v[148:151], a[120:123], v[40:43]
    buffer_store_dwordx4 v[180:183], v210, s[16:19], 0 offen offset:1024 sc1
    v_mfma_f32_16x16x32_bf16 v[44:47], v[144:147], a[108:111], v[44:47]
    v_mfma_f32_16x16x32_bf16 v[44:47], v[148:151], a[124:127], v[44:47]
    s_waitcnt lgkmcnt(8)
    v_cvt_pk_bf16_f32 v184, v8, v9
    v_mfma_f32_16x16x32_bf16 v[48:51], v[152:155], a[96:99], v[48:51]
    ds_read_b64_tr_b16 v[144:145], v162 offset:16384
    v_cvt_pk_bf16_f32 v185, v10, v11
    v_mfma_f32_16x16x32_bf16 v[48:51], v[156:159], a[112:115], v[48:51]
    ds_read_b64_tr_b16 v[146:147], v162 offset:20480
    v_cvt_pk_bf16_f32 v186, v24, v25
    v_mfma_f32_16x16x32_bf16 v[52:55], v[152:155], a[100:103], v[52:55]
    ds_read_b64_tr_b16 v[148:149], v162 offset:24576
    v_cvt_pk_bf16_f32 v187, v26, v27
    v_mfma_f32_16x16x32_bf16 v[52:55], v[156:159], a[116:119], v[52:55]
    ds_read_b64_tr_b16 v[150:151], v162 offset:28672
    v_min_u32 v184, -2, v184
    v_mfma_f32_16x16x32_bf16 v[56:59], v[152:155], a[104:107], v[56:59]
    v_min_u32 v185, -2, v185
    v_min_u32 v186, -2, v186
    v_mfma_f32_16x16x32_bf16 v[56:59], v[156:159], a[120:123], v[56:59]
    v_min_u32 v187, -2, v187
    v_mfma_f32_16x16x32_bf16 v[60:63], v[152:155], a[108:111], v[60:63]
    buffer_store_dwordx4 v[184:187], v210, s[16:19], 0 offen offset:2048 sc1
    v_mfma_f32_16x16x32_bf16 v[60:63], v[156:159], a[124:127], v[60:63]
    s_waitcnt lgkmcnt(8)
    v_mfma_f32_16x16x32_bf16 v[32:35], v[128:131], a[128:131], v[32:35]
    ds_read_b64_tr_b16 v[152:153], v163 offset:16384
    v_cvt_pk_bf16_f32 v188, v12, v13
    v_mfma_f32_16x16x32_bf16 v[32:35], v[132:135], a[144:147], v[32:35]
    ds_read_b64_tr_b16 v[154:155], v163 offset:20480
    v_cvt_pk_bf16_f32 v189, v14, v15
    v_mfma_f32_16x16x32_bf16 v[36:39], v[128:131], a[132:135], v[36:39]
    ds_read_b64_tr_b16 v[156:157], v163 offset:24576
    v_cvt_pk_bf16_f32 v190, v28, v29
    v_mfma_f32_16x16x32_bf16 v[36:39], v[132:135], a[148:151], v[36:39]
    ds_read_b64_tr_b16 v[158:159], v163 offset:28672
    v_cvt_pk_bf16_f32 v191, v30, v31
    v_mfma_f32_16x16x32_bf16 v[40:43], v[128:131], a[136:139], v[40:43]
    v_min_u32 v188, -2, v188
    v_min_u32 v189, -2, v189
    v_mfma_f32_16x16x32_bf16 v[40:43], v[132:135], a[152:155], v[40:43]
    v_min_u32 v190, -2, v190
    v_min_u32 v191, -2, v191
    v_mfma_f32_16x16x32_bf16 v[44:47], v[128:131], a[140:143], v[44:47]
    buffer_store_dwordx4 v[188:191], v210, s[16:19], 0 offen offset:3072 sc1
    v_mfma_f32_16x16x32_bf16 v[44:47], v[132:135], a[156:159], v[44:47]
    s_waitcnt lgkmcnt(8)
    v_mfma_f32_16x16x32_bf16 v[48:51], v[136:139], a[128:131], v[48:51]
    ds_read_b64_tr_b16 v[128:129], v228 offset:32768
    v_mfma_f32_16x16x32_bf16 v[48:51], v[140:143], a[144:147], v[48:51]
    ds_read_b64_tr_b16 v[130:131], v228 offset:36864
    v_mfma_f32_16x16x32_bf16 v[52:55], v[136:139], a[132:135], v[52:55]
    ds_read_b64_tr_b16 v[132:133], v228 offset:40960
    v_mfma_f32_16x16x32_bf16 v[52:55], v[140:143], a[148:151], v[52:55]
    ds_read_b64_tr_b16 v[134:135], v228 offset:45056
    v_mfma_f32_16x16x32_bf16 v[56:59], v[136:139], a[136:139], v[56:59]
    v_mfma_f32_16x16x32_bf16 v[56:59], v[140:143], a[152:155], v[56:59]
    v_mfma_f32_16x16x32_bf16 v[60:63], v[136:139], a[140:143], v[60:63]
    v_mfma_f32_16x16x32_bf16 v[60:63], v[140:143], a[156:159], v[60:63]
    s_waitcnt lgkmcnt(8)
    v_mfma_f32_16x16x32_bf16 v[32:35], v[144:147], a[160:163], v[32:35]
    ds_read_b64_tr_b16 v[136:137], v229 offset:32768
    v_mfma_f32_16x16x32_bf16 v[32:35], v[148:151], a[176:179], v[32:35]
    ds_read_b64_tr_b16 v[138:139], v229 offset:36864
    v_mfma_f32_16x16x32_bf16 v[36:39], v[144:147], a[164:167], v[36:39]
    ds_read_b64_tr_b16 v[140:141], v229 offset:40960
    v_mfma_f32_16x16x32_bf16 v[36:39], v[148:151], a[180:183], v[36:39]
    ds_read_b64_tr_b16 v[142:143], v229 offset:45056
    v_mfma_f32_16x16x32_bf16 v[40:43], v[144:147], a[168:171], v[40:43]
    v_mfma_f32_16x16x32_bf16 v[40:43], v[148:151], a[184:187], v[40:43]
    v_mfma_f32_16x16x32_bf16 v[44:47], v[144:147], a[172:175], v[44:47]
    v_mfma_f32_16x16x32_bf16 v[44:47], v[148:151], a[188:191], v[44:47]
    s_waitcnt lgkmcnt(8)
    s_or_b32 s39, vcc_lo, s50
    s_bitcmp1_b32 s39, 1
    s_cbranch_scc1 p3_t0_1
    s_bitset1_b32 s50, 1
    buffer_load_dwordx4 a[208:211], v214, s[16:19], 0 offen offset:0 sc1
    buffer_load_dwordx4 a[212:215], v214, s[16:19], 0 offen offset:1024 sc1
    buffer_load_dwordx4 a[216:219], v214, s[16:19], 0 offen offset:2048 sc1
    buffer_load_dwordx4 a[220:223], v214, s[16:19], 0 offen offset:3072 sc1
p3_t0_1:
    v_mfma_f32_16x16x32_bf16 v[48:51], v[152:155], a[160:163], v[48:51]
    ds_read_b64_tr_b16 v[144:145], v228 offset:49152
    v_mfma_f32_16x16x32_bf16 v[48:51], v[156:159], a[176:179], v[48:51]
    ds_read_b64_tr_b16 v[146:147], v228 offset:53248
    v_mfma_f32_16x16x32_bf16 v[52:55], v[152:155], a[164:167], v[52:55]
    ds_read_b64_tr_b16 v[148:149], v228 offset:57344
    v_mfma_f32_16x16x32_bf16 v[52:55], v[156:159], a[180:183], v[52:55]
    ds_read_b64_tr_b16 v[150:151], v228 offset:61440
    v_mfma_f32_16x16x32_bf16 v[56:59], v[152:155], a[168:171], v[56:59]
    v_mfma_f32_16x16x32_bf16 v[56:59], v[156:159], a[184:187], v[56:59]
    v_mfma_f32_16x16x32_bf16 v[60:63], v[152:155], a[172:175], v[60:63]
    v_mfma_f32_16x16x32_bf16 v[60:63], v[156:159], a[188:191], v[60:63]
    s_waitcnt lgkmcnt(8)
    v_mfma_f32_16x16x32_bf16 v[64:67], v[128:131], a[64:67], v[64:67]
    ds_read_b64_tr_b16 v[152:153], v229 offset:49152
    v_mfma_f32_16x16x32_bf16 v[64:67], v[132:135], a[80:83], v[64:67]
    ds_read_b64_tr_b16 v[154:155], v229 offset:53248
    v_mfma_f32_16x16x32_bf16 v[68:71], v[128:131], a[68:71], v[68:71]
    ds_read_b64_tr_b16 v[156:157], v229 offset:57344
    v_cvt_pk_bf16_f32 v176, v32, v33
    v_mfma_f32_16x16x32_bf16 v[68:71], v[132:135], a[84:87], v[68:71]
    ds_read_b64_tr_b16 v[158:159], v229 offset:61440
    v_cvt_pk_bf16_f32 v177, v34, v35
    v_mfma_f32_16x16x32_bf16 v[72:75], v[128:131], a[72:75], v[72:75]
    v_cvt_pk_bf16_f32 v178, v48, v49
    v_cvt_pk_bf16_f32 v179, v50, v51
    v_mfma_f32_16x16x32_bf16 v[72:75], v[132:135], a[88:91], v[72:75]
    v_min_u32 v176, -2, v176
    v_min_u32 v177, -2, v177
    v_mfma_f32_16x16x32_bf16 v[76:79], v[128:131], a[76:79], v[76:79]
    v_min_u32 v178, -2, v178
    v_min_u32 v179, -2, v179
    v_mfma_f32_16x16x32_bf16 v[76:79], v[132:135], a[92:95], v[76:79]
    s_waitcnt lgkmcnt(8)
    v_mfma_f32_16x16x32_bf16 v[80:83], v[136:139], a[64:67], v[80:83]
    ds_read_b64_tr_b16 v[128:129], v164 offset:0
    v_mfma_f32_16x16x32_bf16 v[80:83], v[140:143], a[80:83], v[80:83]
    ds_read_b64_tr_b16 v[130:131], v164 offset:4096
    v_mfma_f32_16x16x32_bf16 v[84:87], v[136:139], a[68:71], v[84:87]
    ds_read_b64_tr_b16 v[132:133], v164 offset:8192
    v_mfma_f32_16x16x32_bf16 v[84:87], v[140:143], a[84:87], v[84:87]
    ds_read_b64_tr_b16 v[134:135], v164 offset:12288
    v_mfma_f32_16x16x32_bf16 v[88:91], v[136:139], a[72:75], v[88:91]
    buffer_store_dwordx4 v[176:179], v211, s[16:19], 0 offen offset:0 sc1
    v_mfma_f32_16x16x32_bf16 v[88:91], v[140:143], a[88:91], v[88:91]
    v_mfma_f32_16x16x32_bf16 v[92:95], v[136:139], a[76:79], v[92:95]
    v_cvt_pk_bf16_f32 v180, v36, v37
    v_cvt_pk_bf16_f32 v181, v38, v39
    v_mfma_f32_16x16x32_bf16 v[92:95], v[140:143], a[92:95], v[92:95]
    s_waitcnt lgkmcnt(8)
    v_cvt_pk_bf16_f32 v182, v52, v53
    v_mfma_f32_16x16x32_bf16 v[64:67], v[144:147], a[96:99], v[64:67]
    ds_read_b64_tr_b16 v[136:137], v165 offset:0
    v_cvt_pk_bf16_f32 v183, v54, v55
    v_mfma_f32_16x16x32_bf16 v[64:67], v[148:151], a[112:115], v[64:67]
    ds_read_b64_tr_b16 v[138:139], v165 offset:4096
    v_min_u32 v180, -2, v180
    v_mfma_f32_16x16x32_bf16 v[68:71], v[144:147], a[100:103], v[68:71]
    ds_read_b64_tr_b16 v[140:141], v165 offset:8192
    v_min_u32 v181, -2, v181
    v_mfma_f32_16x16x32_bf16 v[68:71], v[148:151], a[116:119], v[68:71]
    ds_read_b64_tr_b16 v[142:143], v165 offset:12288
    v_min_u32 v182, -2, v182
    v_mfma_f32_16x16x32_bf16 v[72:75], v[144:147], a[104:107], v[72:75]
    v_min_u32 v183, -2, v183
    v_mfma_f32_16x16x32_bf16 v[72:75], v[148:151], a[120:123], v[72:75]
    buffer_store_dwordx4 v[180:183], v211, s[16:19], 0 offen offset:1024 sc1
    v_mfma_f32_16x16x32_bf16 v[76:79], v[144:147], a[108:111], v[76:79]
    v_mfma_f32_16x16x32_bf16 v[76:79], v[148:151], a[124:127], v[76:79]
    s_waitcnt lgkmcnt(8)
    v_cvt_pk_bf16_f32 v184, v40, v41
    v_mfma_f32_16x16x32_bf16 v[80:83], v[152:155], a[96:99], v[80:83]
    ds_read_b64_tr_b16 v[144:145], v164 offset:16384
    v_cvt_pk_bf16_f32 v185, v42, v43
    v_mfma_f32_16x16x32_bf16 v[80:83], v[156:159], a[112:115], v[80:83]
    ds_read_b64_tr_b16 v[146:147], v164 offset:20480
    v_cvt_pk_bf16_f32 v186, v56, v57
    v_mfma_f32_16x16x32_bf16 v[84:87], v[152:155], a[100:103], v[84:87]
    ds_read_b64_tr_b16 v[148:149], v164 offset:24576
    v_cvt_pk_bf16_f32 v187, v58, v59
    v_mfma_f32_16x16x32_bf16 v[84:87], v[156:159], a[116:119], v[84:87]
    ds_read_b64_tr_b16 v[150:151], v164 offset:28672
    v_min_u32 v184, -2, v184
    v_mfma_f32_16x16x32_bf16 v[88:91], v[152:155], a[104:107], v[88:91]
    v_min_u32 v185, -2, v185
    v_min_u32 v186, -2, v186
    v_mfma_f32_16x16x32_bf16 v[88:91], v[156:159], a[120:123], v[88:91]
    v_min_u32 v187, -2, v187
    v_mfma_f32_16x16x32_bf16 v[92:95], v[152:155], a[108:111], v[92:95]
    buffer_store_dwordx4 v[184:187], v211, s[16:19], 0 offen offset:2048 sc1
    v_mfma_f32_16x16x32_bf16 v[92:95], v[156:159], a[124:127], v[92:95]
    s_waitcnt lgkmcnt(8)
    v_mfma_f32_16x16x32_bf16 v[64:67], v[128:131], a[128:131], v[64:67]
    ds_read_b64_tr_b16 v[152:153], v165 offset:16384
    v_cvt_pk_bf16_f32 v188, v44, v45
    v_mfma_f32_16x16x32_bf16 v[64:67], v[132:135], a[144:147], v[64:67]
    ds_read_b64_tr_b16 v[154:155], v165 offset:20480
    v_cvt_pk_bf16_f32 v189, v46, v47
    v_mfma_f32_16x16x32_bf16 v[68:71], v[128:131], a[132:135], v[68:71]
    ds_read_b64_tr_b16 v[156:157], v165 offset:24576
    v_cvt_pk_bf16_f32 v190, v60, v61
    v_mfma_f32_16x16x32_bf16 v[68:71], v[132:135], a[148:151], v[68:71]
    ds_read_b64_tr_b16 v[158:159], v165 offset:28672
    v_cvt_pk_bf16_f32 v191, v62, v63
    v_mfma_f32_16x16x32_bf16 v[72:75], v[128:131], a[136:139], v[72:75]
    v_min_u32 v188, -2, v188
    v_min_u32 v189, -2, v189
    v_mfma_f32_16x16x32_bf16 v[72:75], v[132:135], a[152:155], v[72:75]
    v_min_u32 v190, -2, v190
    v_min_u32 v191, -2, v191
    v_mfma_f32_16x16x32_bf16 v[76:79], v[128:131], a[140:143], v[76:79]
    buffer_store_dwordx4 v[188:191], v211, s[16:19], 0 offen offset:3072 sc1
    v_mfma_f32_16x16x32_bf16 v[76:79], v[132:135], a[156:159], v[76:79]
    s_waitcnt lgkmcnt(8)
    v_mfma_f32_16x16x32_bf16 v[80:83], v[136:139], a[128:131], v[80:83]
    ds_read_b64_tr_b16 v[128:129], v174 offset:0
    v_mfma_f32_16x16x32_bf16 v[80:83], v[140:143], a[144:147], v[80:83]
    ds_read_b64_tr_b16 v[130:131], v174 offset:4096
    v_mfma_f32_16x16x32_bf16 v[84:87], v[136:139], a[132:135], v[84:87]
    ds_read_b64_tr_b16 v[132:133], v174 offset:8192
    v_mfma_f32_16x16x32_bf16 v[84:87], v[140:143], a[148:151], v[84:87]
    ds_read_b64_tr_b16 v[134:135], v174 offset:12288
    v_mfma_f32_16x16x32_bf16 v[88:91], v[136:139], a[136:139], v[88:91]
    v_mfma_f32_16x16x32_bf16 v[88:91], v[140:143], a[152:155], v[88:91]
    v_mfma_f32_16x16x32_bf16 v[92:95], v[136:139], a[140:143], v[92:95]
    v_mfma_f32_16x16x32_bf16 v[92:95], v[140:143], a[156:159], v[92:95]
    s_waitcnt lgkmcnt(8)
    v_mfma_f32_16x16x32_bf16 v[64:67], v[144:147], a[160:163], v[64:67]
    ds_read_b64_tr_b16 v[136:137], v175 offset:0
    v_mfma_f32_16x16x32_bf16 v[64:67], v[148:151], a[176:179], v[64:67]
    ds_read_b64_tr_b16 v[138:139], v175 offset:4096
    v_mfma_f32_16x16x32_bf16 v[68:71], v[144:147], a[164:167], v[68:71]
    ds_read_b64_tr_b16 v[140:141], v175 offset:8192
    v_mfma_f32_16x16x32_bf16 v[68:71], v[148:151], a[180:183], v[68:71]
    ds_read_b64_tr_b16 v[142:143], v175 offset:12288
    s_or_b32 s39, vcc_lo, s50
    s_bitcmp1_b32 s39, 2
    s_cbranch_scc1 p3_t0_2
    s_bitset1_b32 s50, 2
    buffer_load_dwordx4 a[224:227], v215, s[16:19], 0 offen offset:0 sc1
    buffer_load_dwordx4 a[228:231], v215, s[16:19], 0 offen offset:1024 sc1
    buffer_load_dwordx4 a[232:235], v215, s[16:19], 0 offen offset:2048 sc1
    buffer_load_dwordx4 a[236:239], v215, s[16:19], 0 offen offset:3072 sc1
p3_t0_2:
    v_mfma_f32_16x16x32_bf16 v[72:75], v[144:147], a[168:171], v[72:75]
    v_mfma_f32_16x16x32_bf16 v[72:75], v[148:151], a[184:187], v[72:75]
    v_mfma_f32_16x16x32_bf16 v[76:79], v[144:147], a[172:175], v[76:79]
    v_mfma_f32_16x16x32_bf16 v[76:79], v[148:151], a[188:191], v[76:79]
    s_waitcnt lgkmcnt(8)
    v_mfma_f32_16x16x32_bf16 v[80:83], v[152:155], a[160:163], v[80:83]
    ds_read_b64_tr_b16 v[144:145], v174 offset:16384
    v_mfma_f32_16x16x32_bf16 v[80:83], v[156:159], a[176:179], v[80:83]
    ds_read_b64_tr_b16 v[146:147], v174 offset:20480
    v_mfma_f32_16x16x32_bf16 v[84:87], v[152:155], a[164:167], v[84:87]
    ds_read_b64_tr_b16 v[148:149], v174 offset:24576
    v_mfma_f32_16x16x32_bf16 v[84:87], v[156:159], a[180:183], v[84:87]
    ds_read_b64_tr_b16 v[150:151], v174 offset:28672
    v_mfma_f32_16x16x32_bf16 v[88:91], v[152:155], a[168:171], v[88:91]
    v_mfma_f32_16x16x32_bf16 v[88:91], v[156:159], a[184:187], v[88:91]
    v_mfma_f32_16x16x32_bf16 v[92:95], v[152:155], a[172:175], v[92:95]
    v_mfma_f32_16x16x32_bf16 v[92:95], v[156:159], a[188:191], v[92:95]
    s_waitcnt lgkmcnt(8)
    v_mfma_f32_16x16x32_bf16 v[96:99], v[128:131], a[0:3], v[96:99]
    ds_read_b64_tr_b16 v[152:153], v175 offset:16384
    v_mfma_f32_16x16x32_bf16 v[96:99], v[132:135], a[16:19], v[96:99]
    ds_read_b64_tr_b16 v[154:155], v175 offset:20480
    v_mfma_f32_16x16x32_bf16 v[100:103], v[128:131], a[4:7], v[100:103]
    ds_read_b64_tr_b16 v[156:157], v175 offset:24576
    v_cvt_pk_bf16_f32 v176, v64, v65
    v_cvt_pk_bf16_f32 v177, v66, v67
    v_mfma_f32_16x16x32_bf16 v[100:103], v[132:135], a[20:23], v[100:103]
    ds_read_b64_tr_b16 v[158:159], v175 offset:28672
    v_cvt_pk_bf16_f32 v178, v80, v81
    v_cvt_pk_bf16_f32 v179, v82, v83
    v_mfma_f32_16x16x32_bf16 v[104:107], v[128:131], a[8:11], v[104:107]
    v_min_u32 v176, -2, v176
    v_min_u32 v177, -2, v177
    v_mfma_f32_16x16x32_bf16 v[104:107], v[132:135], a[24:27], v[104:107]
    v_min_u32 v178, -2, v178
    v_min_u32 v179, -2, v179
    v_mfma_f32_16x16x32_bf16 v[108:111], v[128:131], a[12:15], v[108:111]
    buffer_store_dwordx4 v[176:179], v212, s[16:19], 0 offen offset:0 sc1
    v_cvt_pk_bf16_f32 v180, v68, v69
    v_cvt_pk_bf16_f32 v181, v70, v71
    v_mfma_f32_16x16x32_bf16 v[108:111], v[132:135], a[28:31], v[108:111]
    s_waitcnt lgkmcnt(8)
    v_cvt_pk_bf16_f32 v182, v84, v85
    v_cvt_pk_bf16_f32 v183, v86, v87
    v_mfma_f32_16x16x32_bf16 v[112:115], v[136:139], a[0:3], v[112:115]
    ds_read_b64_tr_b16 v[128:129], v230 offset:32768
    v_min_u32 v180, -2, v180
    v_min_u32 v181, -2, v181
    v_mfma_f32_16x16x32_bf16 v[112:115], v[140:143], a[16:19], v[112:115]
    ds_read_b64_tr_b16 v[130:131], v230 offset:36864
    v_min_u32 v182, -2, v182
    v_min_u32 v183, -2, v183
    v_mfma_f32_16x16x32_bf16 v[116:119], v[136:139], a[4:7], v[116:119]
    ds_read_b64_tr_b16 v[132:133], v230 offset:40960
    buffer_store_dwordx4 v[180:183], v212, s[16:19], 0 offen offset:1024 sc1
    v_cvt_pk_bf16_f32 v184, v72, v73
    v_cvt_pk_bf16_f32 v185, v74, v75
    v_mfma_f32_16x16x32_bf16 v[116:119], v[140:143], a[20:23], v[116:119]
    ds_read_b64_tr_b16 v[134:135], v230 offset:45056
    v_cvt_pk_bf16_f32 v186, v88, v89
    v_cvt_pk_bf16_f32 v187, v90, v91
    v_mfma_f32_16x16x32_bf16 v[120:123], v[136:139], a[8:11], v[120:123]
    v_min_u32 v184, -2, v184
    v_min_u32 v185, -2, v185
    v_mfma_f32_16x16x32_bf16 v[120:123], v[140:143], a[24:27], v[120:123]
    v_min_u32 v186, -2, v186
    v_min_u32 v187, -2, v187
    v_mfma_f32_16x16x32_bf16 v[124:127], v[136:139], a[12:15], v[124:127]
    buffer_store_dwordx4 v[184:187], v212, s[16:19], 0 offen offset:2048 sc1
    v_cvt_pk_bf16_f32 v188, v76, v77
    v_cvt_pk_bf16_f32 v189, v78, v79
    v_mfma_f32_16x16x32_bf16 v[124:127], v[140:143], a[28:31], v[124:127]
    s_waitcnt lgkmcnt(8)
    v_cvt_pk_bf16_f32 v190, v92, v93
    v_cvt_pk_bf16_f32 v191, v94, v95
    v_mfma_f32_16x16x32_bf16 v[96:99], v[144:147], a[32:35], v[96:99]
    ds_read_b64_tr_b16 v[136:137], v231 offset:32768
    v_min_u32 v188, -2, v188
    v_min_u32 v189, -2, v189
    v_mfma_f32_16x16x32_bf16 v[96:99], v[148:151], a[48:51], v[96:99]
    ds_read_b64_tr_b16 v[138:139], v231 offset:36864
    v_min_u32 v190, -2, v190
    v_min_u32 v191, -2, v191
    v_mfma_f32_16x16x32_bf16 v[100:103], v[144:147], a[36:39], v[100:103]
    ds_read_b64_tr_b16 v[140:141], v231 offset:40960
    buffer_store_dwordx4 v[188:191], v212, s[16:19], 0 offen offset:3072 sc1
    v_mfma_f32_16x16x32_bf16 v[100:103], v[148:151], a[52:55], v[100:103]
    ds_read_b64_tr_b16 v[142:143], v231 offset:45056
    v_mfma_f32_16x16x32_bf16 v[104:107], v[144:147], a[40:43], v[104:107]
    v_mfma_f32_16x16x32_bf16 v[104:107], v[148:151], a[56:59], v[104:107]
    v_mfma_f32_16x16x32_bf16 v[108:111], v[144:147], a[44:47], v[108:111]
    v_mfma_f32_16x16x32_bf16 v[108:111], v[148:151], a[60:63], v[108:111]
    s_waitcnt lgkmcnt(8)
    v_mfma_f32_16x16x32_bf16 v[112:115], v[152:155], a[32:35], v[112:115]
    ds_read_b64_tr_b16 v[144:145], v230 offset:49152
    v_mfma_f32_16x16x32_bf16 v[112:115], v[156:159], a[48:51], v[112:115]
    ds_read_b64_tr_b16 v[146:147], v230 offset:53248
    v_mfma_f32_16x16x32_bf16 v[116:119], v[152:155], a[36:39], v[116:119]
    ds_read_b64_tr_b16 v[148:149], v230 offset:57344
    v_mfma_f32_16x16x32_bf16 v[116:119], v[156:159], a[52:55], v[116:119]
    ds_read_b64_tr_b16 v[150:151], v230 offset:61440
    v_mfma_f32_16x16x32_bf16 v[120:123], v[152:155], a[40:43], v[120:123]
    v_mfma_f32_16x16x32_bf16 v[120:123], v[156:159], a[56:59], v[120:123]
    v_mfma_f32_16x16x32_bf16 v[124:127], v[152:155], a[44:47], v[124:127]
    v_mfma_f32_16x16x32_bf16 v[124:127], v[156:159], a[60:63], v[124:127]
    s_waitcnt lgkmcnt(8)
    v_mfma_f32_16x16x32_bf16 v[0:3], v[128:131], a[64:67], 0
    ds_read_b64_tr_b16 v[152:153], v231 offset:49152
    v_mfma_f32_16x16x32_bf16 v[0:3], v[132:135], a[80:83], v[0:3]
    ds_read_b64_tr_b16 v[154:155], v231 offset:53248
    v_mfma_f32_16x16x32_bf16 v[4:7], v[128:131], a[68:71], 0
    ds_read_b64_tr_b16 v[156:157], v231 offset:57344
    v_mfma_f32_16x16x32_bf16 v[4:7], v[132:135], a[84:87], v[4:7]
    ds_read_b64_tr_b16 v[158:159], v231 offset:61440
    v_mfma_f32_16x16x32_bf16 v[8:11], v[128:131], a[72:75], 0
    v_mfma_f32_16x16x32_bf16 v[8:11], v[132:135], a[88:91], v[8:11]
    v_mfma_f32_16x16x32_bf16 v[12:15], v[128:131], a[76:79], 0
    v_mfma_f32_16x16x32_bf16 v[12:15], v[132:135], a[92:95], v[12:15]
    s_waitcnt lgkmcnt(8)
    v_mfma_f32_16x16x32_bf16 v[16:19], v[136:139], a[64:67], 0
    ds_read_b64_tr_b16 v[128:129], v166 offset:0
    buffer_load_dword v251, v220, s[16:19], 0 offen sc1
    v_mfma_f32_16x16x32_bf16 v[16:19], v[140:143], a[80:83], v[16:19]
    ds_read_b64_tr_b16 v[130:131], v166 offset:4096
    v_mfma_f32_16x16x32_bf16 v[20:23], v[136:139], a[68:71], 0
    ds_read_b64_tr_b16 v[132:133], v166 offset:8192
    v_mfma_f32_16x16x32_bf16 v[20:23], v[140:143], a[84:87], v[20:23]
    ds_read_b64_tr_b16 v[134:135], v166 offset:12288
    v_mfma_f32_16x16x32_bf16 v[24:27], v[136:139], a[72:75], 0
    v_mfma_f32_16x16x32_bf16 v[24:27], v[140:143], a[88:91], v[24:27]
    v_mfma_f32_16x16x32_bf16 v[28:31], v[136:139], a[76:79], 0
    v_mfma_f32_16x16x32_bf16 v[28:31], v[140:143], a[92:95], v[28:31]
    s_waitcnt lgkmcnt(8)
    v_mfma_f32_16x16x32_bf16 v[0:3], v[144:147], a[96:99], v[0:3]
    ds_read_b64_tr_b16 v[136:137], v167 offset:0
    v_mfma_f32_16x16x32_bf16 v[0:3], v[148:151], a[112:115], v[0:3]
    ds_read_b64_tr_b16 v[138:139], v167 offset:4096
    v_mfma_f32_16x16x32_bf16 v[4:7], v[144:147], a[100:103], v[4:7]
    ds_read_b64_tr_b16 v[140:141], v167 offset:8192
    v_mfma_f32_16x16x32_bf16 v[4:7], v[148:151], a[116:119], v[4:7]
    ds_read_b64_tr_b16 v[142:143], v167 offset:12288
    v_mfma_f32_16x16x32_bf16 v[8:11], v[144:147], a[104:107], v[8:11]
    v_mfma_f32_16x16x32_bf16 v[8:11], v[148:151], a[120:123], v[8:11]
    v_mfma_f32_16x16x32_bf16 v[12:15], v[144:147], a[108:111], v[12:15]
    v_mfma_f32_16x16x32_bf16 v[12:15], v[148:151], a[124:127], v[12:15]
    s_waitcnt lgkmcnt(8)
    v_mfma_f32_16x16x32_bf16 v[16:19], v[152:155], a[96:99], v[16:19]
    ds_read_b64_tr_b16 v[144:145], v166 offset:16384
    v_mfma_f32_16x16x32_bf16 v[16:19], v[156:159], a[112:115], v[16:19]
    ds_read_b64_tr_b16 v[146:147], v166 offset:20480
    v_mfma_f32_16x16x32_bf16 v[20:23], v[152:155], a[100:103], v[20:23]
    ds_read_b64_tr_b16 v[148:149], v166 offset:24576
    v_mfma_f32_16x16x32_bf16 v[20:23], v[156:159], a[116:119], v[20:23]
    ds_read_b64_tr_b16 v[150:151], v166 offset:28672
    v_mfma_f32_16x16x32_bf16 v[24:27], v[152:155], a[104:107], v[24:27]
    v_mfma_f32_16x16x32_bf16 v[24:27], v[156:159], a[120:123], v[24:27]
    v_mfma_f32_16x16x32_bf16 v[28:31], v[152:155], a[108:111], v[28:31]
    v_mfma_f32_16x16x32_bf16 v[28:31], v[156:159], a[124:127], v[28:31]
    s_waitcnt lgkmcnt(8)
    v_mfma_f32_16x16x32_bf16 v[0:3], v[128:131], a[128:131], v[0:3]
    ds_read_b64_tr_b16 v[152:153], v167 offset:16384
    v_mfma_f32_16x16x32_bf16 v[0:3], v[132:135], a[144:147], v[0:3]
    ds_read_b64_tr_b16 v[154:155], v167 offset:20480
    v_mfma_f32_16x16x32_bf16 v[4:7], v[128:131], a[132:135], v[4:7]
    ds_read_b64_tr_b16 v[156:157], v167 offset:24576
    v_mfma_f32_16x16x32_bf16 v[4:7], v[132:135], a[148:151], v[4:7]
    ds_read_b64_tr_b16 v[158:159], v167 offset:28672
    v_mfma_f32_16x16x32_bf16 v[8:11], v[128:131], a[136:139], v[8:11]
    v_mfma_f32_16x16x32_bf16 v[8:11], v[132:135], a[152:155], v[8:11]
    v_mfma_f32_16x16x32_bf16 v[12:15], v[128:131], a[140:143], v[12:15]
    v_mfma_f32_16x16x32_bf16 v[12:15], v[132:135], a[156:159], v[12:15]
    s_waitcnt lgkmcnt(8)
    v_mfma_f32_16x16x32_bf16 v[16:19], v[136:139], a[128:131], v[16:19]
    v_mfma_f32_16x16x32_bf16 v[16:19], v[140:143], a[144:147], v[16:19]
    v_mfma_f32_16x16x32_bf16 v[20:23], v[136:139], a[132:135], v[20:23]
    v_mfma_f32_16x16x32_bf16 v[20:23], v[140:143], a[148:151], v[20:23]
    v_mfma_f32_16x16x32_bf16 v[24:27], v[136:139], a[136:139], v[24:27]
    s_waitcnt vmcnt(0)
    v_cmp_eq_u32 vcc, -1, v251
    s_nop 3
    v_mfma_f32_16x16x32_bf16 v[24:27], v[140:143], a[152:155], v[24:27]
    s_or_b32 s39, vcc_lo, s50
    s_bitcmp1_b32 s39, 0
    s_cbranch_scc1 p3_t1_0
    s_bitset1_b32 s50, 0
    buffer_load_dwordx4 a[192:195], v213, s[16:19], 0 offen offset:0 sc1
    buffer_load_dwordx4 a[196:199], v213, s[16:19], 0 offen offset:1024 sc1
    buffer_load_dwordx4 a[200:203], v213, s[16:19], 0 offen offset:2048 sc1
    buffer_load_dwordx4 a[204:207], v213, s[16:19], 0 offen offset:3072 sc1
p3_t1_0:
    v_mfma_f32_16x16x32_bf16 v[28:31], v[136:139], a[140:143], v[28:31]
    v_mfma_f32_16x16x32_bf16 v[28:31], v[140:143], a[156:159], v[28:31]
    s_waitcnt lgkmcnt(4)
    v_mfma_f32_16x16x32_bf16 v[0:3], v[144:147], a[160:163], v[0:3]
    v_mfma_f32_16x16x32_bf16 v[0:3], v[148:151], a[176:179], v[0:3]
    v_mfma_f32_16x16x32_bf16 v[4:7], v[144:147], a[164:167], v[4:7]
    v_mfma_f32_16x16x32_bf16 v[4:7], v[148:151], a[180:183], v[4:7]
    v_mfma_f32_16x16x32_bf16 v[8:11], v[144:147], a[168:171], v[8:11]
    v_mfma_f32_16x16x32_bf16 v[8:11], v[148:151], a[184:187], v[8:11]
    s_or_b32 s39, vcc_lo, s50
    s_bitcmp1_b32 s39, 1
    s_cbranch_scc1 p3_t1_1
    s_bitset1_b32 s50, 1
    buffer_load_dwordx4 a[208:211], v214, s[16:19], 0 offen offset:0 sc1
    buffer_load_dwordx4 a[212:215], v214, s[16:19], 0 offen offset:1024 sc1
    buffer_load_dwordx4 a[216:219], v214, s[16:19], 0 offen offset:2048 sc1
    buffer_load_dwordx4 a[220:223], v214, s[16:19], 0 offen offset:3072 sc1
p3_t1_1:
    v_mfma_f32_16x16x32_bf16 v[12:15], v[144:147], a[172:175], v[12:15]
    v_mfma_f32_16x16x32_bf16 v[12:15], v[148:151], a[188:191], v[12:15]
    s_waitcnt lgkmcnt(0)
    v_mfma_f32_16x16x32_bf16 v[16:19], v[152:155], a[160:163], v[16:19]
    v_mfma_f32_16x16x32_bf16 v[16:19], v[156:159], a[176:179], v[16:19]
    v_mfma_f32_16x16x32_bf16 v[20:23], v[152:155], a[164:167], v[20:23]
    v_mfma_f32_16x16x32_bf16 v[20:23], v[156:159], a[180:183], v[20:23]
    v_mfma_f32_16x16x32_bf16 v[24:27], v[152:155], a[168:171], v[24:27]
    v_mfma_f32_16x16x32_bf16 v[24:27], v[156:159], a[184:187], v[24:27]
    v_mfma_f32_16x16x32_bf16 v[28:31], v[152:155], a[172:175], v[28:31]
    v_mfma_f32_16x16x32_bf16 v[28:31], v[156:159], a[188:191], v[28:31]
    s_nop 2
    s_cmp_lg_u32 s50, 7
    s_cbranch_scc1 p3_wait
p3_have:
    s_waitcnt vmcnt(0)
    v_accvgpr_read_b32 v32, a192
    v_accvgpr_read_b32 v33, a193
    v_accvgpr_read_b32 v34, a194
    v_accvgpr_read_b32 v35, a195
    v_accvgpr_read_b32 v36, a196
    v_accvgpr_read_b32 v37, a197
    v_accvgpr_read_b32 v38, a198
    v_accvgpr_read_b32 v39, a199
    v_accvgpr_read_b32 v40, a200
    v_accvgpr_read_b32 v41, a201
    v_accvgpr_read_b32 v42, a202
    v_accvgpr_read_b32 v43, a203
    v_accvgpr_read_b32 v44, a204
    v_accvgpr_read_b32 v45, a205
    v_accvgpr_read_b32 v46, a206
    v_accvgpr_read_b32 v47, a207
    v_accvgpr_read_b32 v48, a208
    v_accvgpr_read_b32 v49, a209
    v_accvgpr_read_b32 v50, a210
    v_accvgpr_read_b32 v51, a211
    v_accvgpr_read_b32 v52, a212
    v_accvgpr_read_b32 v53, a213
    v_accvgpr_read_b32 v54, a214
    v_accvgpr_read_b32 v55, a215
    v_accvgpr_read_b32 v56, a216
    v_accvgpr_read_b32 v57, a217
    v_accvgpr_read_b32 v58, a218
    v_accvgpr_read_b32 v59, a219
    v_accvgpr_read_b32 v60, a220
    v_accvgpr_read_b32 v61, a221
    v_accvgpr_read_b32 v62, a222
    v_accvgpr_read_b32 v63, a223
    v_accvgpr_read_b32 v64, a224
    v_accvgpr_read_b32 v65, a225
    v_accvgpr_read_b32 v66, a226
    v_accvgpr_read_b32 v67, a227
    v_accvgpr_read_b32 v68, a228
    v_accvgpr_read_b32 v69, a229
    v_accvgpr_read_b32 v70, a230
    v_accvgpr_read_b32 v71, a231
    v_accvgpr_read_b32 v72, a232
    v_accvgpr_read_b32 v73, a233
    v_accvgpr_read_b32 v74, a234
    v_accvgpr_read_b32 v75, a235
    v_accvgpr_read_b32 v76, a236
    v_accvgpr_read_b32 v77, a237
    v_accvgpr_read_b32 v78, a238
    v_accvgpr_read_b32 v79, a239
    v_max3_u32 v209, v32, v33, v34
    v_max3_u32 v209, v209, v35, v36
    v_max3_u32 v209, v209, v37, v38
    v_max3_u32 v209, v209, v39, v40
    v_max3_u32 v209, v209, v41, v42
    v_max3_u32 v209, v209, v43, v44
    v_max3_u32 v209, v209, v45, v46
    v_max3_u32 v209, v209, v47, v48
    v_max3_u32 v209, v209, v49, v50
    v_max3_u32 v209, v209, v51, v52
    v_max3_u32 v209, v209, v53, v54
    v_max3_u32 v209, v209, v55, v56
    v_max3_u32 v209, v209, v57, v58
    v_max3_u32 v209, v209, v59, v60
    v_max3_u32 v209, v209, v61, v62
    v_max3_u32 v209, v209, v63, v64
    v_max3_u32 v209, v209, v65, v66
    v_max3_u32 v209, v209, v67, v68
    v_max3_u32 v209, v209, v69, v70
    v_max3_u32 v209, v209, v71, v72
    v_max3_u32 v209, v209, v73, v74
    v_max3_u32 v209, v209, v75, v76
    v_max3_u32 v209, v209, v77, v78
    v_max_u32 v209, v209, v79
    v_cmp_eq_u32 vcc, -1, v209
    s_nop 3
    s_cmp_lg_u64 vcc, 0
    s_cbranch_scc1 p3_again
p3_got:
    s_mov_b32 s78, 0xffff0000
    v_fma_f32 v96, v96, v200, v0
    v_fma_f32 v97, v97, v200, v1
    v_fma_f32 v98, v98, v200, v2
    v_fma_f32 v99, v99, v200, v3
    v_fma_f32 v112, v112, v200, v16
    v_fma_f32 v113, v113, v200, v17
    v_fma_f32 v114, v114, v200, v18
    v_fma_f32 v115, v115, v200, v19
    v_lshlrev_b32 v144, 16, v32
    v_and_b32 v145, s78, v32
    v_lshlrev_b32 v146, 16, v33
    v_and_b32 v147, s78, v33
    v_lshlrev_b32 v148, 16, v34
    v_and_b32 v149, s78, v34
    v_lshlrev_b32 v150, 16, v35
    v_and_b32 v151, s78, v35
    v_pk_add_f32 v[96:97], v[96:97], v[144:145]
    v_pk_add_f32 v[98:99], v[98:99], v[146:147]
    v_pk_add_f32 v[112:113], v[112:113], v[148:149]
    v_pk_add_f32 v[114:115], v[114:115], v[150:151]
    v_lshlrev_b32 v144, 16, v48
    v_and_b32 v145, s78, v48
    v_lshlrev_b32 v146, 16, v49
    v_and_b32 v147, s78, v49
    v_lshlrev_b32 v148, 16, v50
    v_and_b32 v149, s78, v50
    v_lshlrev_b32 v150, 16, v51
    v_and_b32 v151, s78, v51
    v_pk_add_f32 v[96:97], v[96:97], v[144:145]
    v_pk_add_f32 v[98:99], v[98:99], v[146:147]
    v_pk_add_f32 v[112:113], v[112:113], v[148:149]
    v_pk_add_f32 v[114:115], v[114:115], v[150:151]
    v_lshlrev_b32 v144, 16, v64
    v_and_b32 v145, s78, v64
    v_lshlrev_b32 v146, 16, v65
    v_and_b32 v147, s78, v65
    v_lshlrev_b32 v148, 16, v66
    v_and_b32 v149, s78, v66
    v_lshlrev_b32 v150, 16, v67
    v_and_b32 v151, s78, v67
    v_pk_add_f32 v[96:97], v[96:97], v[144:145]
    v_pk_add_f32 v[98:99], v[98:99], v[146:147]
    v_pk_add_f32 v[112:113], v[112:113], v[148:149]
    v_pk_add_f32 v[114:115], v[114:115], v[150:151]
    v_cvt_pk_bf16_f32 v128, v96, v97
    v_cvt_pk_bf16_f32 v129, v98, v99
    v_cvt_pk_bf16_f32 v130, v112, v113
    v_cvt_pk_bf16_f32 v131, v114, v115
    s_nop 1
    v_permlane16_swap_b32 v128, v130
    v_permlane16_swap_b32 v129, v131
    buffer_store_dwordx4 v[128:131], v216, s[24:27], 0 offen nt
    v_fma_f32 v100, v100, v201, v4
    v_fma_f32 v101, v101, v201, v5
    v_fma_f32 v102, v102, v201, v6
    v_fma_f32 v103, v103, v201, v7
    v_fma_f32 v116, v116, v201, v20
    v_fma_f32 v117, v117, v201, v21
    v_fma_f32 v118, v118, v201, v22
    v_fma_f32 v119, v119, v201, v23
    v_lshlrev_b32 v144, 16, v36
    v_and_b32 v145, s78, v36
    v_lshlrev_b32 v146, 16, v37
    v_and_b32 v147, s78, v37
    v_lshlrev_b32 v148, 16, v38
    v_and_b32 v149, s78, v38
    v_lshlrev_b32 v150, 16, v39
    v_and_b32 v151, s78, v39
    v_pk_add_f32 v[100:101], v[100:101], v[144:145]
    v_pk_add_f32 v[102:103], v[102:103], v[146:147]
    v_pk_add_f32 v[116:117], v[116:117], v[148:149]
    v_pk_add_f32 v[118:119], v[118:119], v[150:151]
    v_lshlrev_b32 v144, 16, v52
    v_and_b32 v145, s78, v52
    v_lshlrev_b32 v146, 16, v53
    v_and_b32 v147, s78, v53
    v_lshlrev_b32 v148, 16, v54
    v_and_b32 v149, s78, v54
    v_lshlrev_b32 v150, 16, v55
    v_and_b32 v151, s78, v55
    v_pk_add_f32 v[100:101], v[100:101], v[144:145]
    v_pk_add_f32 v[102:103], v[102:103], v[146:147]
    v_pk_add_f32 v[116:117], v[116:117], v[148:149]
    v_pk_add_f32 v[118:119], v[118:119], v[150:151]
    v_lshlrev_b32 v144, 16, v68
    v_and_b32 v145, s78, v68
    v_lshlrev_b32 v146, 16, v69
    v_and_b32 v147, s78, v69
    v_lshlrev_b32 v148, 16, v70
    v_and_b32 v149, s78, v70
    v_lshlrev_b32 v150, 16, v71
    v_and_b32 v151, s78, v71
    v_pk_add_f32 v[100:101], v[100:101], v[144:145]
    v_pk_add_f32 v[102:103], v[102:103], v[146:147]
    v_pk_add_f32 v[116:117], v[116:117], v[148:149]
    v_pk_add_f32 v[118:119], v[118:119], v[150:151]
    v_cvt_pk_bf16_f32 v132, v100, v101
    v_cvt_pk_bf16_f32 v133, v102, v103
    v_cvt_pk_bf16_f32 v134, v116, v117
    v_cvt_pk_bf16_f32 v135, v118, v119
    s_nop 1
    v_permlane16_swap_b32 v132, v134
    v_permlane16_swap_b32 v133, v135
    buffer_store_dwordx4 v[132:135], v217, s[24:27], 0 offen nt
    v_fma_f32 v104, v104, v202, v8
    v_fma_f32 v105, v105, v202, v9
    v_fma_f32 v106, v106, v202, v10
    v_fma_f32 v107, v107, v202, v11
    v_fma_f32 v120, v120, v202, v24
    v_fma_f32 v121, v121, v202, v25
    v_fma_f32 v122, v122, v202, v26
    v_fma_f32 v123, v123, v202, v27
    v_lshlrev_b32 v144, 16, v40
    v_and_b32 v145, s78, v40
    v_lshlrev_b32 v146, 16, v41
    v_and_b32 v147, s78, v41
    v_lshlrev_b32 v148, 16, v42
    v_and_b32 v149, s78, v42
    v_lshlrev_b32 v150, 16, v43
    v_and_b32 v151, s78, v43
    v_pk_add_f32 v[104:105], v[104:105], v[144:145]
    v_pk_add_f32 v[106:107], v[106:107], v[146:147]
    v_pk_add_f32 v[120:121], v[120:121], v[148:149]
    v_pk_add_f32 v[122:123], v[122:123], v[150:151]
    v_lshlrev_b32 v144, 16, v56
    v_and_b32 v145, s78, v56
    v_lshlrev_b32 v146, 16, v57
    v_and_b32 v147, s78, v57
    v_lshlrev_b32 v148, 16, v58
    v_and_b32 v149, s78, v58
    v_lshlrev_b32 v150, 16, v59
    v_and_b32 v151, s78, v59
    v_pk_add_f32 v[104:105], v[104:105], v[144:145]
    v_pk_add_f32 v[106:107], v[106:107], v[146:147]
    v_pk_add_f32 v[120:121], v[120:121], v[148:149]
    v_pk_add_f32 v[122:123], v[122:123], v[150:151]
    v_lshlrev_b32 v144, 16, v72
    v_and_b32 v145, s78, v72
    v_lshlrev_b32 v146, 16, v73
    v_and_b32 v147, s78, v73
    v_lshlrev_b32 v148, 16, v74
    v_and_b32 v149, s78, v74
    v_lshlrev_b32 v150, 16, v75
    v_and_b32 v151, s78, v75
    v_pk_add_f32 v[104:105], v[104:105], v[144:145]
    v_pk_add_f32 v[106:107], v[106:107], v[146:147]
    v_pk_add_f32 v[120:121], v[120:121], v[148:149]
    v_pk_add_f32 v[122:123], v[122:123], v[150:151]
    v_cvt_pk_bf16_f32 v136, v104, v105
    v_cvt_pk_bf16_f32 v137, v106, v107
    v_cvt_pk_bf16_f32 v138, v120, v121
    v_cvt_pk_bf16_f32 v139, v122, v123
    s_nop 1
    v_permlane16_swap_b32 v136, v138
    v_permlane16_swap_b32 v137, v139
    buffer_store_dwordx4 v[136:139], v218, s[24:27], 0 offen nt
    v_fma_f32 v108, v108, v203, v12
    v_fma_f32 v109, v109, v203, v13
    v_fma_f32 v110, v110, v203, v14
    v_fma_f32 v111, v111, v203, v15
    v_fma_f32 v124, v124, v203, v28
    v_fma_f32 v125, v125, v203, v29
    v_fma_f32 v126, v126, v203, v30
    v_fma_f32 v127, v127, v203, v31
    v_lshlrev_b32 v144, 16, v44
    v_and_b32 v145, s78, v44
    v_lshlrev_b32 v146, 16, v45
    v_and_b32 v147, s78, v45
    v_lshlrev_b32 v148, 16, v46
    v_and_b32 v149, s78, v46
    v_lshlrev_b32 v150, 16, v47
    v_and_b32 v151, s78, v47
    v_pk_add_f32 v[108:109], v[108:109], v[144:145]
    v_pk_add_f32 v[110:111], v[110:111], v[146:147]
    v_pk_add_f32 v[124:125], v[124:125], v[148:149]
    v_pk_add_f32 v[126:127], v[126:127], v[150:151]
    v_lshlrev_b32 v144, 16, v60
    v_and_b32 v145, s78, v60
    v_lshlrev_b32 v146, 16, v61
    v_and_b32 v147, s78, v61
    v_lshlrev_b32 v148, 16, v62
    v_and_b32 v149, s78, v62
    v_lshlrev_b32 v150, 16, v63
    v_and_b32 v151, s78, v63
    v_pk_add_f32 v[108:109], v[108:109], v[144:145]
    v_pk_add_f32 v[110:111], v[110:111], v[146:147]
    v_pk_add_f32 v[124:125], v[124:125], v[148:149]
    v_pk_add_f32 v[126:127], v[126:127], v[150:151]
    v_lshlrev_b32 v144, 16, v76
    v_and_b32 v145, s78, v76
    v_lshlrev_b32 v146, 16, v77
    v_and_b32 v147, s78, v77
    v_lshlrev_b32 v148, 16, v78
    v_and_b32 v149, s78, v78
    v_lshlrev_b32 v150, 16, v79
    v_and_b32 v151, s78, v79
    v_pk_add_f32 v[108:109], v[108:109], v[144:145]
    v_pk_add_f32 v[110:111], v[110:111], v[146:147]
    v_pk_add_f32 v[124:125], v[124:125], v[148:149]
    v_pk_add_f32 v[126:127], v[126:127], v[150:151]
    v_cvt_pk_bf16_f32 v140, v108, v109
    v_cvt_pk_bf16_f32 v141, v110, v111
    v_cvt_pk_bf16_f32 v142, v124, v125
    v_cvt_pk_bf16_f32 v143, v126, v127
    s_nop 1
    v_permlane16_swap_b32 v140, v142
    v_permlane16_swap_b32 v141, v143
    buffer_store_dwordx4 v[140:143], v219, s[24:27], 0 offen nt
k_fin:
k_done:
    s_endpgm
p3_wait:
    buffer_load_dword v251, v220, s[16:19], 0 offen sc1
    s_sub_u32 s40, s40, 1
    s_waitcnt vmcnt(0)
    s_cbranch_scc1 p3_load
    v_cmp_eq_u32 vcc, -1, v251
    s_nop 3
    s_or_b32 s39, vcc_lo, s50
    s_bitcmp1_b32 s39, 0
    s_cbranch_scc1 p3_w0
    s_bitset1_b32 s50, 0
    buffer_load_dwordx4 a[192:195], v213, s[16:19], 0 offen offset:0 sc1
    buffer_load_dwordx4 a[196:199], v213, s[16:19], 0 offen offset:1024 sc1
    buffer_load_dwordx4 a[200:203], v213, s[16:19], 0 offen offset:2048 sc1
    buffer_load_dwordx4 a[204:207], v213, s[16:19], 0 offen offset:3072 sc1
p3_w0:
    s_or_b32 s39, vcc_lo, s50
    s_bitcmp1_b32 s39, 1
    s_cbranch_scc1 p3_w1
    s_bitset1_b32 s50, 1
    buffer_load_dwordx4 a[208:211], v214, s[16:19], 0 offen offset:0 sc1
    buffer_load_dwordx4 a[212:215], v214, s[16:19], 0 offen offset:1024 sc1
    buffer_load_dwordx4 a[216:219], v214, s[16:19], 0 offen offset:2048 sc1
    buffer_load_dwordx4 a[220:223], v214, s[16:19], 0 offen offset:3072 sc1
p3_w1:
    s_or_b32 s39, vcc_lo, s50
    s_bitcmp1_b32 s39, 2
    s_cbranch_scc1 p3_w2
    s_bitset1_b32 s50, 2
    buffer_load_dwordx4 a[224:227], v215, s[16:19], 0 offen offset:0 sc1
    buffer_load_dwordx4 a[228:231], v215, s[16:19], 0 offen offset:1024 sc1
    buffer_load_dwordx4 a[232:235], v215, s[16:19], 0 offen offset:2048 sc1
    buffer_load_dwordx4 a[236:239], v215, s[16:19], 0 offen offset:3072 sc1
p3_w2:
    s_cmp_eq_u32 s50, 7
    s_cbranch_scc1 p3_have
    s_sleep 2
    s_branch p3_wait
p3_again:
    s_sub_u32 s40, s40, 1
    s_cbranch_scc1 p3_got
p3_load:
    buffer_load_dwordx4 a[192:195], v213, s[16:19], 0 offen offset:0 sc1
    buffer_load_dwordx4 a[196:199], v213, s[16:19], 0 offen offset:1024 sc1
    buffer_load_dwordx4 a[200:203], v213, s[16:19], 0 offen offset:2048 sc1
    buffer_load_dwordx4 a[204:207], v213, s[16:19], 0 offen offset:3072 sc1
    buffer_load_dwordx4 a[208:211], v214, s[16:19], 0 offen offset:0 sc1
    buffer_load_dwordx4 a[212:215], v214, s[16:19], 0 offen offset:1024 sc1
    buffer_load_dwordx4 a[216:219], v214, s[16:19], 0 offen offset:2048 sc1
    buffer_load_dwordx4 a[220:223], v214, s[16:19], 0 offen offset:3072 sc1
    buffer_load_dwordx4 a[224:227], v215, s[16:19], 0 offen offset:0 sc1
    buffer_load_dwordx4 a[228:231], v215, s[16:19], 0 offen offset:1024 sc1
    buffer_load_dwordx4 a[232:235], v215, s[16:19], 0 offen offset:2048 sc1
    buffer_load_dwordx4 a[236:239], v215, s[16:19], 0 offen offset:3072 sc1
    s_branch p3_have
oready_spin:
    s_mov_b32 s40, 1048576
oready_spin1:
    s_sleep 2
    buffer_load_dword v251, v252, s[16:19], s72 offen sc1
    s_waitcnt vmcnt(0)
    v_readfirstlane_b32 s62, v251
    s_sub_u32 s40, s40, 1
    s_cbranch_scc1 oready_ok
    s_cmp_ge_u32 s62, 128
    s_cbranch_scc0 oready_spin1
    s_branch oready_ok
p1_clear:
    s_sub_u32 s39, s2, 248
    s_lshl_b32 s39, s39, 2
    s_add_u32 s39, s39, s3
    s_mul_i32 s39, s39, 768
    s_add_u32 s39, s39, 0x1e02000
    v_min_u32 v208, 11, v255
    v_and_b32 v209, 1, v208
    v_lshrrev_b32 v208, 1, v208
    v_lshlrev_b32 v208, 7, v208
    v_lshl_add_u32 v208, v209, 4, v208
    buffer_store_dwordx4 v[212:215], v208, s[16:19], s39 offen sc1
    s_branch p1_clear_ret
p1_init:
    buffer_atomic_add v253, v252, s[28:31], 0 offen sc1
    s_branch p1_init_ret
init_spin:
    s_mov_b32 s40, 1048576
init_spin1:
    s_sleep 2
    buffer_load_dword v251, v252, s[28:31], 0 offen sc1
    s_waitcnt vmcnt(0)
    v_readfirstlane_b32 s62, v251
    s_sub_u32 s40, s40, 1
    s_cbranch_scc1 init_ok
    s_cmp_ge_u32 s62, 32
    s_cbranch_scc0 init_spin1
    s_branch init_ok
p2_slow:
    s_waitcnt vmcnt(0) lgkmcnt(0)
    s_lshl_b32 s39, s37, 17
    s_add_u32 s39, s39, 0x400000
    s_add_u32 s78, s39, 0x400000
    v_mov_b32 v64, 0
    v_mov_b32 v65, 0
    v_mov_b32 v66, 0
    v_mov_b32 v67, 0
    v_mov_b32 v68, 0
    v_mov_b32 v69, 0
    v_mov_b32 v70, 0
    v_mov_b32 v71, 0
    v_mov_b32 v72, 0
    v_mov_b32 v73, 0
    v_mov_b32 v74, 0
    v_mov_b32 v75, 0
    v_mov_b32 v76, 0
    v_mov_b32 v77, 0
    v_mov_b32 v78, 0
    v_mov_b32 v79, 0
    v_mov_b32 v192, 0
    v_mov_b32 v193, 0
    v_mov_b32 v194, 0
    v_mov_b32 v195, 0
    v_sub_f32 v32, 0, v32
    v_mov_b32 v80, 0
    v_mov_b32 v81, 0
    v_mov_b32 v82, 0
    v_mov_b32 v83, 0
    v_mov_b32 v84, 0
    v_mov_b32 v85, 0
    v_mov_b32 v86, 0
    v_mov_b32 v87, 0
    v_mov_b32 v88, 0
    v_mov_b32 v89, 0
    v_mov_b32 v90, 0
    v_mov_b32 v91, 0
    v_mov_b32 v92, 0
    v_mov_b32 v93, 0
    v_mov_b32 v94, 0
    v_mov_b32 v95, 0
    v_mov_b32 v196, 0
    v_mov_b32 v197, 0
    v_mov_b32 v198, 0
    v_mov_b32 v199, 0
    v_sub_f32 v48, 0, v48
    s_mov_b32 s38, 64
p2_slow_loop:
    buffer_load_dwordx4 a[208:211], v245, s[16:19], s39 offen offset:0 sc1
    buffer_load_dwordx4 a[212:215], v245, s[16:19], s39 offen offset:512 sc1
    buffer_load_dwordx4 a[224:227], v254, s[16:19], s78 offen offset:0 sc1
    buffer_load_dwordx4 a[228:231], v254, s[16:19], s78 offen offset:1024 sc1
    s_add_u32 s39, s39, 2048
    s_add_u32 s78, s78, 2048
    s_waitcnt vmcnt(0)
    v_mfma_f32_32x32x16_bf16 v[0:15], a[208:211], a[240:243], 0
    v_mfma_f32_32x32x16_bf16 v[0:15], a[212:215], a[244:247], v[0:15]
    v_mfma_f32_32x32x16_bf16 v[16:31], a[208:211], a[248:251], 0
    v_mfma_f32_32x32x16_bf16 v[16:31], a[212:215], a[252:255], v[16:31]
    s_nop 7
    s_nop 3
    v_max3_f32 v214, v0, v1, v32
    v_max3_f32 v214, v214, v2, v3
    v_max3_f32 v214, v214, v4, v5
    v_max3_f32 v214, v214, v6, v7
    v_max3_f32 v214, v214, v8, v9
    v_max3_f32 v214, v214, v10, v11
    v_max3_f32 v214, v214, v12, v13
    v_max3_f32 v214, v214, v14, v15
    v_mov_b32 v215, v214
    s_nop 1
    v_permlane32_swap_b32 v214, v215
    v_max_f32 v214, v214, v215
    v_sub_f32 v216, v32, v214
    v_exp_f32 v216, v216
    v_mov_b32 v32, v214
    v_sub_f32 v0, v0, v214
    v_sub_f32 v1, v1, v214
    v_sub_f32 v2, v2, v214
    v_sub_f32 v3, v3, v214
    v_sub_f32 v4, v4, v214
    v_sub_f32 v5, v5, v214
    v_sub_f32 v6, v6, v214
    v_sub_f32 v7, v7, v214
    v_sub_f32 v8, v8, v214
    v_sub_f32 v9, v9, v214
    v_sub_f32 v10, v10, v214
    v_sub_f32 v11, v11, v214
    v_sub_f32 v12, v12, v214
    v_sub_f32 v13, v13, v214
    v_sub_f32 v14, v14, v214
    v_sub_f32 v15, v15, v214
    v_exp_f32 v0, v0
    v_exp_f32 v1, v1
    v_exp_f32 v2, v2
    v_exp_f32 v3, v3
    v_exp_f32 v4, v4
    v_exp_f32 v5, v5
    v_exp_f32 v6, v6
    v_exp_f32 v7, v7
    v_exp_f32 v8, v8
    v_exp_f32 v9, v9
    v_exp_f32 v10, v10
    v_exp_f32 v11, v11
    v_exp_f32 v12, v12
    v_exp_f32 v13, v13
    v_exp_f32 v14, v14
    v_exp_f32 v15, v15
    v_mul_f32 v64, v64, v216
    v_mul_f32 v65, v65, v216
    v_mul_f32 v66, v66, v216
    v_mul_f32 v67, v67, v216
    v_mul_f32 v68, v68, v216
    v_mul_f32 v69, v69, v216
    v_mul_f32 v70, v70, v216
    v_mul_f32 v71, v71, v216
    v_mul_f32 v72, v72, v216
    v_mul_f32 v73, v73, v216
    v_mul_f32 v74, v74, v216
    v_mul_f32 v75, v75, v216
    v_mul_f32 v76, v76, v216
    v_mul_f32 v77, v77, v216
    v_mul_f32 v78, v78, v216
    v_mul_f32 v79, v79, v216
    v_mul_f32 v192, v192, v216
    s_nop 1
    v_smfmac_f32_32x32x32_bf16 v[64:79], a[224:227], v[0:7], v244
    v_smfmac_f32_16x16x64_bf16 v[192:195], v[240:243], v[0:7], v244
    v_smfmac_f32_32x32x32_bf16 v[64:79], a[228:231], v[8:15], v244
    v_smfmac_f32_16x16x64_bf16 v[192:195], v[240:243], v[8:15], v244
    v_max3_f32 v214, v16, v17, v48
    v_max3_f32 v214, v214, v18, v19
    v_max3_f32 v214, v214, v20, v21
    v_max3_f32 v214, v214, v22, v23
    v_max3_f32 v214, v214, v24, v25
    v_max3_f32 v214, v214, v26, v27
    v_max3_f32 v214, v214, v28, v29
    v_max3_f32 v214, v214, v30, v31
    v_mov_b32 v215, v214
    s_nop 1
    v_permlane32_swap_b32 v214, v215
    v_max_f32 v214, v214, v215
    v_sub_f32 v216, v48, v214
    v_exp_f32 v216, v216
    v_mov_b32 v48, v214
    v_sub_f32 v16, v16, v214
    v_sub_f32 v17, v17, v214
    v_sub_f32 v18, v18, v214
    v_sub_f32 v19, v19, v214
    v_sub_f32 v20, v20, v214
    v_sub_f32 v21, v21, v214
    v_sub_f32 v22, v22, v214
    v_sub_f32 v23, v23, v214
    v_sub_f32 v24, v24, v214
    v_sub_f32 v25, v25, v214
    v_sub_f32 v26, v26, v214
    v_sub_f32 v27, v27, v214
    v_sub_f32 v28, v28, v214
    v_sub_f32 v29, v29, v214
    v_sub_f32 v30, v30, v214
    v_sub_f32 v31, v31, v214
    v_exp_f32 v16, v16
    v_exp_f32 v17, v17
    v_exp_f32 v18, v18
    v_exp_f32 v19, v19
    v_exp_f32 v20, v20
    v_exp_f32 v21, v21
    v_exp_f32 v22, v22
    v_exp_f32 v23, v23
    v_exp_f32 v24, v24
    v_exp_f32 v25, v25
    v_exp_f32 v26, v26
    v_exp_f32 v27, v27
    v_exp_f32 v28, v28
    v_exp_f32 v29, v29
    v_exp_f32 v30, v30
    v_exp_f32 v31, v31
    v_mul_f32 v80, v80, v216
    v_mul_f32 v81, v81, v216
    v_mul_f32 v82, v82, v216
    v_mul_f32 v83, v83, v216
    v_mul_f32 v84, v84, v216
    v_mul_f32 v85, v85, v216
    v_mul_f32 v86, v86, v216
    v_mul_f32 v87, v87, v216
    v_mul_f32 v88, v88, v216
    v_mul_f32 v89, v89, v216
    v_mul_f32 v90, v90, v216
    v_mul_f32 v91, v91, v216
    v_mul_f32 v92, v92, v216
    v_mul_f32 v93, v93, v216
    v_mul_f32 v94, v94, v216
    v_mul_f32 v95, v95, v216
    v_mul_f32 v196, v196, v216
    s_nop 1
    v_smfmac_f32_32x32x32_bf16 v[80:95], a[224:227], v[16:23], v244
    v_smfmac_f32_16x16x64_bf16 v[196:199], v[240:243], v[16:23], v244
    v_smfmac_f32_32x32x32_bf16 v[80:95], a[228:231], v[24:31], v244
    v_smfmac_f32_16x16x64_bf16 v[196:199], v[240:243], v[24:31], v244
    s_sub_u32 s38, s38, 1
    s_cmp_lg_u32 s38, 0
    s_cbranch_scc1 p2_slow_loop
    s_nop 7
    s_nop 3
    s_branch p2_epi
kv_spin:
    s_mov_b32 s40, 1048576
kv_spin1:
    s_sleep 2
    buffer_load_dword v251, v252, s[16:19], s74 offen sc1
    s_waitcnt vmcnt(0)
    v_readfirstlane_b32 s62, v251
    s_sub_u32 s40, s40, 1
    s_cbranch_scc1 kv_ok
    s_cmp_ge_u32 s62, 32
    s_cbranch_scc0 kv_spin1
    s_branch kv_ok
hready_spin:
    s_mov_b32 s40, 1048576
hready_spin1:
    s_sleep 2
    buffer_load_dword v251, v252, s[16:19], s75 offen sc1
    s_waitcnt vmcnt(0)
    v_readfirstlane_b32 s62, v251
    s_sub_u32 s40, s40, 1
    s_cbranch_scc1 hready_ok
    s_cmp_ge_u32 s62, 128
    s_cbranch_scc0 hready_spin1
    s_branch hready_ok
k_end:
.section .rodata,"a"
.p2align 6
.amdhsa_kernel gated_mix__softmax_full_mha__glu_gated_bilinear__prompt_kernel
  .amdhsa_next_free_vgpr 512
  .amdhsa_next_free_sgpr 102
  .amdhsa_accum_offset 256
  .amdhsa_group_segment_fixed_size 0
  .amdhsa_kernarg_size 88
  .amdhsa_user_sgpr_count 2
  .amdhsa_user_sgpr_kernarg_segment_ptr 1
  .amdhsa_system_sgpr_workgroup_id_x 1
  .amdhsa_float_denorm_mode_32 3
.end_amdhsa_kernel
```
